```python
import torch

def _softmax(x, axis=-1):
    return torch.softmax(x, dim=axis)

def _gelu(x):
    return torch.nn.functional.gelu(x, approximate='tanh')

def _silu(x):
    return torch.nn.functional.silu(x)

def _sigmoid(x):
    return torch.sigmoid(x)

def _layernorm(x, axis=-1, eps=1e-05):
    m = x.mean(dim=axis, keepdim=True)
    v = x.var(dim=axis, keepdim=True, unbiased=False)
    return (x - m) / torch.sqrt(v + eps)

def _scatter_add(tgt, idx, src, axis=0):
    return tgt.clone().index_add_(axis, idx, src)

def _segment_sum(src, seg, n):
    out = torch.zeros((n,) + src.shape[1:], dtype=src.dtype)
    return out.index_add_(0, seg, src)

def _pad(x, pw):
    flat = tuple((v for pair in reversed(pw) for v in pair))
    return torch.nn.functional.pad(x, flat)
kernel_name = 'sequential_preLN__memory_aug_recurrent_mem_tr__mixer_token_mlp__prompt'

def setup_inputs():

    _w = lambda a: (lambda t: t.to(torch.bfloat16) if t.is_floating_point() else t)(torch.as_tensor(a))

    def _A_setup():
        B, S, Dm = (1, 2048, 512)
        H, Dh = (32, 128)
        M, seg = (8, 32)
        seg = min(seg, S)
        S = S // seg * seg
        return {'x': _w((lambda *s: torch.randn(*s, dtype=torch.bfloat16) * 0.05)(B, S, Dm)), 'mem0': _w((lambda *s: torch.randn(*s, dtype=torch.bfloat16) * 0.2)(B, M, Dm)), 'Wq': _w((lambda *s: torch.randn(*s, dtype=torch.bfloat16) * 1.6)(Dm, H, Dh) * Dm ** (-0.5)), 'Wk': _w((lambda *s: torch.randn(*s, dtype=torch.bfloat16) * 1.6)(Dm, H, Dh) * Dm ** (-0.5)), 'Wv': _w((lambda *s: torch.randn(*s, dtype=torch.bfloat16) * 0.2)(Dm, H, Dh) * Dm ** (-0.5)), 'Wo': _w((lambda *s: torch.randn(*s, dtype=torch.bfloat16) * 0.2)(H, Dh, Dm) * (H * Dh) ** (-0.5)), 'seg_len': seg}
    _A_in = _A_setup()

    def _B_setup():
        B, S, D, F = (1, 2048, 512, 1792)
        return {'x': _w((lambda *s: torch.randn(*s, dtype=torch.bfloat16) * 0.05)(B, S, D)), 'w1': _w((lambda *s: torch.randn(*s, dtype=torch.bfloat16) * 0.4)(S, F) * S ** (-0.5)), 'b1': _w((lambda *s: torch.randn(*s, dtype=torch.bfloat16) * 3.2)(F) * 0.02), 'w2': _w((lambda *s: torch.randn(*s, dtype=torch.bfloat16) * 0.2)(F, S) * F ** (-0.5)), 'b2': _w((lambda *s: torch.randn(*s, dtype=torch.bfloat16) * 0.4)(S) * 0.02)}
    _B_in = _B_setup()
    return {'A_x': _A_in['x'], 'A_mem0': _A_in['mem0'], 'A_Wq': _A_in['Wq'], 'A_Wk': _A_in['Wk'], 'A_Wv': _A_in['Wv'], 'A_Wo': _A_in['Wo'], 'A_seg_len': _A_in['seg_len'], 'B_x': _B_in['x'], 'B_w1': _B_in['w1'], 'B_b1': _B_in['b1'], 'B_w2': _B_in['w2'], 'B_b2': _B_in['b2']}

def reference(A_x, A_mem0, A_Wq, A_Wk, A_Wv, A_Wo, A_seg_len, B_x, B_w1, B_b1, B_w2, B_b2):

    def _A_ref(x, mem0, Wq, Wk, Wv, Wo, seg_len):
        B, S, Dm = x.shape
        H, Dh = (Wq.shape[1], Wq.shape[2])
        M = mem0.shape[1]
        scale = Dh ** (-0.5)
        n_seg = S // seg_len
        L = M + seg_len
        idx = torch.arange(L)
        mask = (idx[:, None] < M) | (idx[:, None] >= idx[None, :])
        mem = mem0
        outs = []
        for s in range(n_seg):
            xs = x[:, s * seg_len:(s + 1) * seg_len, :].clone()
            h = torch.concatenate([mem, xs], axis=1)
            q = torch.einsum('btd,dhe->bhte', h, Wq)
            k = torch.einsum('btd,dhe->bhte', h, Wk)
            v = torch.einsum('btd,dhe->bhte', h, Wv)
            scores = torch.einsum('bhqe,bhke->bhqk', q, k) * scale
            scores = torch.where(mask[None, None], scores, -1000000000.0)
            p = _softmax(scores, axis=-1)
            o = torch.einsum('bhqk,bhke->bhqe', p, v)
            o = torch.einsum('bhte,hed->btd', o, Wo)
            mem = o[:, :M, :].clone()
            outs.append(o[:, M:, :])
        return torch.concatenate(outs, axis=1)

    def _B_ref(x, w1, b1, w2, b2):
        B, S, D = x.shape
        h = _layernorm(x, axis=-1)
        u = torch.einsum('bsd,sf->bdf', h, w1) + b1
        u = _gelu(u)
        y = torch.einsum('bdf,fs->bds', u, w2) + b2
        return (lambda x, *d: x.permute(*d))(y, 0, 2, 1)
    x = A_x
    h = x + _A_ref(_layernorm(x, axis=-1), A_mem0, A_Wq, A_Wk, A_Wv, A_Wo, A_seg_len)
    h2 = h + _B_ref(_layernorm(h, axis=-1), B_w1, B_b1, B_w2, B_b2)
    return h2
```

```asm
; @launch grid=(256,1,1) block=(256,1,1) lds=163328
.amdgcn_target "amdgcn-amd-amdhsa--gfx950"
.text
.globl sequential_preLN__memory_aug_recurrent_mem_tr__mixer_token_mlp__prompt_kernel
.p2align 8
.type sequential_preLN__memory_aug_recurrent_mem_tr__mixer_token_mlp__prompt_kernel,@function
sequential_preLN__memory_aug_recurrent_mem_tr__mixer_token_mlp__prompt_kernel:
    s_cmp_ge_u32 s2, 256
    s_cbranch_scc1 L_exit_1
    s_load_dwordx2 s[16:17], s[0:1], 112
    s_load_dwordx2 s[18:19], s[0:1], 104
    s_load_dwordx4 s[20:23], s[0:1], 16
    s_load_dwordx4 s[24:27], s[0:1], 32
    s_load_dwordx2 s[28:29], s[0:1], 8
    s_load_dwordx2 s[30:31], s[0:1], 0
    v_lshrrev_b32 v1, 6, v0
    v_and_b32 v0, 63, v0
    v_readfirstlane_b32 s33, v1
    s_getreg_b32 s83, hwreg(HW_REG_XCC_ID)
    s_mov_b32 s35, 0x80000
    s_waitcnt lgkmcnt(0)
    s_mov_b32 s4, s16
    s_and_b32 s5, s17, 0xffff
    s_mov_b32 s6, 0x10000000
    s_mov_b32 s7, 0x20000
    s_mov_b32 s84, s18
    s_and_b32 s85, s19, 0xffff
    s_mov_b32 s86, 0x100
    s_mov_b32 s87, 0x20000
    s_mov_b32 s12, s30
    s_and_b32 s13, s31, 0xffff
    s_mov_b32 s14, 0x200000
    s_mov_b32 s15, 0x20000
    v_and_b32 v24, 15, v0
    v_lshrrev_b32 v25, 4, v0
    s_cmp_ge_u32 s2, 128
    s_nop 0
    s_cbranch_scc1 L_l0_2
    v_lshlrev_b32 v26, 10, v24
    v_lshl_add_u32 v26, v25, 4, v26
    s_lshl_b32 s82, s2, 14
    s_lshl_b32 s48, s33, 8
    s_add_u32 s48, s48, s82
    buffer_load_dwordx4 v[32:35], v26, s[12:15], s48 offen offset:0
    buffer_load_dwordx4 v[36:39], v26, s[12:15], s48 offen offset:64
    buffer_load_dwordx4 v[40:43], v26, s[12:15], s48 offen offset:128
    buffer_load_dwordx4 v[44:47], v26, s[12:15], s48 offen offset:192
L_l0_2:
    s_mov_b32 s60, 0
    s_cmp_eq_u32 s33, 0
    s_cbranch_scc1 L_role0_4
    s_branch L_role_done_3
L_role0_4:
    s_mov_b64 exec, 1
    v_mov_b32 v2, 1
    s_cmp_lt_u32 s83, 8
    s_nop 0
    s_cbranch_scc1 L_nw_5
    buffer_atomic_or v2, off, s[84:87], 0 offset:40
    s_waitcnt vmcnt(0)
L_nw_5:
    s_and_b32 s34, s83, 7
    s_lshl_b32 s48, s34, 2
    buffer_atomic_add v2, off, s[84:87], s48 sc0
    s_waitcnt vmcnt(0)
    v_readfirstlane_b32 s32, v2
    s_nop 1
    s_cmp_lt_u32 s32, 32
    s_nop 1
    s_cbranch_scc1 L_rok_6
    v_mov_b32 v2, 1
    buffer_atomic_add v2, off, s[84:87], 0 offset:36 sc0
    s_waitcnt vmcnt(0)
    v_readfirstlane_b32 s51, v2
    s_nop 4
L_ovf_7:
    buffer_load_dwordx4 v[4:7], off, s[84:87], 0 sc1
    buffer_load_dwordx4 v[8:11], off, s[84:87], 0 offset:16 sc1
    s_sub_u32 s35, s35, 1
    s_cbranch_scc1 L_exit_1
    s_waitcnt vmcnt(0)
    s_mov_b32 s48, 0
    v_readfirstlane_b32 s64, v4
    v_readfirstlane_b32 s65, v5
    v_readfirstlane_b32 s66, v6
    v_readfirstlane_b32 s67, v7
    v_readfirstlane_b32 s68, v8
    v_readfirstlane_b32 s69, v9
    v_readfirstlane_b32 s70, v10
    v_readfirstlane_b32 s71, v11
    s_add_u32 s48, s48, s64
    s_add_u32 s48, s48, s65
    s_add_u32 s48, s48, s66
    s_add_u32 s48, s48, s67
    s_add_u32 s48, s48, s68
    s_add_u32 s48, s48, s69
    s_add_u32 s48, s48, s70
    s_add_u32 s48, s48, s71
    s_cmp_lt_u32 s48, 256
    s_cbranch_scc1 L_ovf_7
    s_min_u32 s48, s64, 32
    s_sub_u32 s49, 32, s48
    s_mov_b32 s34, 0
    s_add_u32 s32, s48, s51
    s_cmp_lt_u32 s51, s49
    s_cbranch_scc1 L_rok_6
    s_sub_u32 s51, s51, s49
    s_min_u32 s48, s65, 32
    s_sub_u32 s49, 32, s48
    s_mov_b32 s34, 1
    s_add_u32 s32, s48, s51
    s_cmp_lt_u32 s51, s49
    s_cbranch_scc1 L_rok_6
    s_sub_u32 s51, s51, s49
    s_min_u32 s48, s66, 32
    s_sub_u32 s49, 32, s48
    s_mov_b32 s34, 2
    s_add_u32 s32, s48, s51
    s_cmp_lt_u32 s51, s49
    s_cbranch_scc1 L_rok_6
    s_sub_u32 s51, s51, s49
    s_min_u32 s48, s67, 32
    s_sub_u32 s49, 32, s48
    s_mov_b32 s34, 3
    s_add_u32 s32, s48, s51
    s_cmp_lt_u32 s51, s49
    s_cbranch_scc1 L_rok_6
    s_sub_u32 s51, s51, s49
    s_min_u32 s48, s68, 32
    s_sub_u32 s49, 32, s48
    s_mov_b32 s34, 4
    s_add_u32 s32, s48, s51
    s_cmp_lt_u32 s51, s49
    s_cbranch_scc1 L_rok_6
    s_sub_u32 s51, s51, s49
    s_min_u32 s48, s69, 32
    s_sub_u32 s49, 32, s48
    s_mov_b32 s34, 5
    s_add_u32 s32, s48, s51
    s_cmp_lt_u32 s51, s49
    s_cbranch_scc1 L_rok_6
    s_sub_u32 s51, s51, s49
    s_min_u32 s48, s70, 32
    s_sub_u32 s49, 32, s48
    s_mov_b32 s34, 6
    s_add_u32 s32, s48, s51
    s_cmp_lt_u32 s51, s49
    s_cbranch_scc1 L_rok_6
    s_sub_u32 s51, s51, s49
    s_min_u32 s48, s71, 32
    s_sub_u32 s49, 32, s48
    s_mov_b32 s34, 7
    s_add_u32 s32, s48, s51
    s_cmp_lt_u32 s51, s49
    s_cbranch_scc1 L_rok_6
    s_sub_u32 s51, s51, s49
    s_mov_b32 s34, 0x100
    s_mov_b32 s32, 0
L_rok_6:
    s_lshl_b32 s48, s34, 8
    s_or_b32 s48, s48, s32
    v_mov_b32 v2, s48
    v_mov_b32 v3, 0
    ds_write_b32 v3, v2
    s_waitcnt lgkmcnt(0)
    s_mov_b64 exec, -1
L_role_done_3:
    s_cmp_ge_u32 s2, 128
    s_cbranch_scc1 L_lno_8
    s_lshl_b32 s48, s33, 2
    v_lshlrev_b32 v27, 4, v24
    v_add_u32 v26, s48, v27
    s_cmp_eq_u32 s60, 1
    s_nop 0
    s_cbranch_scc1 L_sw_10
    s_waitcnt vmcnt(0)
L_sw_10:
    v_lshlrev_b32 v48, 16, v32
    v_and_b32 v49, 0xffff0000, v32
    v_lshlrev_b32 v50, 16, v33
    v_and_b32 v51, 0xffff0000, v33
    v_lshlrev_b32 v52, 16, v34
    v_and_b32 v53, 0xffff0000, v34
    v_lshlrev_b32 v54, 16, v35
    v_and_b32 v55, 0xffff0000, v35
    v_lshlrev_b32 v56, 16, v36
    v_and_b32 v57, 0xffff0000, v36
    v_lshlrev_b32 v58, 16, v37
    v_and_b32 v59, 0xffff0000, v37
    v_lshlrev_b32 v60, 16, v38
    v_and_b32 v61, 0xffff0000, v38
    v_lshlrev_b32 v62, 16, v39
    v_and_b32 v63, 0xffff0000, v39
    v_lshlrev_b32 v64, 16, v40
    v_and_b32 v65, 0xffff0000, v40
    v_lshlrev_b32 v66, 16, v41
    v_and_b32 v67, 0xffff0000, v41
    v_lshlrev_b32 v68, 16, v42
    v_and_b32 v69, 0xffff0000, v42
    v_lshlrev_b32 v70, 16, v43
    v_and_b32 v71, 0xffff0000, v43
    v_lshlrev_b32 v72, 16, v44
    v_and_b32 v73, 0xffff0000, v44
    v_lshlrev_b32 v74, 16, v45
    v_and_b32 v75, 0xffff0000, v45
    v_lshlrev_b32 v76, 16, v46
    v_and_b32 v77, 0xffff0000, v46
    v_lshlrev_b32 v78, 16, v47
    v_and_b32 v79, 0xffff0000, v47
    v_add_f32 v28, v48, v49
    v_add_f32 v29, v50, v51
    v_add_f32 v28, v28, v52
    v_add_f32 v29, v29, v53
    v_add_f32 v28, v28, v54
    v_add_f32 v29, v29, v55
    v_add_f32 v28, v28, v56
    v_add_f32 v29, v29, v57
    v_add_f32 v28, v28, v58
    v_add_f32 v29, v29, v59
    v_add_f32 v28, v28, v60
    v_add_f32 v29, v29, v61
    v_add_f32 v28, v28, v62
    v_add_f32 v29, v29, v63
    v_add_f32 v28, v28, v64
    v_add_f32 v29, v29, v65
    v_add_f32 v28, v28, v66
    v_add_f32 v29, v29, v67
    v_add_f32 v28, v28, v68
    v_add_f32 v29, v29, v69
    v_add_f32 v28, v28, v70
    v_add_f32 v29, v29, v71
    v_add_f32 v28, v28, v72
    v_add_f32 v29, v29, v73
    v_add_f32 v28, v28, v74
    v_add_f32 v29, v29, v75
    v_add_f32 v28, v28, v76
    v_add_f32 v29, v29, v77
    v_add_f32 v28, v28, v78
    v_add_f32 v29, v29, v79
    v_add_f32 v28, v28, v29
    v_mov_b32 v29, v28
    s_nop 1
    v_permlane32_swap_b32 v28, v29
    v_add_f32 v28, v28, v29
    v_mov_b32 v29, v28
    s_nop 1
    v_permlane16_swap_b32 v28, v29
    v_add_f32 v28, v28, v29
    ds_write_b32 v26, v28 offset:64
    s_waitcnt lgkmcnt(0)
    s_barrier
    v_mov_b32 v3, 0
    ds_read_b32 v2, v3
    ds_read_b128 v[28:31], v27 offset:64
    s_waitcnt lgkmcnt(0)
    v_add_f32 v28, v28, v29
    v_add_f32 v30, v30, v31
    v_add_f32 v28, v28, v30
    v_mul_f32 v28, 0x3b000000, v28
    v_mov_b32 v29, 0
    v_mov_b32 v30, 0
    v_sub_f32 v48, v48, v28
    v_sub_f32 v49, v49, v28
    v_fmac_f32 v29, v48, v48
    v_fmac_f32 v30, v49, v49
    v_sub_f32 v50, v50, v28
    v_sub_f32 v51, v51, v28
    v_fmac_f32 v29, v50, v50
    v_fmac_f32 v30, v51, v51
    v_sub_f32 v52, v52, v28
    v_sub_f32 v53, v53, v28
    v_fmac_f32 v29, v52, v52
    v_fmac_f32 v30, v53, v53
    v_sub_f32 v54, v54, v28
    v_sub_f32 v55, v55, v28
    v_fmac_f32 v29, v54, v54
    v_fmac_f32 v30, v55, v55
    v_sub_f32 v56, v56, v28
    v_sub_f32 v57, v57, v28
    v_fmac_f32 v29, v56, v56
    v_fmac_f32 v30, v57, v57
    v_sub_f32 v58, v58, v28
    v_sub_f32 v59, v59, v28
    v_fmac_f32 v29, v58, v58
    v_fmac_f32 v30, v59, v59
    v_sub_f32 v60, v60, v28
    v_sub_f32 v61, v61, v28
    v_fmac_f32 v29, v60, v60
    v_fmac_f32 v30, v61, v61
    v_sub_f32 v62, v62, v28
    v_sub_f32 v63, v63, v28
    v_fmac_f32 v29, v62, v62
    v_fmac_f32 v30, v63, v63
    v_sub_f32 v64, v64, v28
    v_sub_f32 v65, v65, v28
    v_fmac_f32 v29, v64, v64
    v_fmac_f32 v30, v65, v65
    v_sub_f32 v66, v66, v28
    v_sub_f32 v67, v67, v28
    v_fmac_f32 v29, v66, v66
    v_fmac_f32 v30, v67, v67
    v_sub_f32 v68, v68, v28
    v_sub_f32 v69, v69, v28
    v_fmac_f32 v29, v68, v68
    v_fmac_f32 v30, v69, v69
    v_sub_f32 v70, v70, v28
    v_sub_f32 v71, v71, v28
    v_fmac_f32 v29, v70, v70
    v_fmac_f32 v30, v71, v71
    v_sub_f32 v72, v72, v28
    v_sub_f32 v73, v73, v28
    v_fmac_f32 v29, v72, v72
    v_fmac_f32 v30, v73, v73
    v_sub_f32 v74, v74, v28
    v_sub_f32 v75, v75, v28
    v_fmac_f32 v29, v74, v74
    v_fmac_f32 v30, v75, v75
    v_sub_f32 v76, v76, v28
    v_sub_f32 v77, v77, v28
    v_fmac_f32 v29, v76, v76
    v_fmac_f32 v30, v77, v77
    v_sub_f32 v78, v78, v28
    v_sub_f32 v79, v79, v28
    v_fmac_f32 v29, v78, v78
    v_fmac_f32 v30, v79, v79
    v_add_f32 v29, v29, v30
    v_mov_b32 v30, v29
    s_nop 1
    v_permlane32_swap_b32 v29, v30
    v_add_f32 v29, v29, v30
    v_mov_b32 v30, v29
    s_nop 1
    v_permlane16_swap_b32 v29, v30
    v_add_f32 v29, v29, v30
    ds_write_b32 v26, v29 offset:320
    s_waitcnt lgkmcnt(0)
    s_barrier
    ds_read_b128 v[28:31], v27 offset:320
    s_waitcnt lgkmcnt(0)
    v_add_f32 v28, v28, v29
    v_add_f32 v30, v30, v31
    v_add_f32 v28, v28, v30
    v_mov_b32 v29, 0x3727c5ac
    v_fmac_f32 v29, 0x3b000000, v28
    v_rsq_f32 v29, v29
    v_lshlrev_b32 v26, 4, v0
    s_lshl_b32 s48, s33, 12
    s_add_u32 s48, s48, s82
    s_add_u32 s48, s48, 0x0
    v_mul_f32 v48, v48, v29
    v_mul_f32 v49, v49, v29
    v_cvt_pk_bf16_f32 v32, v48, v49
    v_mul_f32 v50, v50, v29
    v_mul_f32 v51, v51, v29
    v_cvt_pk_bf16_f32 v33, v50, v51
    v_mul_f32 v52, v52, v29
    v_mul_f32 v53, v53, v29
    v_cvt_pk_bf16_f32 v34, v52, v53
    v_mul_f32 v54, v54, v29
    v_mul_f32 v55, v55, v29
    v_cvt_pk_bf16_f32 v35, v54, v55
    buffer_store_dwordx4 v[32:35], v26, s[4:7], s48 offen offset:0 sc1
    v_mul_f32 v56, v56, v29
    v_mul_f32 v57, v57, v29
    v_cvt_pk_bf16_f32 v36, v56, v57
    v_mul_f32 v58, v58, v29
    v_mul_f32 v59, v59, v29
    v_cvt_pk_bf16_f32 v37, v58, v59
    v_mul_f32 v60, v60, v29
    v_mul_f32 v61, v61, v29
    v_cvt_pk_bf16_f32 v38, v60, v61
    v_mul_f32 v62, v62, v29
    v_mul_f32 v63, v63, v29
    v_cvt_pk_bf16_f32 v39, v62, v63
    buffer_store_dwordx4 v[36:39], v26, s[4:7], s48 offen offset:1024 sc1
    v_mul_f32 v64, v64, v29
    v_mul_f32 v65, v65, v29
    v_cvt_pk_bf16_f32 v40, v64, v65
    v_mul_f32 v66, v66, v29
    v_mul_f32 v67, v67, v29
    v_cvt_pk_bf16_f32 v41, v66, v67
    v_mul_f32 v68, v68, v29
    v_mul_f32 v69, v69, v29
    v_cvt_pk_bf16_f32 v42, v68, v69
    v_mul_f32 v70, v70, v29
    v_mul_f32 v71, v71, v29
    v_cvt_pk_bf16_f32 v43, v70, v71
    buffer_store_dwordx4 v[40:43], v26, s[4:7], s48 offen offset:2048 sc1
    v_mul_f32 v72, v72, v29
    v_mul_f32 v73, v73, v29
    v_cvt_pk_bf16_f32 v44, v72, v73
    v_mul_f32 v74, v74, v29
    v_mul_f32 v75, v75, v29
    v_cvt_pk_bf16_f32 v45, v74, v75
    v_mul_f32 v76, v76, v29
    v_mul_f32 v77, v77, v29
    v_cvt_pk_bf16_f32 v46, v76, v77
    v_mul_f32 v78, v78, v29
    v_mul_f32 v79, v79, v29
    v_cvt_pk_bf16_f32 v47, v78, v79
    buffer_store_dwordx4 v[44:47], v26, s[4:7], s48 offen offset:3072 sc1
    s_nop 1
    s_branch L_lnd_9
L_lno_8:
    s_barrier
    v_mov_b32 v3, 0
    ds_read_b32 v2, v3
    s_waitcnt lgkmcnt(0)
L_lnd_9:
    v_readfirstlane_b32 s48, v2
    s_nop 1
    s_and_b32 s32, s48, 31
    s_bfe_u32 s34, s48, 0x30008
    s_cmp_ge_u32 s48, 0x10000
    s_cbranch_scc1 L_exit_1
    s_barrier
    s_cmp_lg_u32 s34, 0
    s_cbranch_scc1 L_tok_11
    v_mov_b32 v100, v0
    v_and_b32 v3, 15, v100
    v_bfe_u32 v2, v100, 4, 2
    s_lshl_b32 s63, s33, 11
    v_bfe_u32 v4, v3, 1, 1
    v_mul_u32_u24 v4, 0xaaaa, v4
    v_add_u32 v112, 0x4444, v4
    v_lshlrev_b32 v113, 4, v100
    s_mul_i32 s48, s33, 640
    v_lshrrev_b32 v4, 2, v3
    v_mul_u32_u24 v4, 160, v4
    v_lshl_add_u32 v4, v2, 4, v4
    v_and_b32 v5, 3, v3
    v_lshl_add_u32 v4, v5, 2, v4
    v_add_u32 v114, s48, v4
    v_mul_u32_u24 v6, 160, v2
    v_and_b32 v4, 1, v3
    v_bfe_u32 v5, v3, 1, 2
    v_lshl_add_u32 v4, v4, 2, v5
    v_lshl_add_u32 v115, v4, 4, v6
    v_and_b32 v4, 1, v3
    v_lshrrev_b32 v5, 2, v3
    v_and_b32 v7, 2, v3
    v_xor_b32 v5, v5, v7
    v_lshl_add_u32 v4, v4, 2, v5
    v_lshl_add_u32 v116, v4, 4, v6
    v_add_u32 v116, 2560, v116
    s_lshl_b32 s48, s33, 9
    s_add_u32 s48, s48, 7168
    v_lshrrev_b32 v4, 1, v2
    v_lshlrev_b32 v4, 8, v4
    v_lshrrev_b32 v5, 1, v3
    v_lshl_add_u32 v4, v5, 6, v4
    v_and_b32 v5, 1, v2
    v_lshl_add_u32 v4, v5, 5, v4
    v_and_b32 v5, 1, v3
    v_lshl_add_u32 v4, v5, 4, v4
    v_add_u32 v4, s48, v4
    v_add_u32 v5, 0, v113
    v_cmp_gt_u32 vcc, 8, v3
    s_nop 1
    v_cndmask_b32 v117, v5, v4, vcc
    s_lshl_b32 s48, s33, 14
    s_add_u32 s48, s48, 31744
    v_add_u32 v118, s48, v113
    v_add_u32 v119, 65792, v118
    v_add_u32 v124, s63, v113
    v_lshrrev_b32 v4, 3, v3
    v_lshl_add_u32 v4, v2, 1, v4
    v_mul_u32_u24 v4, 8448, v4
    v_and_b32 v5, 7, v3
    v_lshl_add_u32 v4, v5, 4, v4
    s_mul_i32 s48, s33, 67584
    s_lshl_b32 s49, s32, 8
    s_add_u32 s48, s48, s49
    v_add_u32 v120, s48, v4
    s_mul_i32 s48, s32, 8448
    s_add_u32 s43, s48, s63
    s_lshl_b32 s49, s33, 7
    s_add_u32 s48, s48, s49
    v_lshlrev_b32 v4, 8, v2
    v_lshl_add_u32 v4, v3, 3, v4
    v_add_u32 v121, s48, v4
    s_and_b32 s49, s32, 1
    s_lshl_b32 s49, s49, 10
    s_lshl_b32 s48, s33, 12
    s_add_u32 s48, s48, s49
    s_lshr_b32 s49, s32, 1
    s_lshl_b32 s49, s49, 6
    s_add_u32 s48, s48, s49
    v_lshrrev_b32 v4, 3, v3
    v_lshlrev_b32 v4, 5, v4
    v_and_b32 v5, 1, v3
    v_lshl_add_u32 v4, v5, 11, v4
    v_bfe_u32 v5, v3, 1, 2
    v_lshl_add_u32 v4, v5, 2, v4
    v_add_u32 v4, s48, v4
    v_mov_b32 v5, 0x7f000000
    v_cmp_gt_u32 vcc, 16, v100
    s_nop 1
    v_cndmask_b32 v122, v5, v4, vcc
    v_mov_b32 v4, 0x3f80
    v_mov_b32 v5, 0x3f800000
    v_and_b32 v6, 1, v3
    v_cmp_eq_u32 vcc, 1, v6
    s_nop 1
    v_cndmask_b32 v123, v4, v5, vcc
    v_lshrrev_b32 v6, 1, v3
    v_cmp_eq_u32 s[16:17], 0, v6
    v_cmp_eq_u32 s[18:19], 1, v6
    s_mov_b32 s52, 0x3e0293ee
    s_mov_b32 s53, 0x3e0293ee
    s_mov_b32 s54, 0x3f803f80
    s_mov_b32 s55, 0x3f803f80
    s_lshl_b32 s48, s32, 6
    s_lshl_b32 s49, s33, 2
    s_add_u32 s48, s48, s49
    s_add_u32 s82, s48, 0x3f83000
    v_mov_b32 v24, 0
    s_mov_b64 exec, 1
    buffer_store_dword v24, off, s[4:7], s82 sc1
    s_mov_b64 exec, -1
    s_mov_b32 s8, s28
    s_and_b32 s9, s29, 0xffff
    s_mov_b32 s10, 0x2000
    s_mov_b32 s11, 0x20000
    v_and_b32 v27, 15, v100
    s_bfe_u32 s48, s32, 0x20001
    s_lshl_b32 s48, s48, 11
    s_lshr_b32 s49, s32, 3
    s_lshl_b32 s49, s49, 8
    s_add_u32 s48, s48, s49
    s_and_b32 s49, s33, 1
    s_lshl_b32 s49, s49, 7
    s_add_u32 s48, s48, s49
    s_and_b32 s49, s32, 1
    s_lshl_b32 s49, s49, 4
    s_add_u32 s48, s48, s49
    v_and_b32 v36, 1, v27
    v_lshlrev_b32 v36, 6, v36
    v_lshrrev_b32 v37, 1, v27
    v_lshl_add_u32 v36, v37, 1, v36
    buffer_load_ushort v32, v36, s[8:11], s48 offen offset:0
    buffer_load_ushort v33, v36, s[8:11], s48 offen offset:32
    buffer_load_ushort v34, v36, s[8:11], s48 offen offset:1024
    buffer_load_ushort v35, v36, s[8:11], s48 offen offset:1056
    v_and_b32 v3, 15, v100
    v_bfe_u32 v2, v100, 4, 2
    v_lshrrev_b32 v6, 5, v100
    s_and_b32 s48, s33, 1
    s_lshl_b32 s48, s48, 1
    v_or_b32 v6, s48, v6
    v_lshlrev_b32 v6, 1, v6
    v_xor_b32 v6, v6, v3
    v_lshlrev_b32 v6, 4, v6
    v_lshlrev_b32 v7, 13, v2
    v_or_b32 v4, v6, v7
    v_xor_b32 v5, 0x80, v4
    v_lshrrev_b32 v6, 2, v3
    v_and_b32 v7, 3, v3
    v_and_b32 v8, 1, v6
    v_lshrrev_b32 v9, 1, v6
    v_and_b32 v10, 1, v2
    v_lshrrev_b32 v11, 1, v2
    v_lshlrev_b32 v12, 7, v11
    v_lshl_add_u32 v12, v10, 1, v12
    v_lshl_add_u32 v12, v8, 4, v12
    v_lshl_add_u32 v12, v9, 2, v12
    v_lshl_add_u32 v13, v9, 1, v10
    v_lshl_add_u32 v13, v8, 2, v13
    s_lshl_b32 s48, s33, 1
    v_xor_b32 v13, s48, v13
    v_lshlrev_b32 v14, 8, v12
    v_lshl_add_u32 v14, v13, 5, v14
    v_lshl_add_u32 v14, v7, 3, v14
    v_xor_b32 v15, 32, v14
    s_xor_b32 s48, s33, 0
    s_lshl_b32 s48, s48, 13
    s_add_u32 s49, s48, 31744
    v_add_u32 v64, s49, v14
    v_add_u32 v65, s49, v15
    s_add_u32 s49, s48, 97536
    v_add_u32 v66, s49, v14
    v_add_u32 v67, s49, v15
    s_xor_b32 s48, s33, 1
    s_lshl_b32 s48, s48, 13
    s_add_u32 s49, s48, 31744
    v_add_u32 v68, s49, v14
    v_add_u32 v69, s49, v15
    s_add_u32 s49, s48, 97536
    v_add_u32 v70, s49, v14
    v_add_u32 v71, s49, v15
    s_xor_b32 s48, s33, 2
    s_lshl_b32 s48, s48, 13
    s_add_u32 s49, s48, 31744
    v_add_u32 v72, s49, v14
    v_add_u32 v73, s49, v15
    s_add_u32 s49, s48, 97536
    v_add_u32 v74, s49, v14
    v_add_u32 v75, s49, v15
    s_xor_b32 s48, s33, 3
    s_lshl_b32 s48, s48, 13
    s_add_u32 s49, s48, 31744
    v_add_u32 v76, s49, v14
    v_add_u32 v77, s49, v15
    s_add_u32 s49, s48, 97536
    v_add_u32 v78, s49, v14
    v_add_u32 v79, s49, v15
    v_lshl_add_u32 v13, v9, 1, v8
    v_lshl_add_u32 v13, v10, 2, v13
    v_lshlrev_b32 v14, 13, v13
    v_lshl_add_u32 v14, v11, 11, v14
    v_lshl_add_u32 v14, v13, 5, v14
    v_lshl_add_u32 v14, v7, 3, v14
    s_lshl_b32 s48, s33, 8
    v_add_u32 v14, s48, v14
    v_add_u32 v20, 31744, v14
    v_add_u32 v21, 97536, v14
    s_mov_b32 s8, s20
    s_and_b32 s9, s21, 0xffff
    s_mov_b32 s10, 0x400000
    s_mov_b32 s11, 0x20000
    s_lshl_b32 s48, s33, 15
    s_lshl_b32 s49, s32, 8
    s_add_u32 s48, s48, s49
    s_add_u32 s48, s48, 0
    s_lshl_b32 s49, s33, 10
    s_add_u32 s49, s49, 31744
    s_mov_b32 m0, s49
    s_nop 0
    buffer_load_dwordx4 v4, s[8:11], s48 offen lds
    s_add_u32 s48, s48, 131072
    s_add_u32 s49, s49, 4096
    s_mov_b32 m0, s49
    s_nop 0
    buffer_load_dwordx4 v5, s[8:11], s48 offen lds
    s_add_u32 s48, s48, 131072
    s_add_u32 s49, s49, 4096
    s_mov_b32 m0, s49
    s_nop 0
    buffer_load_dwordx4 v4, s[8:11], s48 offen lds
    s_add_u32 s48, s48, 131072
    s_add_u32 s49, s49, 4096
    s_mov_b32 m0, s49
    s_nop 0
    buffer_load_dwordx4 v5, s[8:11], s48 offen lds
    s_add_u32 s48, s48, 131072
    s_add_u32 s49, s49, 4096
    s_mov_b32 m0, s49
    s_nop 0
    buffer_load_dwordx4 v4, s[8:11], s48 offen lds
    s_add_u32 s48, s48, 131072
    s_add_u32 s49, s49, 4096
    s_mov_b32 m0, s49
    s_nop 0
    buffer_load_dwordx4 v5, s[8:11], s48 offen lds
    s_add_u32 s48, s48, 131072
    s_add_u32 s49, s49, 4096
    s_mov_b32 m0, s49
    s_nop 0
    buffer_load_dwordx4 v4, s[8:11], s48 offen lds
    s_add_u32 s48, s48, 131072
    s_add_u32 s49, s49, 4096
    s_mov_b32 m0, s49
    s_nop 0
    buffer_load_dwordx4 v5, s[8:11], s48 offen lds
    s_add_u32 s48, s48, 131072
    s_add_u32 s49, s49, 4096
    s_mov_b32 m0, s49
    s_nop 0
    buffer_load_dwordx4 v4, s[8:11], s48 offen lds
    s_add_u32 s48, s48, 131072
    s_add_u32 s49, s49, 4096
    s_mov_b32 m0, s49
    s_nop 0
    buffer_load_dwordx4 v5, s[8:11], s48 offen lds
    s_add_u32 s48, s48, 131072
    s_add_u32 s49, s49, 4096
    s_mov_b32 m0, s49
    s_nop 0
    buffer_load_dwordx4 v4, s[8:11], s48 offen lds
    s_add_u32 s48, s48, 131072
    s_add_u32 s49, s49, 4096
    s_mov_b32 m0, s49
    s_nop 0
    buffer_load_dwordx4 v5, s[8:11], s48 offen lds
    s_add_u32 s48, s48, 131072
    s_add_u32 s49, s49, 4096
    s_mov_b32 m0, s49
    s_nop 0
    buffer_load_dwordx4 v4, s[8:11], s48 offen lds
    s_add_u32 s48, s48, 131072
    s_add_u32 s49, s49, 4096
    s_mov_b32 m0, s49
    s_nop 0
    buffer_load_dwordx4 v5, s[8:11], s48 offen lds
    s_add_u32 s48, s48, 131072
    s_add_u32 s49, s49, 4096
    s_mov_b32 m0, s49
    s_nop 0
    buffer_load_dwordx4 v4, s[8:11], s48 offen lds
    s_add_u32 s48, s48, 131072
    s_add_u32 s49, s49, 4096
    s_mov_b32 m0, s49
    s_nop 0
    buffer_load_dwordx4 v5, s[8:11], s48 offen lds
    s_mov_b32 s8, s20
    s_and_b32 s9, s21, 0xffff
    s_mov_b32 s10, 0x400000
    s_mov_b32 s11, 0x20000
    s_lshl_b32 s48, s33, 15
    s_lshl_b32 s49, s32, 8
    s_add_u32 s48, s48, s49
    s_add_u32 s48, s48, 2097152
    s_lshl_b32 s49, s33, 10
    s_add_u32 s49, s49, 97536
    s_mov_b32 m0, s49
    s_nop 0
    buffer_load_dwordx4 v4, s[8:11], s48 offen lds
    s_add_u32 s48, s48, 131072
    s_add_u32 s49, s49, 4096
    s_mov_b32 m0, s49
    s_nop 0
    buffer_load_dwordx4 v5, s[8:11], s48 offen lds
    s_add_u32 s48, s48, 131072
    s_add_u32 s49, s49, 4096
    s_mov_b32 m0, s49
    s_nop 0
    buffer_load_dwordx4 v4, s[8:11], s48 offen lds
    s_add_u32 s48, s48, 131072
    s_add_u32 s49, s49, 4096
    s_mov_b32 m0, s49
    s_nop 0
    buffer_load_dwordx4 v5, s[8:11], s48 offen lds
    s_add_u32 s48, s48, 131072
    s_add_u32 s49, s49, 4096
    s_mov_b32 m0, s49
    s_nop 0
    buffer_load_dwordx4 v4, s[8:11], s48 offen lds
    s_add_u32 s48, s48, 131072
    s_add_u32 s49, s49, 4096
    s_mov_b32 m0, s49
    s_nop 0
    buffer_load_dwordx4 v5, s[8:11], s48 offen lds
    s_add_u32 s48, s48, 131072
    s_add_u32 s49, s49, 4096
    s_mov_b32 m0, s49
    s_nop 0
    buffer_load_dwordx4 v4, s[8:11], s48 offen lds
    s_add_u32 s48, s48, 131072
    s_add_u32 s49, s49, 4096
    s_mov_b32 m0, s49
    s_nop 0
    buffer_load_dwordx4 v5, s[8:11], s48 offen lds
    s_add_u32 s48, s48, 131072
    s_add_u32 s49, s49, 4096
    s_mov_b32 m0, s49
    s_nop 0
    buffer_load_dwordx4 v4, s[8:11], s48 offen lds
    s_add_u32 s48, s48, 131072
    s_add_u32 s49, s49, 4096
    s_mov_b32 m0, s49
    s_nop 0
    buffer_load_dwordx4 v5, s[8:11], s48 offen lds
    s_add_u32 s48, s48, 131072
    s_add_u32 s49, s49, 4096
    s_mov_b32 m0, s49
    s_nop 0
    buffer_load_dwordx4 v4, s[8:11], s48 offen lds
    s_add_u32 s48, s48, 131072
    s_add_u32 s49, s49, 4096
    s_mov_b32 m0, s49
    s_nop 0
    buffer_load_dwordx4 v5, s[8:11], s48 offen lds
    s_add_u32 s48, s48, 131072
    s_add_u32 s49, s49, 4096
    s_mov_b32 m0, s49
    s_nop 0
    buffer_load_dwordx4 v4, s[8:11], s48 offen lds
    s_add_u32 s48, s48, 131072
    s_add_u32 s49, s49, 4096
    s_mov_b32 m0, s49
    s_nop 0
    buffer_load_dwordx4 v5, s[8:11], s48 offen lds
    s_add_u32 s48, s48, 131072
    s_add_u32 s49, s49, 4096
    s_mov_b32 m0, s49
    s_nop 0
    buffer_load_dwordx4 v4, s[8:11], s48 offen lds
    s_add_u32 s48, s48, 131072
    s_add_u32 s49, s49, 4096
    s_mov_b32 m0, s49
    s_nop 0
    buffer_load_dwordx4 v5, s[8:11], s48 offen lds
    v_mov_b32 v28, -1
    v_mov_b32 v29, -1
    v_mov_b32 v30, -1
    v_mov_b32 v31, -1
    s_add_u32 s48, s43, 0x3e00000
    buffer_store_dwordx4 v[28:31], v113, s[4:7], s48 offen offset:0 sc1
    buffer_store_dwordx4 v[28:31], v113, s[4:7], s48 offen offset:1024 sc1
    s_add_u32 s48, s43, 0x3e48000
    buffer_store_dwordx4 v[28:31], v113, s[4:7], s48 offen offset:0 sc1
    buffer_store_dwordx4 v[28:31], v113, s[4:7], s48 offen offset:1024 sc1
    s_add_u32 s48, s43, 0x3e90000
    buffer_store_dwordx4 v[28:31], v113, s[4:7], s48 offen offset:0 sc1
    buffer_store_dwordx4 v[28:31], v113, s[4:7], s48 offen offset:1024 sc1
    s_cmp_ge_u32 s33, 2
    s_nop 0
    s_cbranch_scc1 L_ie_13
    s_mov_b32 s48, 0x3f02000
    buffer_store_dword v28, v122, s[4:7], s48 offen sc1
    buffer_store_dword v28, v122, s[4:7], s48 offen offset:16 sc1
    s_waitcnt vmcnt(40)
    v_lshl_or_b32 v32, v33, 16, v32
    v_lshl_or_b32 v34, v35, 16, v34
    v_min_u32 v32, -2, v32
    v_min_u32 v34, -2, v34
    s_mov_b32 s48, 0x3f00000
    buffer_store_dword v32, v122, s[4:7], s48 offen sc1
    buffer_store_dword v34, v122, s[4:7], s48 offen offset:16 sc1
L_ie_13:
    s_waitcnt vmcnt(22)
    s_barrier
    s_cmp_lg_u32 s33, 0
    s_cbranch_scc1 L_na_14
    v_mov_b32 v23, 1
    s_mov_b64 exec, 1
    buffer_atomic_add v23, off, s[84:87], 0 offset:128
    s_mov_b64 exec, -1
L_na_14:
    ds_read_b64_tr_b16 a[0:1], v64 offset:0
    ds_read_b64_tr_b16 a[2:3], v64 offset:256
    ds_read_b64_tr_b16 a[8:9], v64 offset:2048
    ds_read_b64_tr_b16 a[10:11], v64 offset:2304
    ds_read_b64_tr_b16 a[16:17], v68 offset:0
    ds_read_b64_tr_b16 a[18:19], v68 offset:256
    ds_read_b64_tr_b16 a[24:25], v68 offset:2048
    ds_read_b64_tr_b16 a[26:27], v68 offset:2304
    ds_read_b64_tr_b16 a[32:33], v72 offset:0
    ds_read_b64_tr_b16 a[34:35], v72 offset:256
    ds_read_b64_tr_b16 a[40:41], v72 offset:2048
    ds_read_b64_tr_b16 a[42:43], v72 offset:2304
    s_waitcnt lgkmcnt(8)
    ds_read_b64_tr_b16 a[48:49], v76 offset:0
    ds_read_b64_tr_b16 a[50:51], v76 offset:256
    ds_read_b64_tr_b16 a[56:57], v76 offset:2048
    ds_read_b64_tr_b16 a[58:59], v76 offset:2304
    s_waitcnt lgkmcnt(8)
    ds_read_b64_tr_b16 a[64:65], v65 offset:0
    ds_read_b64_tr_b16 a[66:67], v65 offset:256
    ds_read_b64_tr_b16 a[72:73], v65 offset:2048
    ds_read_b64_tr_b16 a[74:75], v65 offset:2304
    s_waitcnt lgkmcnt(8)
    ds_read_b64_tr_b16 a[80:81], v69 offset:0
    ds_read_b64_tr_b16 a[82:83], v69 offset:256
    ds_read_b64_tr_b16 a[88:89], v69 offset:2048
    ds_read_b64_tr_b16 a[90:91], v69 offset:2304
    s_waitcnt lgkmcnt(8)
    ds_read_b64_tr_b16 a[96:97], v73 offset:0
    ds_read_b64_tr_b16 a[98:99], v73 offset:256
    ds_read_b64_tr_b16 a[104:105], v73 offset:2048
    ds_read_b64_tr_b16 a[106:107], v73 offset:2304
    s_waitcnt lgkmcnt(8)
    ds_read_b64_tr_b16 a[112:113], v77 offset:0
    ds_read_b64_tr_b16 a[114:115], v77 offset:256
    ds_read_b64_tr_b16 a[120:121], v77 offset:2048
    ds_read_b64_tr_b16 a[122:123], v77 offset:2304
    s_waitcnt lgkmcnt(0)
    s_barrier
    s_mov_b32 s8, s22
    s_and_b32 s9, s23, 0xffff
    s_mov_b32 s10, 0x400000
    s_mov_b32 s11, 0x20000
    s_lshl_b32 s48, s33, 15
    s_lshl_b32 s49, s32, 8
    s_add_u32 s48, s48, s49
    s_add_u32 s48, s48, 0
    s_lshl_b32 s49, s33, 10
    s_add_u32 s49, s49, 31744
    s_mov_b32 m0, s49
    s_nop 0
    buffer_load_dwordx4 v4, s[8:11], s48 offen lds
    s_add_u32 s48, s48, 131072
    s_add_u32 s49, s49, 4096
    s_mov_b32 m0, s49
    s_nop 0
    buffer_load_dwordx4 v5, s[8:11], s48 offen lds
    s_add_u32 s48, s48, 131072
    s_add_u32 s49, s49, 4096
    s_mov_b32 m0, s49
    s_nop 0
    buffer_load_dwordx4 v4, s[8:11], s48 offen lds
    s_add_u32 s48, s48, 131072
    s_add_u32 s49, s49, 4096
    s_mov_b32 m0, s49
    s_nop 0
    buffer_load_dwordx4 v5, s[8:11], s48 offen lds
    s_add_u32 s48, s48, 131072
    s_add_u32 s49, s49, 4096
    s_mov_b32 m0, s49
    s_nop 0
    buffer_load_dwordx4 v4, s[8:11], s48 offen lds
    s_add_u32 s48, s48, 131072
    s_add_u32 s49, s49, 4096
    s_mov_b32 m0, s49
    s_nop 0
    buffer_load_dwordx4 v5, s[8:11], s48 offen lds
    s_add_u32 s48, s48, 131072
    s_add_u32 s49, s49, 4096
    s_mov_b32 m0, s49
    s_nop 0
    buffer_load_dwordx4 v4, s[8:11], s48 offen lds
    s_add_u32 s48, s48, 131072
    s_add_u32 s49, s49, 4096
    s_mov_b32 m0, s49
    s_nop 0
    buffer_load_dwordx4 v5, s[8:11], s48 offen lds
    s_add_u32 s48, s48, 131072
    s_add_u32 s49, s49, 4096
    s_mov_b32 m0, s49
    s_nop 0
    buffer_load_dwordx4 v4, s[8:11], s48 offen lds
    s_add_u32 s48, s48, 131072
    s_add_u32 s49, s49, 4096
    s_mov_b32 m0, s49
    s_nop 0
    buffer_load_dwordx4 v5, s[8:11], s48 offen lds
    s_add_u32 s48, s48, 131072
    s_add_u32 s49, s49, 4096
    s_mov_b32 m0, s49
    s_nop 0
    buffer_load_dwordx4 v4, s[8:11], s48 offen lds
    s_add_u32 s48, s48, 131072
    s_add_u32 s49, s49, 4096
    s_mov_b32 m0, s49
    s_nop 0
    buffer_load_dwordx4 v5, s[8:11], s48 offen lds
    s_add_u32 s48, s48, 131072
    s_add_u32 s49, s49, 4096
    s_mov_b32 m0, s49
    s_nop 0
    buffer_load_dwordx4 v4, s[8:11], s48 offen lds
    s_add_u32 s48, s48, 131072
    s_add_u32 s49, s49, 4096
    s_mov_b32 m0, s49
    s_nop 0
    buffer_load_dwordx4 v5, s[8:11], s48 offen lds
    s_add_u32 s48, s48, 131072
    s_add_u32 s49, s49, 4096
    s_mov_b32 m0, s49
    s_nop 0
    buffer_load_dwordx4 v4, s[8:11], s48 offen lds
    s_add_u32 s48, s48, 131072
    s_add_u32 s49, s49, 4096
    s_mov_b32 m0, s49
    s_nop 0
    buffer_load_dwordx4 v5, s[8:11], s48 offen lds
    s_waitcnt vmcnt(16)
    s_barrier
    s_cmp_lg_u32 s33, 0
    s_cbranch_scc1 L_na_15
    v_mov_b32 v23, 1
    s_mov_b64 exec, 1
    buffer_atomic_add v23, off, s[84:87], 0 offset:196
    s_mov_b64 exec, -1
L_na_15:
    ds_read_b64_tr_b16 a[4:5], v66 offset:0
    ds_read_b64_tr_b16 a[6:7], v66 offset:256
    ds_read_b64_tr_b16 a[12:13], v66 offset:2048
    ds_read_b64_tr_b16 a[14:15], v66 offset:2304
    ds_read_b64_tr_b16 a[20:21], v70 offset:0
    ds_read_b64_tr_b16 a[22:23], v70 offset:256
    ds_read_b64_tr_b16 a[28:29], v70 offset:2048
    ds_read_b64_tr_b16 a[30:31], v70 offset:2304
    ds_read_b64_tr_b16 a[36:37], v74 offset:0
    ds_read_b64_tr_b16 a[38:39], v74 offset:256
    ds_read_b64_tr_b16 a[44:45], v74 offset:2048
    ds_read_b64_tr_b16 a[46:47], v74 offset:2304
    s_waitcnt lgkmcnt(8)
    ds_read_b64_tr_b16 a[52:53], v78 offset:0
    ds_read_b64_tr_b16 a[54:55], v78 offset:256
    ds_read_b64_tr_b16 a[60:61], v78 offset:2048
    ds_read_b64_tr_b16 a[62:63], v78 offset:2304
    s_waitcnt lgkmcnt(8)
    ds_read_b64_tr_b16 a[68:69], v67 offset:0
    ds_read_b64_tr_b16 a[70:71], v67 offset:256
    ds_read_b64_tr_b16 a[76:77], v67 offset:2048
    ds_read_b64_tr_b16 a[78:79], v67 offset:2304
    s_waitcnt lgkmcnt(8)
    ds_read_b64_tr_b16 a[84:85], v71 offset:0
    ds_read_b64_tr_b16 a[86:87], v71 offset:256
    ds_read_b64_tr_b16 a[92:93], v71 offset:2048
    ds_read_b64_tr_b16 a[94:95], v71 offset:2304
    s_waitcnt lgkmcnt(8)
    ds_read_b64_tr_b16 a[100:101], v75 offset:0
    ds_read_b64_tr_b16 a[102:103], v75 offset:256
    ds_read_b64_tr_b16 a[108:109], v75 offset:2048
    ds_read_b64_tr_b16 a[110:111], v75 offset:2304
    s_waitcnt lgkmcnt(8)
    ds_read_b64_tr_b16 a[116:117], v79 offset:0
    ds_read_b64_tr_b16 a[118:119], v79 offset:256
    ds_read_b64_tr_b16 a[124:125], v79 offset:2048
    ds_read_b64_tr_b16 a[126:127], v79 offset:2304
    s_waitcnt lgkmcnt(0)
    s_barrier
    s_mov_b32 s8, s22
    s_and_b32 s9, s23, 0xffff
    s_mov_b32 s10, 0x400000
    s_mov_b32 s11, 0x20000
    s_lshl_b32 s48, s33, 15
    s_lshl_b32 s49, s32, 8
    s_add_u32 s48, s48, s49
    s_add_u32 s48, s48, 2097152
    s_lshl_b32 s49, s33, 10
    s_add_u32 s49, s49, 97536
    s_mov_b32 m0, s49
    s_nop 0
    buffer_load_dwordx4 v4, s[8:11], s48 offen lds
    s_add_u32 s48, s48, 131072
    s_add_u32 s49, s49, 4096
    s_mov_b32 m0, s49
    s_nop 0
    buffer_load_dwordx4 v5, s[8:11], s48 offen lds
    s_add_u32 s48, s48, 131072
    s_add_u32 s49, s49, 4096
    s_mov_b32 m0, s49
    s_nop 0
    buffer_load_dwordx4 v4, s[8:11], s48 offen lds
    s_add_u32 s48, s48, 131072
    s_add_u32 s49, s49, 4096
    s_mov_b32 m0, s49
    s_nop 0
    buffer_load_dwordx4 v5, s[8:11], s48 offen lds
    s_add_u32 s48, s48, 131072
    s_add_u32 s49, s49, 4096
    s_mov_b32 m0, s49
    s_nop 0
    buffer_load_dwordx4 v4, s[8:11], s48 offen lds
    s_add_u32 s48, s48, 131072
    s_add_u32 s49, s49, 4096
    s_mov_b32 m0, s49
    s_nop 0
    buffer_load_dwordx4 v5, s[8:11], s48 offen lds
    s_add_u32 s48, s48, 131072
    s_add_u32 s49, s49, 4096
    s_mov_b32 m0, s49
    s_nop 0
    buffer_load_dwordx4 v4, s[8:11], s48 offen lds
    s_add_u32 s48, s48, 131072
    s_add_u32 s49, s49, 4096
    s_mov_b32 m0, s49
    s_nop 0
    buffer_load_dwordx4 v5, s[8:11], s48 offen lds
    s_add_u32 s48, s48, 131072
    s_add_u32 s49, s49, 4096
    s_mov_b32 m0, s49
    s_nop 0
    buffer_load_dwordx4 v4, s[8:11], s48 offen lds
    s_add_u32 s48, s48, 131072
    s_add_u32 s49, s49, 4096
    s_mov_b32 m0, s49
    s_nop 0
    buffer_load_dwordx4 v5, s[8:11], s48 offen lds
    s_add_u32 s48, s48, 131072
    s_add_u32 s49, s49, 4096
    s_mov_b32 m0, s49
    s_nop 0
    buffer_load_dwordx4 v4, s[8:11], s48 offen lds
    s_add_u32 s48, s48, 131072
    s_add_u32 s49, s49, 4096
    s_mov_b32 m0, s49
    s_nop 0
    buffer_load_dwordx4 v5, s[8:11], s48 offen lds
    s_add_u32 s48, s48, 131072
    s_add_u32 s49, s49, 4096
    s_mov_b32 m0, s49
    s_nop 0
    buffer_load_dwordx4 v4, s[8:11], s48 offen lds
    s_add_u32 s48, s48, 131072
    s_add_u32 s49, s49, 4096
    s_mov_b32 m0, s49
    s_nop 0
    buffer_load_dwordx4 v5, s[8:11], s48 offen lds
    s_add_u32 s48, s48, 131072
    s_add_u32 s49, s49, 4096
    s_mov_b32 m0, s49
    s_nop 0
    buffer_load_dwordx4 v4, s[8:11], s48 offen lds
    s_add_u32 s48, s48, 131072
    s_add_u32 s49, s49, 4096
    s_mov_b32 m0, s49
    s_nop 0
    buffer_load_dwordx4 v5, s[8:11], s48 offen lds
    s_waitcnt vmcnt(16)
    s_barrier
    ds_read_b64_tr_b16 a[128:129], v64 offset:0
    ds_read_b64_tr_b16 a[130:131], v64 offset:256
    ds_read_b64_tr_b16 a[136:137], v64 offset:2048
    ds_read_b64_tr_b16 a[138:139], v64 offset:2304
    ds_read_b64_tr_b16 a[144:145], v68 offset:0
    ds_read_b64_tr_b16 a[146:147], v68 offset:256
    ds_read_b64_tr_b16 a[152:153], v68 offset:2048
    ds_read_b64_tr_b16 a[154:155], v68 offset:2304
    ds_read_b64_tr_b16 a[160:161], v72 offset:0
    ds_read_b64_tr_b16 a[162:163], v72 offset:256
    ds_read_b64_tr_b16 a[168:169], v72 offset:2048
    ds_read_b64_tr_b16 a[170:171], v72 offset:2304
    s_waitcnt lgkmcnt(8)
    ds_read_b64_tr_b16 a[176:177], v76 offset:0
    ds_read_b64_tr_b16 a[178:179], v76 offset:256
    ds_read_b64_tr_b16 a[184:185], v76 offset:2048
    ds_read_b64_tr_b16 a[186:187], v76 offset:2304
    s_waitcnt lgkmcnt(8)
    ds_read_b64_tr_b16 a[192:193], v65 offset:0
    ds_read_b64_tr_b16 a[194:195], v65 offset:256
    ds_read_b64_tr_b16 a[200:201], v65 offset:2048
    ds_read_b64_tr_b16 a[202:203], v65 offset:2304
    s_waitcnt lgkmcnt(8)
    ds_read_b64_tr_b16 a[208:209], v69 offset:0
    ds_read_b64_tr_b16 a[210:211], v69 offset:256
    ds_read_b64_tr_b16 a[216:217], v69 offset:2048
    ds_read_b64_tr_b16 a[218:219], v69 offset:2304
    s_waitcnt lgkmcnt(8)
    ds_read_b64_tr_b16 a[224:225], v73 offset:0
    ds_read_b64_tr_b16 a[226:227], v73 offset:256
    ds_read_b64_tr_b16 a[232:233], v73 offset:2048
    ds_read_b64_tr_b16 a[234:235], v73 offset:2304
    s_waitcnt lgkmcnt(8)
    ds_read_b64_tr_b16 a[240:241], v77 offset:0
    ds_read_b64_tr_b16 a[242:243], v77 offset:256
    ds_read_b64_tr_b16 a[248:249], v77 offset:2048
    ds_read_b64_tr_b16 a[250:251], v77 offset:2304
    s_waitcnt lgkmcnt(0)
    s_barrier
    s_mov_b32 s8, s24
    s_and_b32 s9, s25, 0xffff
    s_mov_b32 s10, 0x400000
    s_mov_b32 s11, 0x20000
    s_lshl_b32 s48, s33, 15
    s_lshl_b32 s49, s32, 8
    s_add_u32 s48, s48, s49
    s_add_u32 s48, s48, 0
    s_lshl_b32 s49, s33, 10
    s_add_u32 s49, s49, 31744
    s_mov_b32 m0, s49
    s_nop 0
    buffer_load_dwordx4 v4, s[8:11], s48 offen lds
    s_add_u32 s48, s48, 131072
    s_add_u32 s49, s49, 4096
    s_mov_b32 m0, s49
    s_nop 0
    buffer_load_dwordx4 v5, s[8:11], s48 offen lds
    s_add_u32 s48, s48, 131072
    s_add_u32 s49, s49, 4096
    s_mov_b32 m0, s49
    s_nop 0
    buffer_load_dwordx4 v4, s[8:11], s48 offen lds
    s_add_u32 s48, s48, 131072
    s_add_u32 s49, s49, 4096
    s_mov_b32 m0, s49
    s_nop 0
    buffer_load_dwordx4 v5, s[8:11], s48 offen lds
    s_add_u32 s48, s48, 131072
    s_add_u32 s49, s49, 4096
    s_mov_b32 m0, s49
    s_nop 0
    buffer_load_dwordx4 v4, s[8:11], s48 offen lds
    s_add_u32 s48, s48, 131072
    s_add_u32 s49, s49, 4096
    s_mov_b32 m0, s49
    s_nop 0
    buffer_load_dwordx4 v5, s[8:11], s48 offen lds
    s_add_u32 s48, s48, 131072
    s_add_u32 s49, s49, 4096
    s_mov_b32 m0, s49
    s_nop 0
    buffer_load_dwordx4 v4, s[8:11], s48 offen lds
    s_add_u32 s48, s48, 131072
    s_add_u32 s49, s49, 4096
    s_mov_b32 m0, s49
    s_nop 0
    buffer_load_dwordx4 v5, s[8:11], s48 offen lds
    s_add_u32 s48, s48, 131072
    s_add_u32 s49, s49, 4096
    s_mov_b32 m0, s49
    s_nop 0
    buffer_load_dwordx4 v4, s[8:11], s48 offen lds
    s_add_u32 s48, s48, 131072
    s_add_u32 s49, s49, 4096
    s_mov_b32 m0, s49
    s_nop 0
    buffer_load_dwordx4 v5, s[8:11], s48 offen lds
    s_add_u32 s48, s48, 131072
    s_add_u32 s49, s49, 4096
    s_mov_b32 m0, s49
    s_nop 0
    buffer_load_dwordx4 v4, s[8:11], s48 offen lds
    s_add_u32 s48, s48, 131072
    s_add_u32 s49, s49, 4096
    s_mov_b32 m0, s49
    s_nop 0
    buffer_load_dwordx4 v5, s[8:11], s48 offen lds
    s_add_u32 s48, s48, 131072
    s_add_u32 s49, s49, 4096
    s_mov_b32 m0, s49
    s_nop 0
    buffer_load_dwordx4 v4, s[8:11], s48 offen lds
    s_add_u32 s48, s48, 131072
    s_add_u32 s49, s49, 4096
    s_mov_b32 m0, s49
    s_nop 0
    buffer_load_dwordx4 v5, s[8:11], s48 offen lds
    s_add_u32 s48, s48, 131072
    s_add_u32 s49, s49, 4096
    s_mov_b32 m0, s49
    s_nop 0
    buffer_load_dwordx4 v4, s[8:11], s48 offen lds
    s_add_u32 s48, s48, 131072
    s_add_u32 s49, s49, 4096
    s_mov_b32 m0, s49
    s_nop 0
    buffer_load_dwordx4 v5, s[8:11], s48 offen lds
    s_waitcnt vmcnt(16)
    s_barrier
    ds_read_b64_tr_b16 a[132:133], v66 offset:0
    ds_read_b64_tr_b16 a[134:135], v66 offset:256
    ds_read_b64_tr_b16 a[140:141], v66 offset:2048
    ds_read_b64_tr_b16 a[142:143], v66 offset:2304
    ds_read_b64_tr_b16 a[148:149], v70 offset:0
    ds_read_b64_tr_b16 a[150:151], v70 offset:256
    ds_read_b64_tr_b16 a[156:157], v70 offset:2048
    ds_read_b64_tr_b16 a[158:159], v70 offset:2304
    ds_read_b64_tr_b16 a[164:165], v74 offset:0
    ds_read_b64_tr_b16 a[166:167], v74 offset:256
    ds_read_b64_tr_b16 a[172:173], v74 offset:2048
    ds_read_b64_tr_b16 a[174:175], v74 offset:2304
    s_waitcnt lgkmcnt(8)
    ds_read_b64_tr_b16 a[180:181], v78 offset:0
    ds_read_b64_tr_b16 a[182:183], v78 offset:256
    ds_read_b64_tr_b16 a[188:189], v78 offset:2048
    ds_read_b64_tr_b16 a[190:191], v78 offset:2304
    s_waitcnt lgkmcnt(8)
    ds_read_b64_tr_b16 a[196:197], v67 offset:0
    ds_read_b64_tr_b16 a[198:199], v67 offset:256
    ds_read_b64_tr_b16 a[204:205], v67 offset:2048
    ds_read_b64_tr_b16 a[206:207], v67 offset:2304
    s_waitcnt lgkmcnt(8)
    ds_read_b64_tr_b16 a[212:213], v71 offset:0
    ds_read_b64_tr_b16 a[214:215], v71 offset:256
    ds_read_b64_tr_b16 a[220:221], v71 offset:2048
    ds_read_b64_tr_b16 a[222:223], v71 offset:2304
    s_waitcnt lgkmcnt(8)
    ds_read_b64_tr_b16 a[228:229], v75 offset:0
    ds_read_b64_tr_b16 a[230:231], v75 offset:256
    ds_read_b64_tr_b16 a[236:237], v75 offset:2048
    ds_read_b64_tr_b16 a[238:239], v75 offset:2304
    s_waitcnt lgkmcnt(8)
    ds_read_b64_tr_b16 a[244:245], v79 offset:0
    ds_read_b64_tr_b16 a[246:247], v79 offset:256
    ds_read_b64_tr_b16 a[252:253], v79 offset:2048
    ds_read_b64_tr_b16 a[254:255], v79 offset:2304
    s_waitcnt lgkmcnt(0)
    s_barrier
    s_mov_b32 s8, s24
    s_and_b32 s9, s25, 0xffff
    s_mov_b32 s10, 0x400000
    s_mov_b32 s11, 0x20000
    s_lshl_b32 s48, s33, 15
    s_lshl_b32 s49, s32, 8
    s_add_u32 s48, s48, s49
    s_add_u32 s48, s48, 2097152
    s_lshl_b32 s49, s33, 10
    s_add_u32 s49, s49, 97536
    s_mov_b32 m0, s49
    s_nop 0
    buffer_load_dwordx4 v4, s[8:11], s48 offen lds
    s_add_u32 s48, s48, 131072
    s_add_u32 s49, s49, 4096
    s_mov_b32 m0, s49
    s_nop 0
    buffer_load_dwordx4 v5, s[8:11], s48 offen lds
    s_add_u32 s48, s48, 131072
    s_add_u32 s49, s49, 4096
    s_mov_b32 m0, s49
    s_nop 0
    buffer_load_dwordx4 v4, s[8:11], s48 offen lds
    s_add_u32 s48, s48, 131072
    s_add_u32 s49, s49, 4096
    s_mov_b32 m0, s49
    s_nop 0
    buffer_load_dwordx4 v5, s[8:11], s48 offen lds
    s_add_u32 s48, s48, 131072
    s_add_u32 s49, s49, 4096
    s_mov_b32 m0, s49
    s_nop 0
    buffer_load_dwordx4 v4, s[8:11], s48 offen lds
    s_add_u32 s48, s48, 131072
    s_add_u32 s49, s49, 4096
    s_mov_b32 m0, s49
    s_nop 0
    buffer_load_dwordx4 v5, s[8:11], s48 offen lds
    s_add_u32 s48, s48, 131072
    s_add_u32 s49, s49, 4096
    s_mov_b32 m0, s49
    s_nop 0
    buffer_load_dwordx4 v4, s[8:11], s48 offen lds
    s_add_u32 s48, s48, 131072
    s_add_u32 s49, s49, 4096
    s_mov_b32 m0, s49
    s_nop 0
    buffer_load_dwordx4 v5, s[8:11], s48 offen lds
    s_add_u32 s48, s48, 131072
    s_add_u32 s49, s49, 4096
    s_mov_b32 m0, s49
    s_nop 0
    buffer_load_dwordx4 v4, s[8:11], s48 offen lds
    s_add_u32 s48, s48, 131072
    s_add_u32 s49, s49, 4096
    s_mov_b32 m0, s49
    s_nop 0
    buffer_load_dwordx4 v5, s[8:11], s48 offen lds
    s_add_u32 s48, s48, 131072
    s_add_u32 s49, s49, 4096
    s_mov_b32 m0, s49
    s_nop 0
    buffer_load_dwordx4 v4, s[8:11], s48 offen lds
    s_add_u32 s48, s48, 131072
    s_add_u32 s49, s49, 4096
    s_mov_b32 m0, s49
    s_nop 0
    buffer_load_dwordx4 v5, s[8:11], s48 offen lds
    s_add_u32 s48, s48, 131072
    s_add_u32 s49, s49, 4096
    s_mov_b32 m0, s49
    s_nop 0
    buffer_load_dwordx4 v4, s[8:11], s48 offen lds
    s_add_u32 s48, s48, 131072
    s_add_u32 s49, s49, 4096
    s_mov_b32 m0, s49
    s_nop 0
    buffer_load_dwordx4 v5, s[8:11], s48 offen lds
    s_add_u32 s48, s48, 131072
    s_add_u32 s49, s49, 4096
    s_mov_b32 m0, s49
    s_nop 0
    buffer_load_dwordx4 v4, s[8:11], s48 offen lds
    s_add_u32 s48, s48, 131072
    s_add_u32 s49, s49, 4096
    s_mov_b32 m0, s49
    s_nop 0
    buffer_load_dwordx4 v5, s[8:11], s48 offen lds
    buffer_load_dword v24, off, s[84:87], 0 offset:128 sc1
    s_waitcnt vmcnt(17)
    s_barrier
    ds_read_b64_tr_b16 v[128:129], v64 offset:0
    ds_read_b64_tr_b16 v[130:131], v64 offset:256
    ds_read_b64_tr_b16 v[136:137], v64 offset:2048
    ds_read_b64_tr_b16 v[138:139], v64 offset:2304
    ds_read_b64_tr_b16 v[144:145], v68 offset:0
    ds_read_b64_tr_b16 v[146:147], v68 offset:256
    ds_read_b64_tr_b16 v[152:153], v68 offset:2048
    ds_read_b64_tr_b16 v[154:155], v68 offset:2304
    ds_read_b64_tr_b16 v[160:161], v72 offset:0
    ds_read_b64_tr_b16 v[162:163], v72 offset:256
    ds_read_b64_tr_b16 v[168:169], v72 offset:2048
    ds_read_b64_tr_b16 v[170:171], v72 offset:2304
    s_waitcnt lgkmcnt(8)
    ds_read_b64_tr_b16 v[176:177], v76 offset:0
    ds_read_b64_tr_b16 v[178:179], v76 offset:256
    ds_read_b64_tr_b16 v[184:185], v76 offset:2048
    ds_read_b64_tr_b16 v[186:187], v76 offset:2304
    s_waitcnt lgkmcnt(8)
    ds_read_b64_tr_b16 v[192:193], v65 offset:0
    ds_read_b64_tr_b16 v[194:195], v65 offset:256
    ds_read_b64_tr_b16 v[200:201], v65 offset:2048
    ds_read_b64_tr_b16 v[202:203], v65 offset:2304
    s_waitcnt lgkmcnt(8)
    ds_read_b64_tr_b16 v[208:209], v69 offset:0
    ds_read_b64_tr_b16 v[210:211], v69 offset:256
    ds_read_b64_tr_b16 v[216:217], v69 offset:2048
    ds_read_b64_tr_b16 v[218:219], v69 offset:2304
    s_waitcnt lgkmcnt(8)
    ds_read_b64_tr_b16 v[224:225], v73 offset:0
    ds_read_b64_tr_b16 v[226:227], v73 offset:256
    ds_read_b64_tr_b16 v[232:233], v73 offset:2048
    ds_read_b64_tr_b16 v[234:235], v73 offset:2304
    s_waitcnt lgkmcnt(8)
    ds_read_b64_tr_b16 v[240:241], v77 offset:0
    ds_read_b64_tr_b16 v[242:243], v77 offset:256
    ds_read_b64_tr_b16 v[248:249], v77 offset:2048
    ds_read_b64_tr_b16 v[250:251], v77 offset:2304
    s_waitcnt lgkmcnt(0)
    s_barrier
    s_mov_b32 s8, s26
    s_and_b32 s9, s27, 0xffff
    s_mov_b32 s10, 0x400000
    s_mov_b32 s11, 0x20000
    s_and_b32 s48, s33, 1
    s_lshl_b32 s48, s48, 13
    s_lshr_b32 s49, s33, 1
    s_lshl_b32 s49, s49, 15
    s_add_u32 s48, s48, s49
    s_lshl_b32 s49, s32, 17
    s_add_u32 s48, s48, s49
    s_add_u32 s48, s48, 0
    s_lshl_b32 s49, s33, 11
    s_add_u32 s49, s49, 31744
    s_add_u32 s50, s49, 0
    s_add_u32 s51, s48, 0
    s_mov_b32 m0, s50
    s_nop 0
    buffer_load_dwordx4 v113, s[8:11], s51 offen lds
    s_add_u32 s50, s49, 1024
    s_add_u32 s51, s48, 2048
    s_mov_b32 m0, s50
    s_nop 0
    buffer_load_dwordx4 v113, s[8:11], s51 offen lds
    s_add_u32 s50, s49, 8224
    s_add_u32 s51, s48, 1024
    s_mov_b32 m0, s50
    s_nop 0
    buffer_load_dwordx4 v113, s[8:11], s51 offen lds
    s_add_u32 s50, s49, 9248
    s_add_u32 s51, s48, 3072
    s_mov_b32 m0, s50
    s_nop 0
    buffer_load_dwordx4 v113, s[8:11], s51 offen lds
    s_add_u32 s50, s49, 16448
    s_add_u32 s51, s48, 4096
    s_mov_b32 m0, s50
    s_nop 0
    buffer_load_dwordx4 v113, s[8:11], s51 offen lds
    s_add_u32 s50, s49, 17472
    s_add_u32 s51, s48, 6144
    s_mov_b32 m0, s50
    s_nop 0
    buffer_load_dwordx4 v113, s[8:11], s51 offen lds
    s_add_u32 s50, s49, 24672
    s_add_u32 s51, s48, 5120
    s_mov_b32 m0, s50
    s_nop 0
    buffer_load_dwordx4 v113, s[8:11], s51 offen lds
    s_add_u32 s50, s49, 25696
    s_add_u32 s51, s48, 7168
    s_mov_b32 m0, s50
    s_nop 0
    buffer_load_dwordx4 v113, s[8:11], s51 offen lds
    s_add_u32 s50, s49, 32896
    s_add_u32 s51, s48, 16384
    s_mov_b32 m0, s50
    s_nop 0
    buffer_load_dwordx4 v113, s[8:11], s51 offen lds
    s_add_u32 s50, s49, 33920
    s_add_u32 s51, s48, 18432
    s_mov_b32 m0, s50
    s_nop 0
    buffer_load_dwordx4 v113, s[8:11], s51 offen lds
    s_add_u32 s50, s49, 41120
    s_add_u32 s51, s48, 17408
    s_mov_b32 m0, s50
    s_nop 0
    buffer_load_dwordx4 v113, s[8:11], s51 offen lds
    s_add_u32 s50, s49, 42144
    s_add_u32 s51, s48, 19456
    s_mov_b32 m0, s50
    s_nop 0
    buffer_load_dwordx4 v113, s[8:11], s51 offen lds
    s_add_u32 s50, s49, 49344
    s_add_u32 s51, s48, 20480
    s_mov_b32 m0, s50
    s_nop 0
    buffer_load_dwordx4 v113, s[8:11], s51 offen lds
    s_add_u32 s50, s49, 50368
    s_add_u32 s51, s48, 22528
    s_mov_b32 m0, s50
    s_nop 0
    buffer_load_dwordx4 v113, s[8:11], s51 offen lds
    s_add_u32 s50, s49, 57568
    s_add_u32 s51, s48, 21504
    s_mov_b32 m0, s50
    s_nop 0
    buffer_load_dwordx4 v113, s[8:11], s51 offen lds
    s_add_u32 s50, s49, 58592
    s_add_u32 s51, s48, 23552
    s_mov_b32 m0, s50
    s_nop 0
    buffer_load_dwordx4 v113, s[8:11], s51 offen lds
    s_waitcnt vmcnt(16)
    s_barrier
    ds_read_b64_tr_b16 v[132:133], v66 offset:0
    ds_read_b64_tr_b16 v[134:135], v66 offset:256
    ds_read_b64_tr_b16 v[140:141], v66 offset:2048
    ds_read_b64_tr_b16 v[142:143], v66 offset:2304
    ds_read_b64_tr_b16 v[148:149], v70 offset:0
    ds_read_b64_tr_b16 v[150:151], v70 offset:256
    ds_read_b64_tr_b16 v[156:157], v70 offset:2048
    ds_read_b64_tr_b16 v[158:159], v70 offset:2304
    ds_read_b64_tr_b16 v[164:165], v74 offset:0
    ds_read_b64_tr_b16 v[166:167], v74 offset:256
    ds_read_b64_tr_b16 v[172:173], v74 offset:2048
    ds_read_b64_tr_b16 v[174:175], v74 offset:2304
    s_waitcnt lgkmcnt(8)
    ds_read_b64_tr_b16 v[180:181], v78 offset:0
    ds_read_b64_tr_b16 v[182:183], v78 offset:256
    ds_read_b64_tr_b16 v[188:189], v78 offset:2048
    ds_read_b64_tr_b16 v[190:191], v78 offset:2304
    s_waitcnt lgkmcnt(8)
    ds_read_b64_tr_b16 v[196:197], v67 offset:0
    ds_read_b64_tr_b16 v[198:199], v67 offset:256
    ds_read_b64_tr_b16 v[204:205], v67 offset:2048
    ds_read_b64_tr_b16 v[206:207], v67 offset:2304
    s_waitcnt lgkmcnt(8)
    ds_read_b64_tr_b16 v[212:213], v71 offset:0
    ds_read_b64_tr_b16 v[214:215], v71 offset:256
    ds_read_b64_tr_b16 v[220:221], v71 offset:2048
    ds_read_b64_tr_b16 v[222:223], v71 offset:2304
    s_waitcnt lgkmcnt(8)
    ds_read_b64_tr_b16 v[228:229], v75 offset:0
    ds_read_b64_tr_b16 v[230:231], v75 offset:256
    ds_read_b64_tr_b16 v[236:237], v75 offset:2048
    ds_read_b64_tr_b16 v[238:239], v75 offset:2304
    s_waitcnt lgkmcnt(8)
    ds_read_b64_tr_b16 v[244:245], v79 offset:0
    ds_read_b64_tr_b16 v[246:247], v79 offset:256
    ds_read_b64_tr_b16 v[252:253], v79 offset:2048
    ds_read_b64_tr_b16 v[254:255], v79 offset:2304
    s_waitcnt lgkmcnt(0)
    s_barrier
    s_mov_b32 s8, s26
    s_and_b32 s9, s27, 0xffff
    s_mov_b32 s10, 0x400000
    s_mov_b32 s11, 0x20000
    s_and_b32 s48, s33, 1
    s_lshl_b32 s48, s48, 13
    s_lshr_b32 s49, s33, 1
    s_lshl_b32 s49, s49, 15
    s_add_u32 s48, s48, s49
    s_lshl_b32 s49, s32, 17
    s_add_u32 s48, s48, s49
    s_add_u32 s48, s48, 65536
    s_lshl_b32 s49, s33, 11
    s_add_u32 s49, s49, 97536
    s_add_u32 s50, s49, 0
    s_add_u32 s51, s48, 0
    s_mov_b32 m0, s50
    s_nop 0
    buffer_load_dwordx4 v113, s[8:11], s51 offen lds
    s_add_u32 s50, s49, 1024
    s_add_u32 s51, s48, 2048
    s_mov_b32 m0, s50
    s_nop 0
    buffer_load_dwordx4 v113, s[8:11], s51 offen lds
    s_add_u32 s50, s49, 8224
    s_add_u32 s51, s48, 1024
    s_mov_b32 m0, s50
    s_nop 0
    buffer_load_dwordx4 v113, s[8:11], s51 offen lds
    s_add_u32 s50, s49, 9248
    s_add_u32 s51, s48, 3072
    s_mov_b32 m0, s50
    s_nop 0
    buffer_load_dwordx4 v113, s[8:11], s51 offen lds
    s_add_u32 s50, s49, 16448
    s_add_u32 s51, s48, 4096
    s_mov_b32 m0, s50
    s_nop 0
    buffer_load_dwordx4 v113, s[8:11], s51 offen lds
    s_add_u32 s50, s49, 17472
    s_add_u32 s51, s48, 6144
    s_mov_b32 m0, s50
    s_nop 0
    buffer_load_dwordx4 v113, s[8:11], s51 offen lds
    s_add_u32 s50, s49, 24672
    s_add_u32 s51, s48, 5120
    s_mov_b32 m0, s50
    s_nop 0
    buffer_load_dwordx4 v113, s[8:11], s51 offen lds
    s_add_u32 s50, s49, 25696
    s_add_u32 s51, s48, 7168
    s_mov_b32 m0, s50
    s_nop 0
    buffer_load_dwordx4 v113, s[8:11], s51 offen lds
    s_add_u32 s50, s49, 32896
    s_add_u32 s51, s48, 16384
    s_mov_b32 m0, s50
    s_nop 0
    buffer_load_dwordx4 v113, s[8:11], s51 offen lds
    s_add_u32 s50, s49, 33920
    s_add_u32 s51, s48, 18432
    s_mov_b32 m0, s50
    s_nop 0
    buffer_load_dwordx4 v113, s[8:11], s51 offen lds
    s_add_u32 s50, s49, 41120
    s_add_u32 s51, s48, 17408
    s_mov_b32 m0, s50
    s_nop 0
    buffer_load_dwordx4 v113, s[8:11], s51 offen lds
    s_add_u32 s50, s49, 42144
    s_add_u32 s51, s48, 19456
    s_mov_b32 m0, s50
    s_nop 0
    buffer_load_dwordx4 v113, s[8:11], s51 offen lds
    s_add_u32 s50, s49, 49344
    s_add_u32 s51, s48, 20480
    s_mov_b32 m0, s50
    s_nop 0
    buffer_load_dwordx4 v113, s[8:11], s51 offen lds
    s_add_u32 s50, s49, 50368
    s_add_u32 s51, s48, 22528
    s_mov_b32 m0, s50
    s_nop 0
    buffer_load_dwordx4 v113, s[8:11], s51 offen lds
    s_add_u32 s50, s49, 57568
    s_add_u32 s51, s48, 21504
    s_mov_b32 m0, s50
    s_nop 0
    buffer_load_dwordx4 v113, s[8:11], s51 offen lds
    s_add_u32 s50, s49, 58592
    s_add_u32 s51, s48, 23552
    s_mov_b32 m0, s50
    s_nop 0
    buffer_load_dwordx4 v113, s[8:11], s51 offen lds
    s_lshl_b32 s22, s32, 7
    s_add_u32 s22, s22, 0x3f80000
    s_lshl_b32 s44, s32, 13
    s_add_u32 s44, s44, s63
    s_add_u32 s44, s44, 0x1200000
    s_add_u32 s62, s63, 15360
    buffer_load_dword v25, off, s[84:87], 0 sc1
    buffer_load_dword v26, off, s[84:87], 0 offset:40 sc1
    buffer_load_dword v27, off, s[84:87], 0 offset:196 sc1
    v_lshrrev_b32 v29, 2, v113
    v_and_b32 v29, 0x7c, v29
    buffer_load_dword v28, v29, s[4:7], s22 offen sc1
    s_waitcnt vmcnt(20)
    s_barrier
    ds_read_b64_tr_b16 v[32:33], v20 offset:0
    ds_read_b64_tr_b16 v[34:35], v20 offset:1024
    ds_read_b64_tr_b16 v[36:37], v20 offset:4096
    ds_read_b64_tr_b16 v[38:39], v20 offset:5120
    ds_read_b64_tr_b16 v[40:41], v20 offset:32
    ds_read_b64_tr_b16 v[42:43], v20 offset:1056
    ds_read_b64_tr_b16 v[44:45], v20 offset:4128
    ds_read_b64_tr_b16 v[46:47], v20 offset:5152
    ds_read_b64_tr_b16 v[48:49], v20 offset:64
    ds_read_b64_tr_b16 v[50:51], v20 offset:1088
    ds_read_b64_tr_b16 v[52:53], v20 offset:4160
    ds_read_b64_tr_b16 v[54:55], v20 offset:5184
    s_waitcnt lgkmcnt(8)
    ds_read_b64_tr_b16 v[56:57], v20 offset:96
    ds_read_b64_tr_b16 v[58:59], v20 offset:1120
    ds_read_b64_tr_b16 v[60:61], v20 offset:4192
    ds_read_b64_tr_b16 v[62:63], v20 offset:5216
    s_waitcnt lgkmcnt(8)
    ds_read_b64_tr_b16 v[64:65], v20 offset:128
    ds_read_b64_tr_b16 v[66:67], v20 offset:1152
    ds_read_b64_tr_b16 v[68:69], v20 offset:4224
    ds_read_b64_tr_b16 v[70:71], v20 offset:5248
    s_waitcnt lgkmcnt(8)
    ds_read_b64_tr_b16 v[72:73], v20 offset:160
    ds_read_b64_tr_b16 v[74:75], v20 offset:1184
    ds_read_b64_tr_b16 v[76:77], v20 offset:4256
    ds_read_b64_tr_b16 v[78:79], v20 offset:5280
    s_waitcnt lgkmcnt(8)
    ds_read_b64_tr_b16 v[80:81], v20 offset:192
    ds_read_b64_tr_b16 v[82:83], v20 offset:1216
    ds_read_b64_tr_b16 v[84:85], v20 offset:4288
    ds_read_b64_tr_b16 v[86:87], v20 offset:5312
    s_waitcnt lgkmcnt(8)
    ds_read_b64_tr_b16 v[88:89], v20 offset:224
    ds_read_b64_tr_b16 v[90:91], v20 offset:1248
    ds_read_b64_tr_b16 v[92:93], v20 offset:4320
    ds_read_b64_tr_b16 v[94:95], v20 offset:5344
    s_waitcnt lgkmcnt(0)
    s_barrier
    ds_write_b128 v118, a[0:3] offset:0
    ds_write_b128 v118, a[4:7] offset:1024
    ds_write_b128 v118, a[64:67] offset:2048
    ds_write_b128 v118, a[68:71] offset:3072
    s_waitcnt lgkmcnt(4)
    ds_write_b128 v118, a[8:11] offset:4096
    ds_write_b128 v118, a[12:15] offset:5120
    ds_write_b128 v118, a[72:75] offset:6144
    ds_write_b128 v118, a[76:79] offset:7168
    s_waitcnt lgkmcnt(4)
    ds_write_b128 v118, a[128:131] offset:8192
    ds_write_b128 v118, a[132:135] offset:9216
    ds_write_b128 v118, a[192:195] offset:10240
    ds_write_b128 v118, a[196:199] offset:11264
    s_waitcnt lgkmcnt(4)
    ds_write_b128 v118, v[80:83] offset:12288
    ds_write_b128 v118, v[84:87] offset:13312
    ds_write_b128 v118, v[88:91] offset:14336
    ds_write_b128 v118, v[92:95] offset:15360
    s_waitcnt lgkmcnt(4)
    s_waitcnt lgkmcnt(0)
    v_accvgpr_write_b32 a0, v32
    v_accvgpr_write_b32 a1, v33
    v_accvgpr_write_b32 a2, v34
    v_accvgpr_write_b32 a3, v35
    v_accvgpr_write_b32 a4, v36
    v_accvgpr_write_b32 a5, v37
    v_accvgpr_write_b32 a6, v38
    v_accvgpr_write_b32 a7, v39
    v_accvgpr_write_b32 a64, v40
    v_accvgpr_write_b32 a65, v41
    v_accvgpr_write_b32 a66, v42
    v_accvgpr_write_b32 a67, v43
    v_accvgpr_write_b32 a68, v44
    v_accvgpr_write_b32 a69, v45
    v_accvgpr_write_b32 a70, v46
    v_accvgpr_write_b32 a71, v47
    v_accvgpr_write_b32 a8, v48
    v_accvgpr_write_b32 a9, v49
    v_accvgpr_write_b32 a10, v50
    v_accvgpr_write_b32 a11, v51
    v_accvgpr_write_b32 a12, v52
    v_accvgpr_write_b32 a13, v53
    v_accvgpr_write_b32 a14, v54
    v_accvgpr_write_b32 a15, v55
    v_accvgpr_write_b32 a72, v56
    v_accvgpr_write_b32 a73, v57
    v_accvgpr_write_b32 a74, v58
    v_accvgpr_write_b32 a75, v59
    v_accvgpr_write_b32 a76, v60
    v_accvgpr_write_b32 a77, v61
    v_accvgpr_write_b32 a78, v62
    v_accvgpr_write_b32 a79, v63
    v_accvgpr_write_b32 a128, v64
    v_accvgpr_write_b32 a129, v65
    v_accvgpr_write_b32 a130, v66
    v_accvgpr_write_b32 a131, v67
    v_accvgpr_write_b32 a132, v68
    v_accvgpr_write_b32 a133, v69
    v_accvgpr_write_b32 a134, v70
    v_accvgpr_write_b32 a135, v71
    v_accvgpr_write_b32 a192, v72
    v_accvgpr_write_b32 a193, v73
    v_accvgpr_write_b32 a194, v74
    v_accvgpr_write_b32 a195, v75
    v_accvgpr_write_b32 a196, v76
    v_accvgpr_write_b32 a197, v77
    v_accvgpr_write_b32 a198, v78
    v_accvgpr_write_b32 a199, v79
    s_waitcnt vmcnt(0)
    s_barrier
    s_mov_b32 s25, 0
    v_bfe_u32 v29, v113, 6, 1
    v_lshl_add_u32 v29, v28, 1, v29
    v_bfe_u32 v30, v113, 7, 1
    v_lshl_add_u32 v29, v30, 5, v29
    v_cmp_le_u32 vcc, 16, v28
    v_mov_b32 v30, 64
    s_nop 0
    v_cndmask_b32 v29, v29, v30, vcc
    s_nop 1
    v_min_u32_dpp v29, v29, v29 row_ror:8 row_mask:0xf bank_mask:0xf
    s_nop 1
    v_min_u32_dpp v29, v29, v29 row_ror:4 row_mask:0xf bank_mask:0xf
    s_nop 1
    v_min_u32_dpp v29, v29, v29 row_ror:2 row_mask:0xf bank_mask:0xf
    s_nop 1
    v_min_u32_dpp v29, v29, v29 row_ror:1 row_mask:0xf bank_mask:0xf
    s_nop 0
    v_readfirstlane_b32 s21, v29
    v_readfirstlane_b32 s48, v24
    v_readfirstlane_b32 s50, v25
    v_readfirstlane_b32 s51, v26
    s_cmp_lg_u32 s48, 256
    s_cbranch_scc1 L_hf_16
    v_readfirstlane_b32 s48, v27
    s_nop 1
    s_cmp_lg_u32 s48, 32
    s_cbranch_scc1 L_hf_16
    s_cmp_eq_u32 s21, 0
    s_cbranch_scc1 L_hf_16
    s_cmp_ge_u32 s50, 32
    s_cselect_b32 s83, 1, 0
    s_cmp_eq_u32 s51, 0
    s_cselect_b32 s83, s83, 0
    s_mov_b32 m0, s62
    s_add_u32 s48, s44, 0x1000000
    buffer_load_dwordx4 v113, s[4:7], s44 offen lds
    buffer_load_dwordx4 v113, s[4:7], s44 offen offset:1024 lds
    s_add_u32 m0, s62, 8192
    s_add_u32 s44, s44, 0x40000
    buffer_load_dwordx4 v113, s[4:7], s48 offen lds
    buffer_load_dwordx4 v113, s[4:7], s48 offen offset:1024 lds
    s_mov_b32 s25, 1
L_hf_16:
    ds_read_b64_tr_b16 v[32:33], v21 offset:0
    ds_read_b64_tr_b16 v[34:35], v21 offset:1024
    ds_read_b64_tr_b16 v[36:37], v21 offset:4096
    ds_read_b64_tr_b16 v[38:39], v21 offset:5120
    ds_read_b64_tr_b16 v[40:41], v21 offset:32
    ds_read_b64_tr_b16 v[42:43], v21 offset:1056
    ds_read_b64_tr_b16 v[44:45], v21 offset:4128
    ds_read_b64_tr_b16 v[46:47], v21 offset:5152
    ds_read_b64_tr_b16 v[48:49], v21 offset:64
    ds_read_b64_tr_b16 v[50:51], v21 offset:1088
    ds_read_b64_tr_b16 v[52:53], v21 offset:4160
    ds_read_b64_tr_b16 v[54:55], v21 offset:5184
    s_waitcnt lgkmcnt(8)
    ds_read_b64_tr_b16 v[56:57], v21 offset:96
    ds_read_b64_tr_b16 v[58:59], v21 offset:1120
    ds_read_b64_tr_b16 v[60:61], v21 offset:4192
    ds_read_b64_tr_b16 v[62:63], v21 offset:5216
    s_waitcnt lgkmcnt(8)
    ds_read_b64_tr_b16 v[64:65], v21 offset:128
    ds_read_b64_tr_b16 v[66:67], v21 offset:1152
    ds_read_b64_tr_b16 v[68:69], v21 offset:4224
    ds_read_b64_tr_b16 v[70:71], v21 offset:5248
    s_waitcnt lgkmcnt(8)
    ds_read_b64_tr_b16 v[72:73], v21 offset:160
    ds_read_b64_tr_b16 v[74:75], v21 offset:1184
    ds_read_b64_tr_b16 v[76:77], v21 offset:4256
    ds_read_b64_tr_b16 v[78:79], v21 offset:5280
    s_waitcnt lgkmcnt(8)
    ds_read_b64_tr_b16 v[80:81], v21 offset:192
    ds_read_b64_tr_b16 v[82:83], v21 offset:1216
    ds_read_b64_tr_b16 v[84:85], v21 offset:4288
    ds_read_b64_tr_b16 v[86:87], v21 offset:5312
    s_waitcnt lgkmcnt(8)
    ds_read_b64_tr_b16 v[88:89], v21 offset:224
    ds_read_b64_tr_b16 v[90:91], v21 offset:1248
    ds_read_b64_tr_b16 v[92:93], v21 offset:4320
    ds_read_b64_tr_b16 v[94:95], v21 offset:5344
    s_waitcnt lgkmcnt(0)
    s_barrier
    ds_write_b128 v119, a[136:139] offset:0
    ds_write_b128 v119, a[140:143] offset:1024
    ds_write_b128 v119, a[200:203] offset:2048
    ds_write_b128 v119, a[204:207] offset:3072
    s_waitcnt lgkmcnt(4)
    ds_write_b128 v119, a[144:147] offset:4096
    ds_write_b128 v119, a[148:151] offset:5120
    ds_write_b128 v119, a[208:211] offset:6144
    ds_write_b128 v119, a[212:215] offset:7168
    s_waitcnt lgkmcnt(4)
    ds_write_b128 v119, a[152:155] offset:8192
    ds_write_b128 v119, a[156:159] offset:9216
    ds_write_b128 v119, a[216:219] offset:10240
    ds_write_b128 v119, a[220:223] offset:11264
    s_waitcnt lgkmcnt(4)
    ds_write_b128 v119, v[80:83] offset:12288
    ds_write_b128 v119, v[84:87] offset:13312
    ds_write_b128 v119, v[88:91] offset:14336
    ds_write_b128 v119, v[92:95] offset:15360
    s_waitcnt lgkmcnt(4)
    s_waitcnt lgkmcnt(0)
    v_accvgpr_write_b32 a136, v32
    v_accvgpr_write_b32 a137, v33
    v_accvgpr_write_b32 a138, v34
    v_accvgpr_write_b32 a139, v35
    v_accvgpr_write_b32 a140, v36
    v_accvgpr_write_b32 a141, v37
    v_accvgpr_write_b32 a142, v38
    v_accvgpr_write_b32 a143, v39
    v_accvgpr_write_b32 a200, v40
    v_accvgpr_write_b32 a201, v41
    v_accvgpr_write_b32 a202, v42
    v_accvgpr_write_b32 a203, v43
    v_accvgpr_write_b32 a204, v44
    v_accvgpr_write_b32 a205, v45
    v_accvgpr_write_b32 a206, v46
    v_accvgpr_write_b32 a207, v47
    v_accvgpr_write_b32 a144, v48
    v_accvgpr_write_b32 a145, v49
    v_accvgpr_write_b32 a146, v50
    v_accvgpr_write_b32 a147, v51
    v_accvgpr_write_b32 a148, v52
    v_accvgpr_write_b32 a149, v53
    v_accvgpr_write_b32 a150, v54
    v_accvgpr_write_b32 a151, v55
    v_accvgpr_write_b32 a208, v56
    v_accvgpr_write_b32 a209, v57
    v_accvgpr_write_b32 a210, v58
    v_accvgpr_write_b32 a211, v59
    v_accvgpr_write_b32 a212, v60
    v_accvgpr_write_b32 a213, v61
    v_accvgpr_write_b32 a214, v62
    v_accvgpr_write_b32 a215, v63
    v_accvgpr_write_b32 a152, v64
    v_accvgpr_write_b32 a153, v65
    v_accvgpr_write_b32 a154, v66
    v_accvgpr_write_b32 a155, v67
    v_accvgpr_write_b32 a156, v68
    v_accvgpr_write_b32 a157, v69
    v_accvgpr_write_b32 a158, v70
    v_accvgpr_write_b32 a159, v71
    v_accvgpr_write_b32 a216, v72
    v_accvgpr_write_b32 a217, v73
    v_accvgpr_write_b32 a218, v74
    v_accvgpr_write_b32 a219, v75
    v_accvgpr_write_b32 a220, v76
    v_accvgpr_write_b32 a221, v77
    v_accvgpr_write_b32 a222, v78
    v_accvgpr_write_b32 a223, v79
    s_mov_b32 s24, s82
    s_cmp_eq_u32 s25, 1
    s_cbranch_scc1 L_tgo_17
L_tre_18:
    s_sleep 4
    buffer_load_dword v24, off, s[84:87], 0 offset:128 sc1
    s_waitcnt vmcnt(0)
    buffer_load_dword v25, off, s[84:87], 0 sc1
    buffer_load_dword v26, off, s[84:87], 0 offset:40 sc1
    buffer_load_dword v27, off, s[84:87], 0 offset:196 sc1
    v_lshrrev_b32 v29, 2, v113
    v_and_b32 v29, 0x7c, v29
    buffer_load_dword v28, v29, s[4:7], s22 offen sc1
    s_sub_u32 s35, s35, 1
    s_cbranch_scc1 L_exit_1
    s_waitcnt vmcnt(0)
    v_bfe_u32 v29, v113, 6, 1
    v_lshl_add_u32 v29, v28, 1, v29
    v_bfe_u32 v30, v113, 7, 1
    v_lshl_add_u32 v29, v30, 5, v29
    v_cmp_le_u32 vcc, 16, v28
    v_mov_b32 v30, 64
    s_nop 0
    v_cndmask_b32 v29, v29, v30, vcc
    s_nop 1
    v_min_u32_dpp v29, v29, v29 row_ror:8 row_mask:0xf bank_mask:0xf
    s_nop 1
    v_min_u32_dpp v29, v29, v29 row_ror:4 row_mask:0xf bank_mask:0xf
    s_nop 1
    v_min_u32_dpp v29, v29, v29 row_ror:2 row_mask:0xf bank_mask:0xf
    s_nop 1
    v_min_u32_dpp v29, v29, v29 row_ror:1 row_mask:0xf bank_mask:0xf
    s_nop 0
    v_readfirstlane_b32 s21, v29
    v_readfirstlane_b32 s48, v24
    v_readfirstlane_b32 s50, v25
    v_readfirstlane_b32 s51, v26
    s_cmp_lg_u32 s48, 256
    s_cbranch_scc1 L_tre_18
    v_readfirstlane_b32 s48, v27
    s_nop 1
    s_cmp_lg_u32 s48, 32
    s_cbranch_scc1 L_tre_18
    s_cmp_eq_u32 s21, 0
    s_cbranch_scc1 L_tre_18
    s_cmp_ge_u32 s50, 32
    s_cselect_b32 s83, 1, 0
    s_cmp_eq_u32 s51, 0
    s_cselect_b32 s83, s83, 0
    s_mov_b32 m0, s62
    s_add_u32 s48, s44, 0x1000000
    buffer_load_dwordx4 v113, s[4:7], s44 offen lds
    buffer_load_dwordx4 v113, s[4:7], s44 offen offset:1024 lds
    s_add_u32 m0, s62, 8192
    s_add_u32 s44, s44, 0x40000
    buffer_load_dwordx4 v113, s[4:7], s48 offen lds
    buffer_load_dwordx4 v113, s[4:7], s48 offen offset:1024 lds
L_tgo_17:
    s_waitcnt vmcnt(0)
    s_barrier
    s_cmp_eq_u32 s83, 0
    s_cbranch_scc1 L_slowmode_19
    s_mov_b32 s34, 0
    s_mov_b32 s36, 0x3f00000
    s_mov_b32 s37, 0x3f02000
    s_mov_b32 s38, 0x3e00000
    s_mov_b32 s39, 0x3e48000
    s_lshl_b32 s45, s32, 12
    s_lshl_b32 s48, s33, 10
    s_add_u32 s45, s45, s48
    s_add_u32 s45, s45, 0xa000000
    s_mul_i32 s20, s33, 640
    s_lshl_b32 s46, s32, 11
    s_lshl_b32 s48, s33, 9
    s_add_u32 s46, s46, s48
    s_add_u32 s46, s46, 0xaa00000
    s_lshr_b32 s48, s33, 1
    s_mul_i32 s42, s48, 0x1000000
    s_and_b32 s48, s33, 1
    s_lshl_b32 s48, s48, 12
    s_add_u32 s42, s42, s48
    s_lshl_b32 s48, s32, 13
    s_add_u32 s42, s42, s48
    s_add_u32 s42, s42, 0x1240000
    s_mov_b32 s47, 0
    s_mov_b32 s26, s22
    v_mov_b64 v[32:33], 0
    v_mov_b64 v[34:35], 0
    v_mov_b64 v[36:37], 0
    v_mov_b64 v[38:39], 0
    ds_read_b128 v[56:59], v118 offset:0
    ds_read_b128 v[60:63], v118 offset:1024
    ds_read_b128 v[64:67], v118 offset:2048
    ds_read_b128 v[68:71], v118 offset:3072
    ds_read_b128 v[72:75], v118 offset:4096
    ds_read_b128 v[76:79], v118 offset:5120
    ds_read_b128 v[80:83], v118 offset:6144
    ds_read_b128 v[84:87], v118 offset:7168
    ds_read_b128 v[88:91], v118 offset:8192
    ds_read_b128 v[92:95], v118 offset:9216
    ds_read_b128 v[96:99], v118 offset:10240
    ds_read_b128 v[100:103], v118 offset:11264
    s_waitcnt lgkmcnt(8)
    ds_read_b128 v[104:107], v119 offset:0
    ds_read_b128 v[108:111], v119 offset:1024
    ds_read_b128 v[48:51], v119 offset:2048
    ds_read_b128 v[52:55], v119 offset:3072
    s_branch L_afpoll_22
.p2align 6
L_rec_21:
    s_waitcnt vmcnt(14)
    v_mfma_f32_16x16x32_bf16 v[44:47], v[40:43], v[0:3], 0
    v_bitop3_b32 v126, v0, v2, s47 bitop3:0x7e
    s_waitcnt vmcnt(12)
    v_mfma_f32_16x16x32_bf16 v[44:47], v[40:43], v[4:7], v[44:47]
    v_bitop3_b32 v127, v4, v6, s47 bitop3:0x7e
    v_or_b32 v126, v126, v127
    s_waitcnt vmcnt(10)
    v_mfma_f32_16x16x32_bf16 v[44:47], v[40:43], v[8:11], v[44:47]
    v_bitop3_b32 v127, v8, v10, s47 bitop3:0x7e
    v_or_b32 v126, v126, v127
    s_waitcnt vmcnt(8)
    v_mfma_f32_16x16x32_bf16 v[44:47], v[40:43], v[12:15], v[44:47]
    v_bitop3_b32 v127, v12, v14, s47 bitop3:0x7e
    v_or_b32 v126, v126, v127
    v_and_b32 v126, 1, v126
    v_cmp_eq_u32 vcc, 1, v126
    s_cbranch_vccnz L_pslow_27
L_red_23:
    v_mov_b32 v127, -1
    s_nop 2
    v_cvt_pk_bf16_f32 v44, v44, v45
    v_cvt_pk_bf16_f32 v46, v46, v47
    buffer_store_dword v44, v122, s[4:7], s37 offen
    buffer_store_dword v46, v122, s[4:7], s37 offen offset:16
    buffer_store_dword v127, v122, s[4:7], s36 offen
    buffer_store_dword v127, v122, s[4:7], s36 offen offset:16
L_bh_24:
    s_barrier
    s_mov_b32 s48, s36
    s_mov_b32 s36, s37
    s_mov_b32 s37, s48
    s_mov_b32 s48, s38
    s_mov_b32 s38, s39
    s_mov_b32 s39, s48
    s_add_u32 s34, s34, 1
    s_bfe_u32 s47, s34, 0x10001
L_afpoll_22:
    s_add_u32 s41, s36, s63
    v_mov_b64 v[40:41], 0
    v_mov_b64 v[42:43], 0
    v_mov_b64 v[44:45], 0
    v_mov_b64 v[46:47], 0
    v_xor_b32 v126, 2048, v124
    v_xor_b32 v127, 4096, v124
    v_xor_b32 v125, 6144, v124
    s_nop 7
    s_nop 7
    buffer_load_dwordx4 v[0:3], v113, s[4:7], s41 offen offset:0 sc1
    buffer_load_dwordx4 v[4:7], v113, s[4:7], s41 offen offset:1024 sc1
    s_nop 7
    s_nop 7
    buffer_load_dwordx4 v[24:27], v113, s[4:7], s41 offen offset:0 sc1
    buffer_load_dwordx4 v[28:31], v113, s[4:7], s41 offen offset:1024 sc1
    s_nop 7
    s_nop 7
    buffer_load_dwordx4 v[16:19], v113, s[4:7], s41 offen offset:0 sc1
    buffer_load_dwordx4 v[20:23], v113, s[4:7], s41 offen offset:1024 sc1
L_afchk_30:
    s_waitcnt vmcnt(4) lgkmcnt(0)
L_afok_29:
    ds_write_b128 v124, v[0:3] offset:7168
    ds_write_b128 v124, v[4:7] offset:8192
    v_smfmac_f32_16x16x64_bf16 v[32:35], v[0:3], v[56:63], v112
    v_max3_u32 v8, v0, v1, v2
    v_max3_u32 v8, v8, v3, v4
    v_smfmac_f32_16x16x64_bf16 v[36:39], v[0:3], v[64:71], v112
    v_max3_u32 v8, v8, v5, v6
    v_max_u32 v8, v8, v7
    v_cmp_eq_u32 vcc, -1, v8
    s_cbranch_vccnz L_aslow_28
    s_waitcnt lgkmcnt(0)
    s_barrier
    ds_read_b128 v[8:11], v126 offset:7168
    ds_read_b128 v[12:15], v126 offset:8192
    v_smfmac_f32_16x16x64_bf16 v[32:35], v[4:7], v[72:79], v112
    v_lshlrev_b32 v126, 2, v113
    v_smfmac_f32_16x16x64_bf16 v[36:39], v[4:7], v[80:87], v112
    v_smfmac_f32_16x16x64_bf16 v[40:43], v[0:3], v[88:95], v112
    v_smfmac_f32_16x16x64_bf16 v[44:47], v[0:3], v[96:103], v112
    ds_read_b128 v[56:59], v119 offset:4096
    ds_read_b128 v[60:63], v119 offset:5120
    v_smfmac_f32_16x16x64_bf16 v[40:43], v[4:7], v[104:111], v112
    ds_read_b128 v[64:67], v119 offset:6144
    ds_read_b128 v[68:71], v119 offset:7168
    v_smfmac_f32_16x16x64_bf16 v[44:47], v[4:7], v[48:55], v112
    s_waitcnt vmcnt(0)
    ds_read_b128 v[16:19], v127 offset:7168
    ds_read_b128 v[20:23], v127 offset:8192
    ds_read_b128 v[24:27], v125 offset:7168
    ds_read_b128 v[28:31], v125 offset:8192
    v_lshrrev_b32 v127, 2, v113
    s_add_u32 s23, s34, 1
    s_cmp_ge_u32 s23, s21
    s_cbranch_scc1 L_kvc_31
L_kvr_32:
    buffer_load_dword v125, v126, s[4:7], s42 offen
    buffer_load_dword v125, v127, s[4:7], s26 offen sc1
    s_waitcnt lgkmcnt(9)
    v_smfmac_f32_16x16x64_bf16 v[32:35], v[8:11], a[16:23], v112
    ds_read_b128 v[72:75], v119 offset:8192
    ds_read_b128 v[76:79], v119 offset:9216
    v_smfmac_f32_16x16x64_bf16 v[36:39], v[8:11], a[80:87], v112
    s_waitcnt lgkmcnt(10)
    v_smfmac_f32_16x16x64_bf16 v[32:35], v[12:15], a[24:31], v112
    ds_read_b128 v[80:83], v119 offset:10240
    ds_read_b128 v[84:87], v119 offset:11264
    v_smfmac_f32_16x16x64_bf16 v[36:39], v[12:15], a[88:95], v112
    s_waitcnt lgkmcnt(7)
    v_smfmac_f32_16x16x64_bf16 v[32:35], v[16:19], a[32:39], v112
    v_add_u32 v48, s20, v116
    v_smfmac_f32_16x16x64_bf16 v[36:39], v[16:19], a[96:103], v112
    ds_read_b128 v[48:51], v48
    s_waitcnt lgkmcnt(7)
    v_smfmac_f32_16x16x64_bf16 v[32:35], v[20:23], a[40:47], v112
    v_lshrrev_b32 v52, 2, v124
    v_smfmac_f32_16x16x64_bf16 v[36:39], v[20:23], a[104:111], v112
    v_add_u32 v52, v52, v127
    s_waitcnt lgkmcnt(6)
    v_smfmac_f32_16x16x64_bf16 v[32:35], v[24:27], a[48:55], v112
    ds_read_b64 v[52:53], v52 offset:5120
    v_smfmac_f32_16x16x64_bf16 v[36:39], v[24:27], a[112:119], v112
    ds_read_b128 v[88:91], v124 offset:23552
    s_waitcnt lgkmcnt(7)
    v_smfmac_f32_16x16x64_bf16 v[32:35], v[28:31], a[56:63], v112
    v_smfmac_f32_16x16x64_bf16 v[36:39], v[28:31], a[120:127], v112
    ds_read_b128 v[92:95], v124 offset:24576
    v_smfmac_f32_16x16x64_bf16 v[40:43], v[8:11], v[56:63], v112
    s_add_u32 s42, s42, 0x40000
    v_lshrrev_b32 v127, 1, v113
    v_smfmac_f32_16x16x64_bf16 v[44:47], v[8:11], v[64:71], v112
    s_waitcnt lgkmcnt(2)
    buffer_store_dwordx4 v[48:51], v113, s[4:7], s45 offen sc1
    v_smfmac_f32_16x16x64_bf16 v[40:43], v[12:15], v[72:79], v112
    buffer_store_dwordx2 v[52:53], v127, s[4:7], s46 offen sc1
    s_add_u32 s45, s45, 0x20000
    s_add_u32 s46, s46, 0x10000
    v_smfmac_f32_16x16x64_bf16 v[44:47], v[12:15], v[80:87], v112
    v_mov_b32 v127, s34
    s_mov_b64 exec, 1
    buffer_store_dword v127, off, s[4:7], s24 sc1
    s_mov_b64 exec, -1
    ds_read_b128 v[56:59], v113 offset:15360
    v_add_f32 v32, v32, v34
    v_smfmac_f32_16x16x64_bf16 v[40:43], v[16:19], a[160:167], v112
    ds_read_b128 v[60:63], v113 offset:16384
    v_add_f32 v33, v33, v35
    v_smfmac_f32_16x16x64_bf16 v[44:47], v[16:19], a[224:231], v112
    ds_read_b128 v[64:67], v113 offset:17408
    v_add_f32 v36, v36, v38
    v_smfmac_f32_16x16x64_bf16 v[40:43], v[20:23], a[168:175], v112
    ds_read_b128 v[68:71], v113 offset:18432
    v_add_f32 v37, v37, v39
    v_smfmac_f32_16x16x64_bf16 v[44:47], v[20:23], a[232:239], v112
    ds_read_b128 v[72:75], v113 offset:19456
    v_cvt_pk_bf16_f32 v32, v32, v36
    v_mov_b64 v[48:49], 0
    v_smfmac_f32_16x16x64_bf16 v[40:43], v[24:27], a[176:183], v112
    ds_read_b128 v[76:79], v113 offset:20480
    v_cvt_pk_bf16_f32 v33, v33, v37
    v_mov_b64 v[50:51], 0
    v_smfmac_f32_16x16x64_bf16 v[44:47], v[24:27], a[240:247], v112
    ds_read_b128 v[80:83], v113 offset:21504
    ds_write2_b32 v114, v32, v33 offset0:0 offset1:16
    v_mov_b64 v[52:53], 0
    v_smfmac_f32_16x16x64_bf16 v[40:43], v[28:31], a[184:191], v112
    ds_read_b128 v[84:87], v113 offset:22528
    v_mov_b64 v[54:55], 0
    v_smfmac_f32_16x16x64_bf16 v[44:47], v[28:31], a[248:255], v112
    v_smfmac_f32_16x16x64_bf16 v[48:51], v[0:3], v[128:135], v112
    v_smfmac_f32_16x16x64_bf16 v[52:55], v[0:3], v[192:199], v112
    s_nop 4
    v_add_f32 v40, v40, v42
    v_add_f32 v41, v41, v43
    v_add_f32 v44, v44, v46
    v_smfmac_f32_16x16x64_bf16 v[48:51], v[4:7], v[136:143], v112
    v_add_f32 v45, v45, v47
    v_cvt_pk_bf16_f32 v40, v40, v44
    v_cvt_pk_bf16_f32 v41, v41, v45
    ds_write_b32 v114, v40 offset:2560
    ds_write_b32 v114, v41 offset:2624
    v_smfmac_f32_16x16x64_bf16 v[52:55], v[4:7], v[200:207], v112
    v_smfmac_f32_16x16x64_bf16 v[48:51], v[8:11], v[144:151], v112
    v_smfmac_f32_16x16x64_bf16 v[52:55], v[8:11], v[208:215], v112
    v_smfmac_f32_16x16x64_bf16 v[48:51], v[12:15], v[152:159], v112
    s_cmp_eq_u32 s34, 63
    s_waitcnt lgkmcnt(0)
    s_cbranch_scc1 L_fin_26
    s_barrier
    ds_read_b128 v[96:99], v115 offset:0
    ds_read_b128 v[100:103], v115 offset:640
    v_smfmac_f32_16x16x64_bf16 v[52:55], v[12:15], v[216:223], v112
    ds_read_b128 v[104:107], v115 offset:1280
    ds_read_b128 v[108:111], v115 offset:1920
    v_smfmac_f32_16x16x64_bf16 v[48:51], v[16:19], v[160:167], v112
    ds_read_b128 v[0:3], v116 offset:0
    ds_read_b128 v[4:7], v116 offset:640
    v_smfmac_f32_16x16x64_bf16 v[52:55], v[16:19], v[224:231], v112
    ds_read_b128 v[8:11], v116 offset:1280
    ds_read_b128 v[12:15], v116 offset:1920
    v_smfmac_f32_16x16x64_bf16 v[48:51], v[20:23], v[168:175], v112
    v_smfmac_f32_16x16x64_bf16 v[52:55], v[20:23], v[232:239], v112
    v_smfmac_f32_16x16x64_bf16 v[48:51], v[24:27], v[176:183], v112
    v_smfmac_f32_16x16x64_bf16 v[52:55], v[24:27], v[240:247], v112
    s_waitcnt lgkmcnt(7)
    v_mfma_f32_16x16x32_bf16 v[32:35], v[56:59], v[96:99], 0
    v_mfma_f32_16x16x32_bf16 v[36:39], v[72:75], v[96:99], 0
    s_waitcnt lgkmcnt(6)
    v_mfma_f32_16x16x32_bf16 v[32:35], v[60:63], v[100:103], v[32:35]
    v_mfma_f32_16x16x32_bf16 v[36:39], v[76:79], v[100:103], v[36:39]
    s_waitcnt lgkmcnt(5)
    v_mfma_f32_16x16x32_bf16 v[32:35], v[64:67], v[104:107], v[32:35]
    v_mov_b64 v[20:21], s[54:55]
    v_mfma_f32_16x16x32_bf16 v[36:39], v[80:83], v[104:107], v[36:39]
    s_waitcnt lgkmcnt(4)
    v_mfma_f32_16x16x32_bf16 v[32:35], v[68:71], v[108:111], v[32:35]
    v_mov_b64 v[22:23], s[54:55]
    v_mfma_f32_16x16x32_bf16 v[36:39], v[84:87], v[108:111], v[36:39]
    s_waitcnt lgkmcnt(0)
    v_mfma_f32_16x16x32_bf16 v[40:43], v[0:3], v[96:99], 0
    v_mov_b32 v85, 0
    v_mov_b32 v86, 0
    v_mfma_f32_16x16x32_bf16 v[40:43], v[4:7], v[100:103], v[40:43]
    s_nop 1
    v_max3_f32 v126, v32, v33, v34
    v_max3_f32 v127, v36, v37, v38
    v_mfma_f32_16x16x32_bf16 v[40:43], v[8:11], v[104:107], v[40:43]
    v_max3_f32 v126, v126, v35, v39
    v_max_f32 v126, v126, v127
    v_mfma_f32_16x16x32_bf16 v[40:43], v[12:15], v[108:111], v[40:43]
    v_mov_b32 v127, v126
    v_smfmac_f32_16x16x64_bf16 v[48:51], v[28:31], v[184:191], v112
    s_nop 0
    v_permlane32_swap_b32 v126, v127
    v_smfmac_f32_16x16x64_bf16 v[52:55], v[28:31], v[248:255], v112
    v_max_f32 v126, v126, v127
    s_nop 1
    v_max3_f32 v127, v40, v41, v42
    v_max3_f32 v126, v127, v43, v126
    v_mov_b32 v127, v126
    v_mov_b64 v[56:57], 0
    v_mov_b64 v[58:59], 0
    v_permlane16_swap_b32 v126, v127
    v_max_f32 v126, v126, v127
    v_mul_f32_e64 v126, -s52, v126
    v_pk_fma_f32 v[40:41], v[40:41], s[52:53], v[126:127] op_sel:[0,0,0] op_sel_hi:[1,1,0]
    v_pk_fma_f32 v[32:33], v[32:33], s[52:53], v[126:127] op_sel:[0,0,0] op_sel_hi:[1,1,0]
    v_pk_fma_f32 v[34:35], v[34:35], s[52:53], v[126:127] op_sel:[0,0,0] op_sel_hi:[1,1,0]
    v_pk_fma_f32 v[36:37], v[36:37], s[52:53], v[126:127] op_sel:[0,0,0] op_sel_hi:[1,1,0]
    v_pk_fma_f32 v[38:39], v[38:39], s[52:53], v[126:127] op_sel:[0,0,0] op_sel_hi:[1,1,0]
    v_exp_f32 v40, v40
    v_exp_f32 v41, v41
    v_pk_add_f32 v[48:49], v[48:49], v[50:51]
    v_pk_add_f32 v[52:53], v[52:53], v[54:55]
    v_cvt_pk_bf16_f32 v84, v40, v41
    v_cvt_pk_bf16_f32 v87, v40, v41
    v_cvt_pk_bf16_f32 v50, v48, v49
    v_cvt_pk_bf16_f32 v51, v52, v53
    v_exp_f32 v32, v32
    v_mfma_f32_16x16x16_bf16 v[80:83], v[20:21], v[84:85], 0
    v_exp_f32 v33, v33
    v_mfma_f32_16x16x16_bf16 v[72:75], v[50:51], v[84:85], 0
    v_exp_f32 v34, v34
    v_mfma_f32_16x16x16_bf16 v[76:79], v[50:51], v[86:87], 0
    v_exp_f32 v35, v35
    v_cvt_pk_bf16_f32 v44, v32, v33
    v_exp_f32 v36, v36
    v_exp_f32 v37, v37
    v_cvt_pk_bf16_f32 v45, v34, v35
    v_exp_f32 v38, v38
    v_exp_f32 v39, v39
    v_cvt_pk_bf16_f32 v46, v36, v37
    v_cvt_pk_bf16_f32 v47, v38, v39
    v_lshrrev_b32 v127, 2, v124
    v_mov_b64 v[36:37], 0
    v_mfma_f32_16x16x32_bf16 v[80:83], v[20:23], v[44:47], v[80:83]
    v_mov_b64 v[38:39], 0
    v_mov_b64 v[40:41], 0
    v_mfma_f32_16x16x32_bf16 v[72:75], v[88:91], v[44:47], v[72:75]
    v_mov_b64 v[42:43], 0
    v_mov_b64 v[60:61], 0
    v_mfma_f32_16x16x32_bf16 v[76:79], v[92:95], v[44:47], v[76:79]
    v_mov_b64 v[62:63], 0
    v_mov_b64 v[96:97], 0
    v_rcp_f32 v126, v80
    v_mov_b64 v[98:99], 0
    v_mov_b64 v[100:101], 0
    v_pk_mul_f32 v[72:73], v[72:73], v[126:127] op_sel:[0,0] op_sel_hi:[1,0]
    v_pk_mul_f32 v[74:75], v[74:75], v[126:127] op_sel:[0,0] op_sel_hi:[1,0]
    v_cvt_pk_bf16_f32 v32, v72, v73
    v_cvt_pk_bf16_f32 v33, v74, v75
    v_pk_mul_f32 v[76:77], v[76:77], v[126:127] op_sel:[0,0] op_sel_hi:[1,0]
    v_pk_mul_f32 v[78:79], v[78:79], v[126:127] op_sel:[0,0] op_sel_hi:[1,0]
    v_cvt_pk_bf16_f32 v34, v76, v77
    v_cvt_pk_bf16_f32 v35, v78, v79
    ds_write_b128 v117, v[32:35]
    v_lshrrev_b32 v126, 2, v113
    v_add_u32 v127, v127, v126
    ds_write_b64 v127, v[50:51] offset:5120
    v_mov_b64 v[72:73], 0
    v_mov_b64 v[74:75], 0
    v_mov_b64 v[76:77], 0
    v_mov_b64 v[78:79], 0
    v_mov_b64 v[102:103], 0
    s_waitcnt lgkmcnt(1)
    s_barrier
    ds_read_b128 v[88:91], v113 offset:7168
    ds_read_b128 v[92:95], v113 offset:8192
    s_add_u32 s40, s38, 4096
    s_waitcnt lgkmcnt(1)
    v_smfmac_f32_16x16x64_bf16 v[36:39], v[88:91], a[0:7], v112
    s_mov_b32 m0, s62
    s_add_u32 s48, s44, 0x1000000
    buffer_load_dwordx4 v113, s[4:7], s44 offen lds
    v_smfmac_f32_16x16x64_bf16 v[40:43], v[88:91], a[64:71], v112
    buffer_load_dwordx4 v113, s[4:7], s44 offen offset:1024 lds
    s_add_u32 m0, s62, 8192
    s_add_u32 s44, s44, 0x40000
    s_waitcnt lgkmcnt(0)
    v_smfmac_f32_16x16x64_bf16 v[36:39], v[92:95], a[136:143], v112
    ds_read_b128 v[0:3], v118 offset:12288
    ds_read_b128 v[4:7], v118 offset:13312
    buffer_load_dwordx4 v113, s[4:7], s48 offen lds
    v_smfmac_f32_16x16x64_bf16 v[40:43], v[92:95], a[200:207], v112
    ds_read_b128 v[8:11], v118 offset:14336
    ds_read_b128 v[12:15], v118 offset:15360
    buffer_load_dwordx4 v113, s[4:7], s48 offen offset:1024 lds
    v_smfmac_f32_16x16x64_bf16 v[56:59], v[88:91], a[8:15], v112
    ds_read_b128 v[24:27], v119 offset:12288
    ds_read_b128 v[28:31], v119 offset:13312
    v_smfmac_f32_16x16x64_bf16 v[60:63], v[88:91], a[72:79], v112
    ds_read_b128 v[64:67], v119 offset:14336
    ds_read_b128 v[68:71], v119 offset:15360
    v_smfmac_f32_16x16x64_bf16 v[56:59], v[92:95], a[144:151], v112
    v_add_f32 v36, v36, v38
    v_add_f32 v37, v37, v39
    v_smfmac_f32_16x16x64_bf16 v[60:63], v[92:95], a[208:215], v112
    v_add_f32 v40, v40, v42
    v_add_f32 v41, v41, v43
    v_smfmac_f32_16x16x64_bf16 v[72:75], v[88:91], a[128:135], v112
    v_cvt_pk_bf16_f32 v32, v36, v40
    v_cvt_pk_bf16_f32 v33, v37, v41
    v_smfmac_f32_16x16x64_bf16 v[76:79], v[88:91], a[192:199], v112
    v_bfi_b32 v32, 1, s47, v32
    v_smfmac_f32_16x16x64_bf16 v[72:75], v[92:95], a[152:159], v112
    v_add_f32 v56, v56, v58
    v_add_f32 v57, v57, v59
    v_smfmac_f32_16x16x64_bf16 v[76:79], v[92:95], a[216:223], v112
    v_add_f32 v60, v60, v62
    v_add_f32 v61, v61, v63
    s_waitcnt lgkmcnt(0)
    v_smfmac_f32_16x16x64_bf16 v[96:99], v[88:91], v[0:7], v112
    v_cvt_pk_bf16_f32 v34, v56, v60
    v_cvt_pk_bf16_f32 v35, v57, v61
    v_smfmac_f32_16x16x64_bf16 v[100:103], v[88:91], v[8:15], v112
    v_bfi_b32 v34, 1, s47, v34
    buffer_store_dwordx4 v[32:35], v120, s[4:7], s38 offen offset:0
    v_smfmac_f32_16x16x64_bf16 v[96:99], v[92:95], v[24:31], v112
    v_add_f32 v72, v72, v74
    v_add_f32 v73, v73, v75
    v_smfmac_f32_16x16x64_bf16 v[100:103], v[92:95], v[64:71], v112
    v_add_f32 v76, v76, v78
    v_add_f32 v77, v77, v79
    v_cvt_pk_bf16_f32 v44, v72, v76
    v_cvt_pk_bf16_f32 v45, v73, v77
    v_bfi_b32 v44, 1, s47, v44
    s_cmp_ge_u32 s33, 2
    v_pk_add_f32 v[96:97], v[96:97], v[98:99]
    s_nop 0
    v_pk_add_f32 v[100:101], v[100:101], v[102:103]
    v_cvt_pk_bf16_f32 v46, v96, v100
    v_cvt_pk_bf16_f32 v47, v97, v101
    v_bfi_b32 v46, 1, s47, v46
    buffer_store_dwordx4 v[44:47], v120, s[4:7], s38 offen offset:128
    s_cmp_lg_u32 s26, s22
    s_cbranch_scc1 L_ke_33
    s_waitcnt vmcnt(9)
    v_mov_b32 v104, v125
    v_bfe_u32 v105, v113, 6, 1
    v_lshl_add_u32 v105, v104, 1, v105
    v_bfe_u32 v106, v113, 7, 1
    v_lshl_add_u32 v105, v106, 5, v105
    v_cmp_le_u32 vcc, 16, v104
    v_mov_b32 v106, 64
    s_nop 0
    v_cndmask_b32 v105, v105, v106, vcc
    s_nop 1
    v_min_u32_dpp v105, v105, v105 row_ror:8 row_mask:0xf bank_mask:0xf
    s_nop 1
    v_min_u32_dpp v105, v105, v105 row_ror:4 row_mask:0xf bank_mask:0xf
    s_nop 1
    v_min_u32_dpp v105, v105, v105 row_ror:2 row_mask:0xf bank_mask:0xf
    s_nop 1
    v_min_u32_dpp v105, v105, v105 row_ror:1 row_mask:0xf bank_mask:0xf
    s_nop 0
    v_readfirstlane_b32 s21, v105
    s_nop 4
    s_branch L_ke2_34
L_ke_33:
    s_nop 7
    s_nop 7
    s_nop 7
L_ke2_34:
    s_add_u32 s23, s34, 8
    s_min_u32 s23, s23, 64
    s_cmp_lt_u32 s21, s23
    s_cselect_b32 s26, s22, 0x7f000000
    s_cmp_ge_u32 s33, 2
    v_mov_b64 v[32:33], 0
    v_mov_b64 v[34:35], 0
    v_mov_b64 v[36:37], 0
    v_mov_b64 v[38:39], 0
    s_cbranch_scc1 L_w23_25
    v_cndmask_b32 v40, 0, v123, s[16:17]
    v_cndmask_b32 v41, 0, v123, s[18:19]
    v_mov_b64 v[42:43], v[40:41]
    s_nop 7
    s_nop 7
    s_nop 7
    buffer_load_dwordx2 v[0:1], v121, s[4:7], s38 offen offset:0 sc1
    buffer_load_dwordx2 v[2:3], v121, s[4:7], s38 offen offset:1024 sc1
    buffer_load_dwordx2 v[4:5], v121, s[4:7], s38 offen offset:2048 sc1
    buffer_load_dwordx2 v[6:7], v121, s[4:7], s38 offen offset:3072 sc1
    buffer_load_dwordx2 v[8:9], v121, s[4:7], s40 offen offset:0 sc1
    buffer_load_dwordx2 v[10:11], v121, s[4:7], s40 offen offset:1024 sc1
    buffer_load_dwordx2 v[12:13], v121, s[4:7], s40 offen offset:2048 sc1
    buffer_load_dwordx2 v[14:15], v121, s[4:7], s40 offen offset:3072 sc1
    ds_read_b128 v[56:59], v118 offset:0
    ds_read_b128 v[60:63], v118 offset:1024
    ds_read_b128 v[64:67], v118 offset:2048
    ds_read_b128 v[68:71], v118 offset:3072
    ds_read_b128 v[72:75], v118 offset:4096
    ds_read_b128 v[76:79], v118 offset:5120
    ds_read_b128 v[80:83], v118 offset:6144
    ds_read_b128 v[84:87], v118 offset:7168
    buffer_load_dwordx2 v[16:17], v121, s[4:7], s38 offen offset:0 sc1
    buffer_load_dwordx2 v[18:19], v121, s[4:7], s38 offen offset:1024 sc1
    buffer_load_dwordx2 v[20:21], v121, s[4:7], s38 offen offset:2048 sc1
    buffer_load_dwordx2 v[22:23], v121, s[4:7], s38 offen offset:3072 sc1
    buffer_load_dwordx2 v[24:25], v121, s[4:7], s40 offen offset:0 sc1
    buffer_load_dwordx2 v[26:27], v121, s[4:7], s40 offen offset:1024 sc1
    buffer_load_dwordx2 v[28:29], v121, s[4:7], s40 offen offset:2048 sc1
    buffer_load_dwordx2 v[30:31], v121, s[4:7], s40 offen offset:3072 sc1
    ds_read_b128 v[88:91], v118 offset:8192
    ds_read_b128 v[92:95], v118 offset:9216
    ds_read_b128 v[96:99], v118 offset:10240
    ds_read_b128 v[100:103], v118 offset:11264
    s_waitcnt lgkmcnt(8)
    ds_read_b128 v[104:107], v119 offset:0
    ds_read_b128 v[108:111], v119 offset:1024
    ds_read_b128 v[48:51], v119 offset:2048
    ds_read_b128 v[52:55], v119 offset:3072
    s_branch L_rec_21
L_w23_25:
    ds_read_b128 v[56:59], v118 offset:0
    ds_read_b128 v[60:63], v118 offset:1024
    ds_read_b128 v[64:67], v118 offset:2048
    ds_read_b128 v[68:71], v118 offset:3072
    ds_read_b128 v[72:75], v118 offset:4096
    ds_read_b128 v[76:79], v118 offset:5120
    ds_read_b128 v[80:83], v118 offset:6144
    ds_read_b128 v[84:87], v118 offset:7168
    ds_read_b128 v[88:91], v118 offset:8192
    ds_read_b128 v[92:95], v118 offset:9216
    ds_read_b128 v[96:99], v118 offset:10240
    ds_read_b128 v[100:103], v118 offset:11264
    s_waitcnt lgkmcnt(8)
    ds_read_b128 v[104:107], v119 offset:0
    ds_read_b128 v[108:111], v119 offset:1024
    ds_read_b128 v[48:51], v119 offset:2048
    ds_read_b128 v[52:55], v119 offset:3072
    s_branch L_bh_24
L_pslow_27:
    s_waitcnt vmcnt(6)
    v_mfma_f32_16x16x32_bf16 v[44:47], v[40:43], v[16:19], 0
    v_bitop3_b32 v126, v16, v18, s47 bitop3:0x7e
    s_waitcnt vmcnt(4)
    v_mfma_f32_16x16x32_bf16 v[44:47], v[40:43], v[20:23], v[44:47]
    v_bitop3_b32 v127, v20, v22, s47 bitop3:0x7e
    v_or_b32 v126, v126, v127
    s_waitcnt vmcnt(2)
    v_mfma_f32_16x16x32_bf16 v[44:47], v[40:43], v[24:27], v[44:47]
    v_bitop3_b32 v127, v24, v26, s47 bitop3:0x7e
    v_or_b32 v126, v126, v127
    s_waitcnt vmcnt(0)
    v_mfma_f32_16x16x32_bf16 v[44:47], v[40:43], v[28:31], v[44:47]
    v_bitop3_b32 v127, v28, v30, s47 bitop3:0x7e
    v_or_b32 v126, v126, v127
    v_and_b32 v126, 1, v126
    v_cmp_eq_u32 vcc, 1, v126
    s_cbranch_vccz L_red_23
    buffer_load_dwordx2 v[0:1], v121, s[4:7], s38 offen offset:0 sc1
    buffer_load_dwordx2 v[2:3], v121, s[4:7], s38 offen offset:1024 sc1
    buffer_load_dwordx2 v[4:5], v121, s[4:7], s38 offen offset:2048 sc1
    buffer_load_dwordx2 v[6:7], v121, s[4:7], s38 offen offset:3072 sc1
    buffer_load_dwordx2 v[8:9], v121, s[4:7], s40 offen offset:0 sc1
    buffer_load_dwordx2 v[10:11], v121, s[4:7], s40 offen offset:1024 sc1
    buffer_load_dwordx2 v[12:13], v121, s[4:7], s40 offen offset:2048 sc1
    buffer_load_dwordx2 v[14:15], v121, s[4:7], s40 offen offset:3072 sc1
    s_sub_u32 s35, s35, 1
    s_cbranch_scc1 L_tdone_20
    s_nop 7
    s_nop 7
    s_nop 7
    buffer_load_dwordx2 v[16:17], v121, s[4:7], s38 offen offset:0 sc1
    buffer_load_dwordx2 v[18:19], v121, s[4:7], s38 offen offset:1024 sc1
    buffer_load_dwordx2 v[20:21], v121, s[4:7], s38 offen offset:2048 sc1
    buffer_load_dwordx2 v[22:23], v121, s[4:7], s38 offen offset:3072 sc1
    buffer_load_dwordx2 v[24:25], v121, s[4:7], s40 offen offset:0 sc1
    buffer_load_dwordx2 v[26:27], v121, s[4:7], s40 offen offset:1024 sc1
    buffer_load_dwordx2 v[28:29], v121, s[4:7], s40 offen offset:2048 sc1
    buffer_load_dwordx2 v[30:31], v121, s[4:7], s40 offen offset:3072 sc1
    s_branch L_rec_21
L_aslow_28:
    buffer_load_dwordx4 v[0:3], v113, s[4:7], s41 offen offset:0 sc1
    buffer_load_dwordx4 v[4:7], v113, s[4:7], s41 offen offset:1024 sc1
    v_mov_b64 v[32:33], 0
    v_mov_b64 v[34:35], 0
    v_mov_b64 v[36:37], 0
    v_mov_b64 v[38:39], 0
    s_waitcnt vmcnt(4)
    v_max3_u32 v8, v24, v25, v26
    v_max3_u32 v9, v27, v28, v29
    v_mov_b64 v[10:11], v[24:25]
    v_max3_u32 v8, v8, v30, v31
    v_max_u32 v8, v8, v9
    v_cmp_eq_u32 vcc, -1, v8
    s_cbranch_vccnz L_af_f_35
    v_mov_b64 v[0:1], v[24:25]
    v_mov_b64 v[2:3], v[26:27]
    v_mov_b64 v[4:5], v[28:29]
    v_mov_b64 v[6:7], v[30:31]
    s_nop 1
    s_branch L_afok_29
L_af_f_35:
    buffer_load_dwordx4 v[24:27], v113, s[4:7], s41 offen offset:0 sc1
    buffer_load_dwordx4 v[28:31], v113, s[4:7], s41 offen offset:1024 sc1
    s_waitcnt vmcnt(4)
    v_max3_u32 v8, v16, v17, v18
    v_max3_u32 v9, v19, v20, v21
    v_mov_b64 v[10:11], v[16:17]
    v_max3_u32 v8, v8, v22, v23
    v_max_u32 v8, v8, v9
    v_cmp_eq_u32 vcc, -1, v8
    s_cbranch_vccnz L_af_f_36
    v_mov_b64 v[0:1], v[16:17]
    v_mov_b64 v[2:3], v[18:19]
    v_mov_b64 v[4:5], v[20:21]
    v_mov_b64 v[6:7], v[22:23]
    s_nop 1
    s_branch L_afok_29
L_af_f_36:
    buffer_load_dwordx4 v[16:19], v113, s[4:7], s41 offen offset:0 sc1
    buffer_load_dwordx4 v[20:23], v113, s[4:7], s41 offen offset:1024 sc1
    s_sub_u32 s35, s35, 1
    s_cbranch_scc1 L_tdone_20
    s_branch L_afchk_30
L_kvc_31:
    s_cmp_eq_u32 s23, 64
    s_cbranch_scc1 L_kvr_32
L_kvw_37:
    v_lshrrev_b32 v49, 2, v113
    v_and_b32 v49, 0x7c, v49
    buffer_load_dword v48, v49, s[4:7], s22 offen sc1
    s_sub_u32 s35, s35, 1
    s_cbranch_scc1 L_tdone_20
    s_waitcnt vmcnt(0)
    v_bfe_u32 v49, v113, 6, 1
    v_lshl_add_u32 v49, v48, 1, v49
    v_bfe_u32 v50, v113, 7, 1
    v_lshl_add_u32 v49, v50, 5, v49
    v_cmp_le_u32 vcc, 16, v48
    v_mov_b32 v50, 64
    s_nop 0
    v_cndmask_b32 v49, v49, v50, vcc
    s_nop 1
    v_min_u32_dpp v49, v49, v49 row_ror:8 row_mask:0xf bank_mask:0xf
    s_nop 1
    v_min_u32_dpp v49, v49, v49 row_ror:4 row_mask:0xf bank_mask:0xf
    s_nop 1
    v_min_u32_dpp v49, v49, v49 row_ror:2 row_mask:0xf bank_mask:0xf
    s_nop 1
    v_min_u32_dpp v49, v49, v49 row_ror:1 row_mask:0xf bank_mask:0xf
    s_nop 0
    v_readfirstlane_b32 s21, v49
    s_nop 1
    s_cmp_le_u32 s21, s23
    s_nop 1
    s_cbranch_scc1 L_kvw_37
    s_branch L_kvr_32
L_fin_26:
    v_add_u32 v126, s20, v116
    ds_read_b128 v[96:99], v126
    v_smfmac_f32_16x16x64_bf16 v[52:55], v[12:15], v[216:223], v112
    v_smfmac_f32_16x16x64_bf16 v[48:51], v[16:19], v[160:167], v112
    v_smfmac_f32_16x16x64_bf16 v[52:55], v[16:19], v[224:231], v112
    v_smfmac_f32_16x16x64_bf16 v[48:51], v[20:23], v[168:175], v112
    v_smfmac_f32_16x16x64_bf16 v[52:55], v[20:23], v[232:239], v112
    v_smfmac_f32_16x16x64_bf16 v[48:51], v[24:27], v[176:183], v112
    v_smfmac_f32_16x16x64_bf16 v[52:55], v[24:27], v[240:247], v112
    v_smfmac_f32_16x16x64_bf16 v[48:51], v[28:31], v[184:191], v112
    v_smfmac_f32_16x16x64_bf16 v[52:55], v[28:31], v[248:255], v112
    v_lshrrev_b32 v127, 1, v113
    s_waitcnt lgkmcnt(0)
    buffer_store_dwordx4 v[96:99], v113, s[4:7], s45 offen sc1
    s_nop 3
    v_pk_add_f32 v[48:49], v[48:49], v[50:51]
    v_pk_add_f32 v[52:53], v[52:53], v[54:55]
    v_cvt_pk_bf16_f32 v50, v48, v49
    v_cvt_pk_bf16_f32 v51, v52, v53
    buffer_store_dwordx2 v[50:51], v127, s[4:7], s46 offen sc1
    v_mov_b32 v6, 65
    s_waitcnt vmcnt(0)
    s_mov_b64 exec, 1
    buffer_store_dword v6, off, s[4:7], s24 sc1
    s_mov_b64 exec, -1
    s_branch L_tdone_20
L_slowmode_19:
    s_mov_b32 s34, 0
    s_mov_b32 s36, 0x3f00000
    s_mov_b32 s37, 0x3f02000
    s_mov_b32 s38, 0x3e00000
    s_mov_b32 s39, 0x3e48000
    s_lshl_b32 s45, s32, 12
    s_lshl_b32 s48, s33, 10
    s_add_u32 s45, s45, s48
    s_add_u32 s45, s45, 0xa000000
    s_mul_i32 s20, s33, 640
    s_lshl_b32 s46, s32, 11
    s_lshl_b32 s48, s33, 9
    s_add_u32 s46, s46, s48
    s_add_u32 s46, s46, 0xaa00000
    s_lshr_b32 s48, s33, 1
    s_mul_i32 s42, s48, 0x1000000
    s_and_b32 s48, s33, 1
    s_lshl_b32 s48, s48, 12
    s_add_u32 s42, s42, s48
    s_lshl_b32 s48, s32, 13
    s_add_u32 s42, s42, s48
    s_add_u32 s42, s42, 0x1240000
    s_mov_b32 s47, 0
    s_mov_b32 s26, s22
    v_mov_b64 v[32:33], 0
    v_mov_b64 v[34:35], 0
    v_mov_b64 v[36:37], 0
    v_mov_b64 v[38:39], 0
    ds_read_b128 v[56:59], v118 offset:0
    ds_read_b128 v[60:63], v118 offset:1024
    ds_read_b128 v[64:67], v118 offset:2048
    ds_read_b128 v[68:71], v118 offset:3072
    ds_read_b128 v[72:75], v118 offset:4096
    ds_read_b128 v[76:79], v118 offset:5120
    ds_read_b128 v[80:83], v118 offset:6144
    ds_read_b128 v[84:87], v118 offset:7168
    ds_read_b128 v[88:91], v118 offset:8192
    ds_read_b128 v[92:95], v118 offset:9216
    ds_read_b128 v[96:99], v118 offset:10240
    ds_read_b128 v[100:103], v118 offset:11264
    s_waitcnt lgkmcnt(8)
    ds_read_b128 v[104:107], v119 offset:0
    ds_read_b128 v[108:111], v119 offset:1024
    ds_read_b128 v[48:51], v119 offset:2048
    ds_read_b128 v[52:55], v119 offset:3072
    s_branch L_afpoll_39
.p2align 6
L_rec_38:
    s_waitcnt vmcnt(14)
    v_mfma_f32_16x16x32_bf16 v[44:47], v[40:43], v[0:3], 0
    v_bitop3_b32 v126, v0, v2, s47 bitop3:0x7e
    s_waitcnt vmcnt(12)
    v_mfma_f32_16x16x32_bf16 v[44:47], v[40:43], v[4:7], v[44:47]
    v_bitop3_b32 v127, v4, v6, s47 bitop3:0x7e
    v_or_b32 v126, v126, v127
    s_waitcnt vmcnt(10)
    v_mfma_f32_16x16x32_bf16 v[44:47], v[40:43], v[8:11], v[44:47]
    v_bitop3_b32 v127, v8, v10, s47 bitop3:0x7e
    v_or_b32 v126, v126, v127
    s_waitcnt vmcnt(8)
    v_mfma_f32_16x16x32_bf16 v[44:47], v[40:43], v[12:15], v[44:47]
    v_bitop3_b32 v127, v12, v14, s47 bitop3:0x7e
    v_or_b32 v126, v126, v127
    v_and_b32 v126, 1, v126
    v_cmp_eq_u32 vcc, 1, v126
    s_cbranch_vccnz L_pslow_44
L_red_40:
    v_mov_b32 v127, -1
    s_nop 2
    v_cvt_pk_bf16_f32 v44, v44, v45
    v_cvt_pk_bf16_f32 v46, v46, v47
    buffer_store_dword v44, v122, s[4:7], s37 offen sc1
    buffer_store_dword v46, v122, s[4:7], s37 offen offset:16 sc1
    buffer_store_dword v127, v122, s[4:7], s36 offen sc1
    buffer_store_dword v127, v122, s[4:7], s36 offen offset:16 sc1
L_bh_41:
    s_barrier
    s_mov_b32 s48, s36
    s_mov_b32 s36, s37
    s_mov_b32 s37, s48
    s_mov_b32 s48, s38
    s_mov_b32 s38, s39
    s_mov_b32 s39, s48
    s_add_u32 s34, s34, 1
    s_bfe_u32 s47, s34, 0x10001
L_afpoll_39:
    s_add_u32 s41, s36, s63
    v_mov_b64 v[40:41], 0
    v_mov_b64 v[42:43], 0
    v_mov_b64 v[44:45], 0
    v_mov_b64 v[46:47], 0
    v_xor_b32 v126, 2048, v124
    v_xor_b32 v127, 4096, v124
    v_xor_b32 v125, 6144, v124
    s_nop 7
    s_nop 7
    buffer_load_dwordx4 v[0:3], v113, s[4:7], s41 offen offset:0 sc1
    buffer_load_dwordx4 v[4:7], v113, s[4:7], s41 offen offset:1024 sc1
    s_nop 7
    s_nop 7
    buffer_load_dwordx4 v[24:27], v113, s[4:7], s41 offen offset:0 sc1
    buffer_load_dwordx4 v[28:31], v113, s[4:7], s41 offen offset:1024 sc1
    s_nop 7
    s_nop 7
    buffer_load_dwordx4 v[16:19], v113, s[4:7], s41 offen offset:0 sc1
    buffer_load_dwordx4 v[20:23], v113, s[4:7], s41 offen offset:1024 sc1
L_afchk_47:
    s_waitcnt vmcnt(4) lgkmcnt(0)
L_afok_46:
    ds_write_b128 v124, v[0:3] offset:7168
    ds_write_b128 v124, v[4:7] offset:8192
    v_smfmac_f32_16x16x64_bf16 v[32:35], v[0:3], v[56:63], v112
    v_max3_u32 v8, v0, v1, v2
    v_max3_u32 v8, v8, v3, v4
    v_smfmac_f32_16x16x64_bf16 v[36:39], v[0:3], v[64:71], v112
    v_max3_u32 v8, v8, v5, v6
    v_max_u32 v8, v8, v7
    v_cmp_eq_u32 vcc, -1, v8
    s_cbranch_vccnz L_aslow_45
    s_waitcnt lgkmcnt(0)
    s_barrier
    ds_read_b128 v[8:11], v126 offset:7168
    ds_read_b128 v[12:15], v126 offset:8192
    v_smfmac_f32_16x16x64_bf16 v[32:35], v[4:7], v[72:79], v112
    v_lshlrev_b32 v126, 2, v113
    v_smfmac_f32_16x16x64_bf16 v[36:39], v[4:7], v[80:87], v112
    v_smfmac_f32_16x16x64_bf16 v[40:43], v[0:3], v[88:95], v112
    v_smfmac_f32_16x16x64_bf16 v[44:47], v[0:3], v[96:103], v112
    ds_read_b128 v[56:59], v119 offset:4096
    ds_read_b128 v[60:63], v119 offset:5120
    v_smfmac_f32_16x16x64_bf16 v[40:43], v[4:7], v[104:111], v112
    ds_read_b128 v[64:67], v119 offset:6144
    ds_read_b128 v[68:71], v119 offset:7168
    v_smfmac_f32_16x16x64_bf16 v[44:47], v[4:7], v[48:55], v112
    s_waitcnt vmcnt(0)
    ds_read_b128 v[16:19], v127 offset:7168
    ds_read_b128 v[20:23], v127 offset:8192
    ds_read_b128 v[24:27], v125 offset:7168
    ds_read_b128 v[28:31], v125 offset:8192
    v_lshrrev_b32 v127, 2, v113
    s_add_u32 s23, s34, 1
    s_cmp_ge_u32 s23, s21
    s_cbranch_scc1 L_kvc_48
L_kvr_49:
    buffer_load_dword v125, v126, s[4:7], s42 offen
    buffer_load_dword v125, v127, s[4:7], s26 offen sc1
    s_waitcnt lgkmcnt(9)
    v_smfmac_f32_16x16x64_bf16 v[32:35], v[8:11], a[16:23], v112
    ds_read_b128 v[72:75], v119 offset:8192
    ds_read_b128 v[76:79], v119 offset:9216
    v_smfmac_f32_16x16x64_bf16 v[36:39], v[8:11], a[80:87], v112
    s_waitcnt lgkmcnt(10)
    v_smfmac_f32_16x16x64_bf16 v[32:35], v[12:15], a[24:31], v112
    ds_read_b128 v[80:83], v119 offset:10240
    ds_read_b128 v[84:87], v119 offset:11264
    v_smfmac_f32_16x16x64_bf16 v[36:39], v[12:15], a[88:95], v112
    s_waitcnt lgkmcnt(7)
    v_smfmac_f32_16x16x64_bf16 v[32:35], v[16:19], a[32:39], v112
    v_add_u32 v48, s20, v116
    v_smfmac_f32_16x16x64_bf16 v[36:39], v[16:19], a[96:103], v112
    ds_read_b128 v[48:51], v48
    s_waitcnt lgkmcnt(7)
    v_smfmac_f32_16x16x64_bf16 v[32:35], v[20:23], a[40:47], v112
    v_lshrrev_b32 v52, 2, v124
    v_smfmac_f32_16x16x64_bf16 v[36:39], v[20:23], a[104:111], v112
    v_add_u32 v52, v52, v127
    s_waitcnt lgkmcnt(6)
    v_smfmac_f32_16x16x64_bf16 v[32:35], v[24:27], a[48:55], v112
    ds_read_b64 v[52:53], v52 offset:5120
    v_smfmac_f32_16x16x64_bf16 v[36:39], v[24:27], a[112:119], v112
    ds_read_b128 v[88:91], v124 offset:23552
    s_waitcnt lgkmcnt(7)
    v_smfmac_f32_16x16x64_bf16 v[32:35], v[28:31], a[56:63], v112
    v_smfmac_f32_16x16x64_bf16 v[36:39], v[28:31], a[120:127], v112
    ds_read_b128 v[92:95], v124 offset:24576
    v_smfmac_f32_16x16x64_bf16 v[40:43], v[8:11], v[56:63], v112
    s_add_u32 s42, s42, 0x40000
    v_lshrrev_b32 v127, 1, v113
    v_smfmac_f32_16x16x64_bf16 v[44:47], v[8:11], v[64:71], v112
    s_waitcnt lgkmcnt(2)
    buffer_store_dwordx4 v[48:51], v113, s[4:7], s45 offen sc1
    v_smfmac_f32_16x16x64_bf16 v[40:43], v[12:15], v[72:79], v112
    buffer_store_dwordx2 v[52:53], v127, s[4:7], s46 offen sc1
    s_add_u32 s45, s45, 0x20000
    s_add_u32 s46, s46, 0x10000
    v_smfmac_f32_16x16x64_bf16 v[44:47], v[12:15], v[80:87], v112
    v_mov_b32 v127, s34
    s_mov_b64 exec, 1
    buffer_store_dword v127, off, s[4:7], s24 sc1
    s_mov_b64 exec, -1
    ds_read_b128 v[56:59], v113 offset:15360
    v_add_f32 v32, v32, v34
    v_smfmac_f32_16x16x64_bf16 v[40:43], v[16:19], a[160:167], v112
    ds_read_b128 v[60:63], v113 offset:16384
    v_add_f32 v33, v33, v35
    v_smfmac_f32_16x16x64_bf16 v[44:47], v[16:19], a[224:231], v112
    ds_read_b128 v[64:67], v113 offset:17408
    v_add_f32 v36, v36, v38
    v_smfmac_f32_16x16x64_bf16 v[40:43], v[20:23], a[168:175], v112
    ds_read_b128 v[68:71], v113 offset:18432
    v_add_f32 v37, v37, v39
    v_smfmac_f32_16x16x64_bf16 v[44:47], v[20:23], a[232:239], v112
    ds_read_b128 v[72:75], v113 offset:19456
    v_cvt_pk_bf16_f32 v32, v32, v36
    v_mov_b64 v[48:49], 0
    v_smfmac_f32_16x16x64_bf16 v[40:43], v[24:27], a[176:183], v112
    ds_read_b128 v[76:79], v113 offset:20480
    v_cvt_pk_bf16_f32 v33, v33, v37
    v_mov_b64 v[50:51], 0
    v_smfmac_f32_16x16x64_bf16 v[44:47], v[24:27], a[240:247], v112
    ds_read_b128 v[80:83], v113 offset:21504
    ds_write2_b32 v114, v32, v33 offset0:0 offset1:16
    v_mov_b64 v[52:53], 0
    v_smfmac_f32_16x16x64_bf16 v[40:43], v[28:31], a[184:191], v112
    ds_read_b128 v[84:87], v113 offset:22528
    v_mov_b64 v[54:55], 0
    v_smfmac_f32_16x16x64_bf16 v[44:47], v[28:31], a[248:255], v112
    v_smfmac_f32_16x16x64_bf16 v[48:51], v[0:3], v[128:135], v112
    v_smfmac_f32_16x16x64_bf16 v[52:55], v[0:3], v[192:199], v112
    s_nop 4
    v_add_f32 v40, v40, v42
    v_add_f32 v41, v41, v43
    v_add_f32 v44, v44, v46
    v_smfmac_f32_16x16x64_bf16 v[48:51], v[4:7], v[136:143], v112
    v_add_f32 v45, v45, v47
    v_cvt_pk_bf16_f32 v40, v40, v44
    v_cvt_pk_bf16_f32 v41, v41, v45
    ds_write_b32 v114, v40 offset:2560
    ds_write_b32 v114, v41 offset:2624
    v_smfmac_f32_16x16x64_bf16 v[52:55], v[4:7], v[200:207], v112
    v_smfmac_f32_16x16x64_bf16 v[48:51], v[8:11], v[144:151], v112
    v_smfmac_f32_16x16x64_bf16 v[52:55], v[8:11], v[208:215], v112
    v_smfmac_f32_16x16x64_bf16 v[48:51], v[12:15], v[152:159], v112
    s_cmp_eq_u32 s34, 63
    s_waitcnt lgkmcnt(0)
    s_cbranch_scc1 L_fin_43
    s_barrier
    ds_read_b128 v[96:99], v115 offset:0
    ds_read_b128 v[100:103], v115 offset:640
    v_smfmac_f32_16x16x64_bf16 v[52:55], v[12:15], v[216:223], v112
    ds_read_b128 v[104:107], v115 offset:1280
    ds_read_b128 v[108:111], v115 offset:1920
    v_smfmac_f32_16x16x64_bf16 v[48:51], v[16:19], v[160:167], v112
    ds_read_b128 v[0:3], v116 offset:0
    ds_read_b128 v[4:7], v116 offset:640
    v_smfmac_f32_16x16x64_bf16 v[52:55], v[16:19], v[224:231], v112
    ds_read_b128 v[8:11], v116 offset:1280
    ds_read_b128 v[12:15], v116 offset:1920
    v_smfmac_f32_16x16x64_bf16 v[48:51], v[20:23], v[168:175], v112
    v_smfmac_f32_16x16x64_bf16 v[52:55], v[20:23], v[232:239], v112
    v_smfmac_f32_16x16x64_bf16 v[48:51], v[24:27], v[176:183], v112
    v_smfmac_f32_16x16x64_bf16 v[52:55], v[24:27], v[240:247], v112
    s_waitcnt lgkmcnt(7)
    v_mfma_f32_16x16x32_bf16 v[32:35], v[56:59], v[96:99], 0
    v_mfma_f32_16x16x32_bf16 v[36:39], v[72:75], v[96:99], 0
    s_waitcnt lgkmcnt(6)
    v_mfma_f32_16x16x32_bf16 v[32:35], v[60:63], v[100:103], v[32:35]
    v_mfma_f32_16x16x32_bf16 v[36:39], v[76:79], v[100:103], v[36:39]
    s_waitcnt lgkmcnt(5)
    v_mfma_f32_16x16x32_bf16 v[32:35], v[64:67], v[104:107], v[32:35]
    v_mov_b64 v[20:21], s[54:55]
    v_mfma_f32_16x16x32_bf16 v[36:39], v[80:83], v[104:107], v[36:39]
    s_waitcnt lgkmcnt(4)
    v_mfma_f32_16x16x32_bf16 v[32:35], v[68:71], v[108:111], v[32:35]
    v_mov_b64 v[22:23], s[54:55]
    v_mfma_f32_16x16x32_bf16 v[36:39], v[84:87], v[108:111], v[36:39]
    s_waitcnt lgkmcnt(0)
    v_mfma_f32_16x16x32_bf16 v[40:43], v[0:3], v[96:99], 0
    v_mov_b32 v85, 0
    v_mov_b32 v86, 0
    v_mfma_f32_16x16x32_bf16 v[40:43], v[4:7], v[100:103], v[40:43]
    s_nop 1
    v_max3_f32 v126, v32, v33, v34
    v_max3_f32 v127, v36, v37, v38
    v_mfma_f32_16x16x32_bf16 v[40:43], v[8:11], v[104:107], v[40:43]
    v_max3_f32 v126, v126, v35, v39
    v_max_f32 v126, v126, v127
    v_mfma_f32_16x16x32_bf16 v[40:43], v[12:15], v[108:111], v[40:43]
    v_mov_b32 v127, v126
    v_smfmac_f32_16x16x64_bf16 v[48:51], v[28:31], v[184:191], v112
    s_nop 0
    v_permlane32_swap_b32 v126, v127
    v_smfmac_f32_16x16x64_bf16 v[52:55], v[28:31], v[248:255], v112
    v_max_f32 v126, v126, v127
    s_nop 1
    v_max3_f32 v127, v40, v41, v42
    v_max3_f32 v126, v127, v43, v126
    v_mov_b32 v127, v126
    v_mov_b64 v[56:57], 0
    v_mov_b64 v[58:59], 0
    v_permlane16_swap_b32 v126, v127
    v_max_f32 v126, v126, v127
    v_mul_f32_e64 v126, -s52, v126
    v_pk_fma_f32 v[40:41], v[40:41], s[52:53], v[126:127] op_sel:[0,0,0] op_sel_hi:[1,1,0]
    v_pk_fma_f32 v[32:33], v[32:33], s[52:53], v[126:127] op_sel:[0,0,0] op_sel_hi:[1,1,0]
    v_pk_fma_f32 v[34:35], v[34:35], s[52:53], v[126:127] op_sel:[0,0,0] op_sel_hi:[1,1,0]
    v_pk_fma_f32 v[36:37], v[36:37], s[52:53], v[126:127] op_sel:[0,0,0] op_sel_hi:[1,1,0]
    v_pk_fma_f32 v[38:39], v[38:39], s[52:53], v[126:127] op_sel:[0,0,0] op_sel_hi:[1,1,0]
    v_exp_f32 v40, v40
    v_exp_f32 v41, v41
    v_pk_add_f32 v[48:49], v[48:49], v[50:51]
    v_pk_add_f32 v[52:53], v[52:53], v[54:55]
    v_cvt_pk_bf16_f32 v84, v40, v41
    v_cvt_pk_bf16_f32 v87, v40, v41
    v_cvt_pk_bf16_f32 v50, v48, v49
    v_cvt_pk_bf16_f32 v51, v52, v53
    v_exp_f32 v32, v32
    v_mfma_f32_16x16x16_bf16 v[80:83], v[20:21], v[84:85], 0
    v_exp_f32 v33, v33
    v_mfma_f32_16x16x16_bf16 v[72:75], v[50:51], v[84:85], 0
    v_exp_f32 v34, v34
    v_mfma_f32_16x16x16_bf16 v[76:79], v[50:51], v[86:87], 0
    v_exp_f32 v35, v35
    v_cvt_pk_bf16_f32 v44, v32, v33
    v_exp_f32 v36, v36
    v_exp_f32 v37, v37
    v_cvt_pk_bf16_f32 v45, v34, v35
    v_exp_f32 v38, v38
    v_exp_f32 v39, v39
    v_cvt_pk_bf16_f32 v46, v36, v37
    v_cvt_pk_bf16_f32 v47, v38, v39
    v_lshrrev_b32 v127, 2, v124
    v_mov_b64 v[36:37], 0
    v_mfma_f32_16x16x32_bf16 v[80:83], v[20:23], v[44:47], v[80:83]
    v_mov_b64 v[38:39], 0
    v_mov_b64 v[40:41], 0
    v_mfma_f32_16x16x32_bf16 v[72:75], v[88:91], v[44:47], v[72:75]
    v_mov_b64 v[42:43], 0
    v_mov_b64 v[60:61], 0
    v_mfma_f32_16x16x32_bf16 v[76:79], v[92:95], v[44:47], v[76:79]
    v_mov_b64 v[62:63], 0
    v_mov_b64 v[96:97], 0
    v_rcp_f32 v126, v80
    v_mov_b64 v[98:99], 0
    v_mov_b64 v[100:101], 0
    v_pk_mul_f32 v[72:73], v[72:73], v[126:127] op_sel:[0,0] op_sel_hi:[1,0]
    v_pk_mul_f32 v[74:75], v[74:75], v[126:127] op_sel:[0,0] op_sel_hi:[1,0]
    v_cvt_pk_bf16_f32 v32, v72, v73
    v_cvt_pk_bf16_f32 v33, v74, v75
    v_pk_mul_f32 v[76:77], v[76:77], v[126:127] op_sel:[0,0] op_sel_hi:[1,0]
    v_pk_mul_f32 v[78:79], v[78:79], v[126:127] op_sel:[0,0] op_sel_hi:[1,0]
    v_cvt_pk_bf16_f32 v34, v76, v77
    v_cvt_pk_bf16_f32 v35, v78, v79
    ds_write_b128 v117, v[32:35]
    v_lshrrev_b32 v126, 2, v113
    v_add_u32 v127, v127, v126
    ds_write_b64 v127, v[50:51] offset:5120
    v_mov_b64 v[72:73], 0
    v_mov_b64 v[74:75], 0
    v_mov_b64 v[76:77], 0
    v_mov_b64 v[78:79], 0
    v_mov_b64 v[102:103], 0
    s_waitcnt lgkmcnt(1)
    s_barrier
    ds_read_b128 v[88:91], v113 offset:7168
    ds_read_b128 v[92:95], v113 offset:8192
    s_add_u32 s40, s38, 4096
    s_waitcnt lgkmcnt(1)
    v_smfmac_f32_16x16x64_bf16 v[36:39], v[88:91], a[0:7], v112
    s_mov_b32 m0, s62
    s_add_u32 s48, s44, 0x1000000
    buffer_load_dwordx4 v113, s[4:7], s44 offen lds
    v_smfmac_f32_16x16x64_bf16 v[40:43], v[88:91], a[64:71], v112
    buffer_load_dwordx4 v113, s[4:7], s44 offen offset:1024 lds
    s_add_u32 m0, s62, 8192
    s_add_u32 s44, s44, 0x40000
    s_waitcnt lgkmcnt(0)
    v_smfmac_f32_16x16x64_bf16 v[36:39], v[92:95], a[136:143], v112
    ds_read_b128 v[0:3], v118 offset:12288
    ds_read_b128 v[4:7], v118 offset:13312
    buffer_load_dwordx4 v113, s[4:7], s48 offen lds
    v_smfmac_f32_16x16x64_bf16 v[40:43], v[92:95], a[200:207], v112
    ds_read_b128 v[8:11], v118 offset:14336
    ds_read_b128 v[12:15], v118 offset:15360
    buffer_load_dwordx4 v113, s[4:7], s48 offen offset:1024 lds
    v_smfmac_f32_16x16x64_bf16 v[56:59], v[88:91], a[8:15], v112
    ds_read_b128 v[24:27], v119 offset:12288
    ds_read_b128 v[28:31], v119 offset:13312
    v_smfmac_f32_16x16x64_bf16 v[60:63], v[88:91], a[72:79], v112
    ds_read_b128 v[64:67], v119 offset:14336
    ds_read_b128 v[68:71], v119 offset:15360
    v_smfmac_f32_16x16x64_bf16 v[56:59], v[92:95], a[144:151], v112
    v_add_f32 v36, v36, v38
    v_add_f32 v37, v37, v39
    v_smfmac_f32_16x16x64_bf16 v[60:63], v[92:95], a[208:215], v112
    v_add_f32 v40, v40, v42
    v_add_f32 v41, v41, v43
    v_smfmac_f32_16x16x64_bf16 v[72:75], v[88:91], a[128:135], v112
    v_cvt_pk_bf16_f32 v32, v36, v40
    v_cvt_pk_bf16_f32 v33, v37, v41
    v_smfmac_f32_16x16x64_bf16 v[76:79], v[88:91], a[192:199], v112
    v_bfi_b32 v32, 1, s47, v32
    v_smfmac_f32_16x16x64_bf16 v[72:75], v[92:95], a[152:159], v112
    v_add_f32 v56, v56, v58
    v_add_f32 v57, v57, v59
    v_smfmac_f32_16x16x64_bf16 v[76:79], v[92:95], a[216:223], v112
    v_add_f32 v60, v60, v62
    v_add_f32 v61, v61, v63
    s_waitcnt lgkmcnt(0)
    v_smfmac_f32_16x16x64_bf16 v[96:99], v[88:91], v[0:7], v112
    v_cvt_pk_bf16_f32 v34, v56, v60
    v_cvt_pk_bf16_f32 v35, v57, v61
    v_smfmac_f32_16x16x64_bf16 v[100:103], v[88:91], v[8:15], v112
    v_bfi_b32 v34, 1, s47, v34
    buffer_store_dwordx4 v[32:35], v120, s[4:7], s38 offen offset:0 sc1
    v_smfmac_f32_16x16x64_bf16 v[96:99], v[92:95], v[24:31], v112
    v_add_f32 v72, v72, v74
    v_add_f32 v73, v73, v75
    v_smfmac_f32_16x16x64_bf16 v[100:103], v[92:95], v[64:71], v112
    v_add_f32 v76, v76, v78
    v_add_f32 v77, v77, v79
    v_cvt_pk_bf16_f32 v44, v72, v76
    v_cvt_pk_bf16_f32 v45, v73, v77
    v_bfi_b32 v44, 1, s47, v44
    s_cmp_ge_u32 s33, 2
    v_pk_add_f32 v[96:97], v[96:97], v[98:99]
    s_nop 0
    v_pk_add_f32 v[100:101], v[100:101], v[102:103]
    v_cvt_pk_bf16_f32 v46, v96, v100
    v_cvt_pk_bf16_f32 v47, v97, v101
    v_bfi_b32 v46, 1, s47, v46
    buffer_store_dwordx4 v[44:47], v120, s[4:7], s38 offen offset:128 sc1
    s_cmp_lg_u32 s26, s22
    s_cbranch_scc1 L_ke_50
    s_waitcnt vmcnt(9)
    v_mov_b32 v104, v125
    v_bfe_u32 v105, v113, 6, 1
    v_lshl_add_u32 v105, v104, 1, v105
    v_bfe_u32 v106, v113, 7, 1
    v_lshl_add_u32 v105, v106, 5, v105
    v_cmp_le_u32 vcc, 16, v104
    v_mov_b32 v106, 64
    s_nop 0
    v_cndmask_b32 v105, v105, v106, vcc
    s_nop 1
    v_min_u32_dpp v105, v105, v105 row_ror:8 row_mask:0xf bank_mask:0xf
    s_nop 1
    v_min_u32_dpp v105, v105, v105 row_ror:4 row_mask:0xf bank_mask:0xf
    s_nop 1
    v_min_u32_dpp v105, v105, v105 row_ror:2 row_mask:0xf bank_mask:0xf
    s_nop 1
    v_min_u32_dpp v105, v105, v105 row_ror:1 row_mask:0xf bank_mask:0xf
    s_nop 0
    v_readfirstlane_b32 s21, v105
    s_nop 4
    s_branch L_ke2_51
L_ke_50:
    s_nop 7
    s_nop 7
    s_nop 7
L_ke2_51:
    s_add_u32 s23, s34, 8
    s_min_u32 s23, s23, 64
    s_cmp_lt_u32 s21, s23
    s_cselect_b32 s26, s22, 0x7f000000
    s_cmp_ge_u32 s33, 2
    v_mov_b64 v[32:33], 0
    v_mov_b64 v[34:35], 0
    v_mov_b64 v[36:37], 0
    v_mov_b64 v[38:39], 0
    s_cbranch_scc1 L_w23_42
    v_cndmask_b32 v40, 0, v123, s[16:17]
    v_cndmask_b32 v41, 0, v123, s[18:19]
    v_mov_b64 v[42:43], v[40:41]
    s_nop 7
    s_nop 7
    s_nop 7
    buffer_load_dwordx2 v[0:1], v121, s[4:7], s38 offen offset:0 sc1
    buffer_load_dwordx2 v[2:3], v121, s[4:7], s38 offen offset:1024 sc1
    buffer_load_dwordx2 v[4:5], v121, s[4:7], s38 offen offset:2048 sc1
    buffer_load_dwordx2 v[6:7], v121, s[4:7], s38 offen offset:3072 sc1
    buffer_load_dwordx2 v[8:9], v121, s[4:7], s40 offen offset:0 sc1
    buffer_load_dwordx2 v[10:11], v121, s[4:7], s40 offen offset:1024 sc1
    buffer_load_dwordx2 v[12:13], v121, s[4:7], s40 offen offset:2048 sc1
    buffer_load_dwordx2 v[14:15], v121, s[4:7], s40 offen offset:3072 sc1
    ds_read_b128 v[56:59], v118 offset:0
    ds_read_b128 v[60:63], v118 offset:1024
    ds_read_b128 v[64:67], v118 offset:2048
    ds_read_b128 v[68:71], v118 offset:3072
    ds_read_b128 v[72:75], v118 offset:4096
    ds_read_b128 v[76:79], v118 offset:5120
    ds_read_b128 v[80:83], v118 offset:6144
    ds_read_b128 v[84:87], v118 offset:7168
    buffer_load_dwordx2 v[16:17], v121, s[4:7], s38 offen offset:0 sc1
    buffer_load_dwordx2 v[18:19], v121, s[4:7], s38 offen offset:1024 sc1
    buffer_load_dwordx2 v[20:21], v121, s[4:7], s38 offen offset:2048 sc1
    buffer_load_dwordx2 v[22:23], v121, s[4:7], s38 offen offset:3072 sc1
    buffer_load_dwordx2 v[24:25], v121, s[4:7], s40 offen offset:0 sc1
    buffer_load_dwordx2 v[26:27], v121, s[4:7], s40 offen offset:1024 sc1
    buffer_load_dwordx2 v[28:29], v121, s[4:7], s40 offen offset:2048 sc1
    buffer_load_dwordx2 v[30:31], v121, s[4:7], s40 offen offset:3072 sc1
    ds_read_b128 v[88:91], v118 offset:8192
    ds_read_b128 v[92:95], v118 offset:9216
    ds_read_b128 v[96:99], v118 offset:10240
    ds_read_b128 v[100:103], v118 offset:11264
    s_waitcnt lgkmcnt(8)
    ds_read_b128 v[104:107], v119 offset:0
    ds_read_b128 v[108:111], v119 offset:1024
    ds_read_b128 v[48:51], v119 offset:2048
    ds_read_b128 v[52:55], v119 offset:3072
    s_branch L_rec_38
L_w23_42:
    ds_read_b128 v[56:59], v118 offset:0
    ds_read_b128 v[60:63], v118 offset:1024
    ds_read_b128 v[64:67], v118 offset:2048
    ds_read_b128 v[68:71], v118 offset:3072
    ds_read_b128 v[72:75], v118 offset:4096
    ds_read_b128 v[76:79], v118 offset:5120
    ds_read_b128 v[80:83], v118 offset:6144
    ds_read_b128 v[84:87], v118 offset:7168
    ds_read_b128 v[88:91], v118 offset:8192
    ds_read_b128 v[92:95], v118 offset:9216
    ds_read_b128 v[96:99], v118 offset:10240
    ds_read_b128 v[100:103], v118 offset:11264
    s_waitcnt lgkmcnt(8)
    ds_read_b128 v[104:107], v119 offset:0
    ds_read_b128 v[108:111], v119 offset:1024
    ds_read_b128 v[48:51], v119 offset:2048
    ds_read_b128 v[52:55], v119 offset:3072
    s_branch L_bh_41
L_pslow_44:
    s_waitcnt vmcnt(6)
    v_mfma_f32_16x16x32_bf16 v[44:47], v[40:43], v[16:19], 0
    v_bitop3_b32 v126, v16, v18, s47 bitop3:0x7e
    s_waitcnt vmcnt(4)
    v_mfma_f32_16x16x32_bf16 v[44:47], v[40:43], v[20:23], v[44:47]
    v_bitop3_b32 v127, v20, v22, s47 bitop3:0x7e
    v_or_b32 v126, v126, v127
    s_waitcnt vmcnt(2)
    v_mfma_f32_16x16x32_bf16 v[44:47], v[40:43], v[24:27], v[44:47]
    v_bitop3_b32 v127, v24, v26, s47 bitop3:0x7e
    v_or_b32 v126, v126, v127
    s_waitcnt vmcnt(0)
    v_mfma_f32_16x16x32_bf16 v[44:47], v[40:43], v[28:31], v[44:47]
    v_bitop3_b32 v127, v28, v30, s47 bitop3:0x7e
    v_or_b32 v126, v126, v127
    v_and_b32 v126, 1, v126
    v_cmp_eq_u32 vcc, 1, v126
    s_cbranch_vccz L_red_40
    buffer_load_dwordx2 v[0:1], v121, s[4:7], s38 offen offset:0 sc1
    buffer_load_dwordx2 v[2:3], v121, s[4:7], s38 offen offset:1024 sc1
    buffer_load_dwordx2 v[4:5], v121, s[4:7], s38 offen offset:2048 sc1
    buffer_load_dwordx2 v[6:7], v121, s[4:7], s38 offen offset:3072 sc1
    buffer_load_dwordx2 v[8:9], v121, s[4:7], s40 offen offset:0 sc1
    buffer_load_dwordx2 v[10:11], v121, s[4:7], s40 offen offset:1024 sc1
    buffer_load_dwordx2 v[12:13], v121, s[4:7], s40 offen offset:2048 sc1
    buffer_load_dwordx2 v[14:15], v121, s[4:7], s40 offen offset:3072 sc1
    s_sub_u32 s35, s35, 1
    s_cbranch_scc1 L_tdone_20
    s_nop 7
    s_nop 7
    s_nop 7
    buffer_load_dwordx2 v[16:17], v121, s[4:7], s38 offen offset:0 sc1
    buffer_load_dwordx2 v[18:19], v121, s[4:7], s38 offen offset:1024 sc1
    buffer_load_dwordx2 v[20:21], v121, s[4:7], s38 offen offset:2048 sc1
    buffer_load_dwordx2 v[22:23], v121, s[4:7], s38 offen offset:3072 sc1
    buffer_load_dwordx2 v[24:25], v121, s[4:7], s40 offen offset:0 sc1
    buffer_load_dwordx2 v[26:27], v121, s[4:7], s40 offen offset:1024 sc1
    buffer_load_dwordx2 v[28:29], v121, s[4:7], s40 offen offset:2048 sc1
    buffer_load_dwordx2 v[30:31], v121, s[4:7], s40 offen offset:3072 sc1
    s_branch L_rec_38
L_aslow_45:
    buffer_load_dwordx4 v[0:3], v113, s[4:7], s41 offen offset:0 sc1
    buffer_load_dwordx4 v[4:7], v113, s[4:7], s41 offen offset:1024 sc1
    v_mov_b64 v[32:33], 0
    v_mov_b64 v[34:35], 0
    v_mov_b64 v[36:37], 0
    v_mov_b64 v[38:39], 0
    s_waitcnt vmcnt(4)
    v_max3_u32 v8, v24, v25, v26
    v_max3_u32 v9, v27, v28, v29
    v_mov_b64 v[10:11], v[24:25]
    v_max3_u32 v8, v8, v30, v31
    v_max_u32 v8, v8, v9
    v_cmp_eq_u32 vcc, -1, v8
    s_cbranch_vccnz L_af_f_52
    v_mov_b64 v[0:1], v[24:25]
    v_mov_b64 v[2:3], v[26:27]
    v_mov_b64 v[4:5], v[28:29]
    v_mov_b64 v[6:7], v[30:31]
    s_nop 1
    s_branch L_afok_46
L_af_f_52:
    buffer_load_dwordx4 v[24:27], v113, s[4:7], s41 offen offset:0 sc1
    buffer_load_dwordx4 v[28:31], v113, s[4:7], s41 offen offset:1024 sc1
    s_waitcnt vmcnt(4)
    v_max3_u32 v8, v16, v17, v18
    v_max3_u32 v9, v19, v20, v21
    v_mov_b64 v[10:11], v[16:17]
    v_max3_u32 v8, v8, v22, v23
    v_max_u32 v8, v8, v9
    v_cmp_eq_u32 vcc, -1, v8
    s_cbranch_vccnz L_af_f_53
    v_mov_b64 v[0:1], v[16:17]
    v_mov_b64 v[2:3], v[18:19]
    v_mov_b64 v[4:5], v[20:21]
    v_mov_b64 v[6:7], v[22:23]
    s_nop 1
    s_branch L_afok_46
L_af_f_53:
    buffer_load_dwordx4 v[16:19], v113, s[4:7], s41 offen offset:0 sc1
    buffer_load_dwordx4 v[20:23], v113, s[4:7], s41 offen offset:1024 sc1
    s_sub_u32 s35, s35, 1
    s_cbranch_scc1 L_tdone_20
    s_branch L_afchk_47
L_kvc_48:
    s_cmp_eq_u32 s23, 64
    s_cbranch_scc1 L_kvr_49
L_kvw_54:
    v_lshrrev_b32 v49, 2, v113
    v_and_b32 v49, 0x7c, v49
    buffer_load_dword v48, v49, s[4:7], s22 offen sc1
    s_sub_u32 s35, s35, 1
    s_cbranch_scc1 L_tdone_20
    s_waitcnt vmcnt(0)
    v_bfe_u32 v49, v113, 6, 1
    v_lshl_add_u32 v49, v48, 1, v49
    v_bfe_u32 v50, v113, 7, 1
    v_lshl_add_u32 v49, v50, 5, v49
    v_cmp_le_u32 vcc, 16, v48
    v_mov_b32 v50, 64
    s_nop 0
    v_cndmask_b32 v49, v49, v50, vcc
    s_nop 1
    v_min_u32_dpp v49, v49, v49 row_ror:8 row_mask:0xf bank_mask:0xf
    s_nop 1
    v_min_u32_dpp v49, v49, v49 row_ror:4 row_mask:0xf bank_mask:0xf
    s_nop 1
    v_min_u32_dpp v49, v49, v49 row_ror:2 row_mask:0xf bank_mask:0xf
    s_nop 1
    v_min_u32_dpp v49, v49, v49 row_ror:1 row_mask:0xf bank_mask:0xf
    s_nop 0
    v_readfirstlane_b32 s21, v49
    s_nop 1
    s_cmp_le_u32 s21, s23
    s_nop 1
    s_cbranch_scc1 L_kvw_54
    s_branch L_kvr_49
L_fin_43:
    v_add_u32 v126, s20, v116
    ds_read_b128 v[96:99], v126
    v_smfmac_f32_16x16x64_bf16 v[52:55], v[12:15], v[216:223], v112
    v_smfmac_f32_16x16x64_bf16 v[48:51], v[16:19], v[160:167], v112
    v_smfmac_f32_16x16x64_bf16 v[52:55], v[16:19], v[224:231], v112
    v_smfmac_f32_16x16x64_bf16 v[48:51], v[20:23], v[168:175], v112
    v_smfmac_f32_16x16x64_bf16 v[52:55], v[20:23], v[232:239], v112
    v_smfmac_f32_16x16x64_bf16 v[48:51], v[24:27], v[176:183], v112
    v_smfmac_f32_16x16x64_bf16 v[52:55], v[24:27], v[240:247], v112
    v_smfmac_f32_16x16x64_bf16 v[48:51], v[28:31], v[184:191], v112
    v_smfmac_f32_16x16x64_bf16 v[52:55], v[28:31], v[248:255], v112
    v_lshrrev_b32 v127, 1, v113
    s_waitcnt lgkmcnt(0)
    buffer_store_dwordx4 v[96:99], v113, s[4:7], s45 offen sc1
    s_nop 3
    v_pk_add_f32 v[48:49], v[48:49], v[50:51]
    v_pk_add_f32 v[52:53], v[52:53], v[54:55]
    v_cvt_pk_bf16_f32 v50, v48, v49
    v_cvt_pk_bf16_f32 v51, v52, v53
    buffer_store_dwordx2 v[50:51], v127, s[4:7], s46 offen sc1
    v_mov_b32 v6, 65
    s_waitcnt vmcnt(0)
    s_mov_b64 exec, 1
    buffer_store_dword v6, off, s[4:7], s24 sc1
    s_mov_b64 exec, -1
    s_branch L_tdone_20
L_tdone_20:
    s_mov_b32 s34, 0
    v_lshrrev_b32 v0, 4, v113
    s_lshr_b32 s48, s34, 1
    s_lshl_b32 s48, s48, 3
    s_lshr_b32 s49, s32, 2
    s_add_u32 s48, s48, s49
    s_lshl_b32 s63, s48, 3
    s_and_b32 s48, s34, 1
    s_lshl_b32 s48, s48, 2
    s_and_b32 s49, s32, 3
    s_add_u32 s48, s48, s49
    s_add_u32 s63, s63, s48
    s_waitcnt vmcnt(0) lgkmcnt(0)
    s_barrier
    s_load_dwordx2 s[16:17], s[0:1], 80
    s_waitcnt lgkmcnt(0)
    s_mov_b32 s96, s16
    s_and_b32 s97, s17, 0xffff
    s_mov_b32 s98, 0x700000
    s_mov_b32 s99, 0x20000
    s_load_dwordx4 s[16:19], s[0:1], 88
    s_waitcnt lgkmcnt(0)
    v_lshrrev_b32 v144, 3, v0
    v_and_b32 v145, 7, v0
    v_lshrrev_b32 v146, 4, v0
    v_lshlrev_b32 v146, 1, v146
    v_xor_b32 v145, v145, v146
    v_lshlrev_b32 v145, 4, v145
    v_lshl_add_u32 v142, v144, 12, v145
    s_lshl_b32 s101, s33, 15
    s_lshr_b32 s48, s63, 3
    s_lshl_b32 s48, s48, 7
    s_add_u32 s101, s101, s48
    s_lshl_b32 s3, s33, 10
    s_add_u32 m0, s3, 73728
    s_add_u32 s48, s101, 0
    buffer_load_dwordx4 v142, s[96:99], s48 offen lds
    s_add_u32 m0, s3, 77824
    s_add_u32 s48, s101, 131072
    buffer_load_dwordx4 v142, s[96:99], s48 offen lds
    s_add_u32 m0, s3, 81920
    s_add_u32 s48, s101, 262144
    buffer_load_dwordx4 v142, s[96:99], s48 offen lds
    s_add_u32 m0, s3, 86016
    s_add_u32 s48, s101, 393216
    buffer_load_dwordx4 v142, s[96:99], s48 offen lds
    s_add_u32 m0, s3, 90112
    s_add_u32 s48, s101, 524288
    buffer_load_dwordx4 v142, s[96:99], s48 offen lds
    s_add_u32 m0, s3, 94208
    s_add_u32 s48, s101, 655360
    buffer_load_dwordx4 v142, s[96:99], s48 offen lds
    s_add_u32 m0, s3, 98304
    s_add_u32 s48, s101, 786432
    buffer_load_dwordx4 v142, s[96:99], s48 offen lds
    s_add_u32 m0, s3, 102400
    s_add_u32 s48, s101, 917504
    buffer_load_dwordx4 v142, s[96:99], s48 offen lds
    s_add_u32 m0, s3, 106496
    s_add_u32 s48, s101, 1048576
    buffer_load_dwordx4 v142, s[96:99], s48 offen lds
    s_add_u32 m0, s3, 110592
    s_add_u32 s48, s101, 1179648
    buffer_load_dwordx4 v142, s[96:99], s48 offen lds
    s_add_u32 m0, s3, 114688
    s_add_u32 s48, s101, 1310720
    buffer_load_dwordx4 v142, s[96:99], s48 offen lds
    s_add_u32 m0, s3, 118784
    s_add_u32 s48, s101, 1441792
    buffer_load_dwordx4 v142, s[96:99], s48 offen lds
    s_add_u32 m0, s3, 122880
    s_add_u32 s48, s101, 1572864
    buffer_load_dwordx4 v142, s[96:99], s48 offen lds
    s_add_u32 m0, s3, 126976
    s_add_u32 s48, s101, 1703936
    buffer_load_dwordx4 v142, s[96:99], s48 offen lds
    s_add_u32 m0, s3, 131072
    s_add_u32 s48, s101, 1835008
    buffer_load_dwordx4 v142, s[96:99], s48 offen lds
    s_add_u32 m0, s3, 135168
    s_add_u32 s48, s101, 1966080
    buffer_load_dwordx4 v142, s[96:99], s48 offen lds
    s_add_u32 m0, s3, 139264
    s_add_u32 s48, s101, 2097152
    buffer_load_dwordx4 v142, s[96:99], s48 offen lds
    s_add_u32 m0, s3, 143360
    s_add_u32 s48, s101, 2228224
    buffer_load_dwordx4 v142, s[96:99], s48 offen lds
    s_add_u32 m0, s3, 147456
    s_add_u32 s48, s101, 2359296
    buffer_load_dwordx4 v142, s[96:99], s48 offen lds
    s_add_u32 m0, s3, 151552
    s_add_u32 s48, s101, 2490368
    buffer_load_dwordx4 v142, s[96:99], s48 offen lds
    s_add_u32 m0, s3, 0
    s_add_u32 s48, s101, 6815744
    buffer_load_dwordx4 v142, s[96:99], s48 offen lds
    s_add_u32 m0, s3, 4096
    s_add_u32 s48, s101, 6946816
    buffer_load_dwordx4 v142, s[96:99], s48 offen lds
    s_add_u32 m0, s3, 8192
    s_add_u32 s48, s101, 7077888
    buffer_load_dwordx4 v142, s[96:99], s48 offen lds
    s_add_u32 m0, s3, 12288
    s_add_u32 s48, s101, 7208960
    buffer_load_dwordx4 v142, s[96:99], s48 offen lds
    s_mov_b32 s62, 0
    s_branch L_g2_12
L_tok_11:
    s_lshr_b32 s48, s34, 1
    s_lshl_b32 s48, s48, 3
    s_lshr_b32 s49, s32, 2
    s_add_u32 s48, s48, s49
    s_lshl_b32 s63, s48, 3
    s_and_b32 s48, s34, 1
    s_lshl_b32 s48, s48, 2
    s_and_b32 s49, s32, 3
    s_add_u32 s48, s48, s49
    s_add_u32 s63, s63, s48
    s_sub_u32 s34, s34, 1
    s_lshl_b32 s100, s34, 5
    s_add_u32 s100, s100, s32
    s_mov_b32 s44, 0
    s_cmp_ge_u32 s34, 2
    s_cbranch_scc1 L_lt_57
    s_lshl_b32 s42, s32, 7
    s_lshl_b32 s48, s34, 4
    s_add_u32 s42, s42, s48
    s_lshl_b32 s48, s33, 2
    s_add_u32 s42, s42, s48
    s_add_u32 s42, s42, 0x3f80000
    v_mov_b32 v22, 0
    s_mov_b64 exec, 1
    buffer_store_dword v22, off, s[4:7], s42 sc1
    s_mov_b64 exec, -1
    s_cmp_lg_u32 s100, 64
    s_cbranch_scc1 L_nz_58
    v_lshlrev_b32 v23, 4, v0
    v_mov_b32 v16, 0
    v_mov_b32 v17, 0
    v_mov_b32 v18, 0
    v_mov_b32 v19, 0
    s_mul_i32 s48, s33, 6144
    s_add_u32 s48, s48, 0x3f84000
    s_add_u32 s49, s48, 4096
    buffer_store_dwordx4 v[16:19], v23, s[4:7], s48 offen offset:0 sc1
    buffer_store_dwordx4 v[16:19], v23, s[4:7], s48 offen offset:1024 sc1
    buffer_store_dwordx4 v[16:19], v23, s[4:7], s48 offen offset:2048 sc1
    buffer_store_dwordx4 v[16:19], v23, s[4:7], s48 offen offset:3072 sc1
    buffer_store_dwordx4 v[16:19], v23, s[4:7], s49 offen sc1
    buffer_store_dwordx4 v[16:19], v23, s[4:7], s49 offen offset:1024 sc1
    s_nop 1
L_nz_58:
    s_branch L_st_56
L_lt_57:
    s_lshl_b32 s42, s32, 7
    s_lshl_b32 s48, s34, 4
    s_add_u32 s42, s42, s48
    s_lshl_b32 s48, s33, 2
    s_add_u32 s42, s42, s48
    s_add_u32 s42, s42, 0x3f80000
    v_mov_b32 v22, 0
    s_mov_b64 exec, 1
    buffer_store_dword v22, off, s[4:7], s42 sc1
    s_mov_b64 exec, -1
    s_cmp_lg_u32 s100, 64
    s_cbranch_scc1 L_nz_59
    v_lshlrev_b32 v23, 4, v0
    v_mov_b32 v16, 0
    v_mov_b32 v17, 0
    v_mov_b32 v18, 0
    v_mov_b32 v19, 0
    s_mul_i32 s48, s33, 6144
    s_add_u32 s48, s48, 0x3f84000
    s_add_u32 s49, s48, 4096
    buffer_store_dwordx4 v[16:19], v23, s[4:7], s48 offen offset:0 sc1
    buffer_store_dwordx4 v[16:19], v23, s[4:7], s48 offen offset:1024 sc1
    buffer_store_dwordx4 v[16:19], v23, s[4:7], s48 offen offset:2048 sc1
    buffer_store_dwordx4 v[16:19], v23, s[4:7], s48 offen offset:3072 sc1
    buffer_store_dwordx4 v[16:19], v23, s[4:7], s49 offen sc1
    buffer_store_dwordx4 v[16:19], v23, s[4:7], s49 offen offset:1024 sc1
    s_nop 1
L_nz_59:
    s_waitcnt vmcnt(0)
    s_barrier
    s_cmp_lg_u32 s33, 0
    s_cbranch_scc1 L_na_60
    v_mov_b32 v23, 1
    s_mov_b64 exec, 1
    buffer_atomic_add v23, off, s[84:87], 0 offset:128
    s_mov_b64 exec, -1
L_na_60:
    s_cmp_lg_u32 s33, 0
    s_cbranch_scc1 L_wgp_62
L_poll_63:
    buffer_load_dword v2, off, s[84:87], 0 offset:128 sc1
    s_sub_u32 s35, s35, 1
    s_cbranch_scc1 L_exit_1
    s_waitcnt vmcnt(0)
    v_readfirstlane_b32 s48, v2
    s_nop 1
    s_cmp_eq_u32 s48, 256
    s_cbranch_scc1 L_pd_64
    s_sleep 100
    s_branch L_poll_63
L_pd_64:
L_wgp_62:
    s_barrier
    s_cmp_ge_u32 s34, 4
    s_cbranch_scc1 L_nost_61
    s_cmp_lg_u32 s33, 0
    s_cbranch_scc1 L_sd_66
    s_cmp_eq_u32 s34, 3
    s_cselect_b32 s49, 4, 1
    s_lshl_b32 s50, s32, 6
    s_add_u32 s50, s50, 0x3f83000
L_sg_65:
    buffer_load_dword v2, off, s[4:7], s50 sc1
    s_sub_u32 s35, s35, 1
    s_cbranch_scc1 L_exit_1
    s_waitcnt vmcnt(0)
    v_readfirstlane_b32 s48, v2
    s_nop 1
    s_cmp_ge_u32 s48, s49
    s_cbranch_scc1 L_sd_66
    s_sleep 40
    s_branch L_sg_65
L_sd_66:
    s_barrier
    s_mov_b32 s44, 1
L_st_56:
    v_and_b32 v3, 15, v0
    v_lshrrev_b32 v2, 4, v0
    s_lshr_b32 s48, s33, 1
    s_lshl_b32 s48, s48, 2
    v_or_b32 v6, s48, v2
    v_lshlrev_b32 v6, 1, v6
    v_xor_b32 v6, v6, v3
    v_lshlrev_b32 v6, 4, v6
    v_lshl_add_u32 v4, v2, 13, v6
    v_lshrrev_b32 v6, 2, v3
    v_and_b32 v7, 3, v3
    v_lshl_add_u32 v8, v2, 3, v6
    v_and_b32 v9, 1, v2
    v_lshl_add_u32 v9, v9, 2, v6
    s_lshl_b32 s48, s33, 1
    v_xor_b32 v9, s48, v9
    v_lshlrev_b32 v10, 8, v8
    v_lshl_add_u32 v10, v9, 5, v10
    v_lshl_add_u32 v10, v7, 3, v10
    v_xor_b32 v11, 32, v10
    v_add_u32 v12, 65536, v10
    v_add_u32 v13, 65536, v11
    s_mov_b32 s8, s22
    s_and_b32 s9, s23, 0xffff
    s_mov_b32 s10, 0x400000
    s_mov_b32 s11, 0x20000
    s_lshl_b32 s48, s33, 15
    s_lshl_b32 s49, s32, 8
    s_add_u32 s48, s48, s49
    s_add_u32 s48, s48, 0
    s_lshl_b32 s49, s33, 10
    s_add_u32 s49, s49, 0
    s_mov_b32 m0, s49
    s_nop 0
    buffer_load_dwordx4 v4, s[8:11], s48 offen lds
    s_add_u32 s48, s48, 131072
    s_add_u32 s49, s49, 4096
    s_mov_b32 m0, s49
    s_nop 0
    buffer_load_dwordx4 v4, s[8:11], s48 offen lds
    s_add_u32 s48, s48, 131072
    s_add_u32 s49, s49, 4096
    s_mov_b32 m0, s49
    s_nop 0
    buffer_load_dwordx4 v4, s[8:11], s48 offen lds
    s_add_u32 s48, s48, 131072
    s_add_u32 s49, s49, 4096
    s_mov_b32 m0, s49
    s_nop 0
    buffer_load_dwordx4 v4, s[8:11], s48 offen lds
    s_add_u32 s48, s48, 131072
    s_add_u32 s49, s49, 4096
    s_mov_b32 m0, s49
    s_nop 0
    buffer_load_dwordx4 v4, s[8:11], s48 offen lds
    s_add_u32 s48, s48, 131072
    s_add_u32 s49, s49, 4096
    s_mov_b32 m0, s49
    s_nop 0
    buffer_load_dwordx4 v4, s[8:11], s48 offen lds
    s_add_u32 s48, s48, 131072
    s_add_u32 s49, s49, 4096
    s_mov_b32 m0, s49
    s_nop 0
    buffer_load_dwordx4 v4, s[8:11], s48 offen lds
    s_add_u32 s48, s48, 131072
    s_add_u32 s49, s49, 4096
    s_mov_b32 m0, s49
    s_nop 0
    buffer_load_dwordx4 v4, s[8:11], s48 offen lds
    s_add_u32 s48, s48, 131072
    s_add_u32 s49, s49, 4096
    s_mov_b32 m0, s49
    s_nop 0
    buffer_load_dwordx4 v4, s[8:11], s48 offen lds
    s_add_u32 s48, s48, 131072
    s_add_u32 s49, s49, 4096
    s_mov_b32 m0, s49
    s_nop 0
    buffer_load_dwordx4 v4, s[8:11], s48 offen lds
    s_add_u32 s48, s48, 131072
    s_add_u32 s49, s49, 4096
    s_mov_b32 m0, s49
    s_nop 0
    buffer_load_dwordx4 v4, s[8:11], s48 offen lds
    s_add_u32 s48, s48, 131072
    s_add_u32 s49, s49, 4096
    s_mov_b32 m0, s49
    s_nop 0
    buffer_load_dwordx4 v4, s[8:11], s48 offen lds
    s_add_u32 s48, s48, 131072
    s_add_u32 s49, s49, 4096
    s_mov_b32 m0, s49
    s_nop 0
    buffer_load_dwordx4 v4, s[8:11], s48 offen lds
    s_add_u32 s48, s48, 131072
    s_add_u32 s49, s49, 4096
    s_mov_b32 m0, s49
    s_nop 0
    buffer_load_dwordx4 v4, s[8:11], s48 offen lds
    s_add_u32 s48, s48, 131072
    s_add_u32 s49, s49, 4096
    s_mov_b32 m0, s49
    s_nop 0
    buffer_load_dwordx4 v4, s[8:11], s48 offen lds
    s_add_u32 s48, s48, 131072
    s_add_u32 s49, s49, 4096
    s_mov_b32 m0, s49
    s_nop 0
    buffer_load_dwordx4 v4, s[8:11], s48 offen lds
    s_mov_b32 s8, s22
    s_and_b32 s9, s23, 0xffff
    s_mov_b32 s10, 0x400000
    s_mov_b32 s11, 0x20000
    s_lshl_b32 s48, s33, 15
    s_lshl_b32 s49, s32, 8
    s_add_u32 s48, s48, s49
    s_add_u32 s48, s48, 2097152
    s_lshl_b32 s49, s33, 10
    s_add_u32 s49, s49, 65536
    s_mov_b32 m0, s49
    s_nop 0
    buffer_load_dwordx4 v4, s[8:11], s48 offen lds
    s_add_u32 s48, s48, 131072
    s_add_u32 s49, s49, 4096
    s_mov_b32 m0, s49
    s_nop 0
    buffer_load_dwordx4 v4, s[8:11], s48 offen lds
    s_add_u32 s48, s48, 131072
    s_add_u32 s49, s49, 4096
    s_mov_b32 m0, s49
    s_nop 0
    buffer_load_dwordx4 v4, s[8:11], s48 offen lds
    s_add_u32 s48, s48, 131072
    s_add_u32 s49, s49, 4096
    s_mov_b32 m0, s49
    s_nop 0
    buffer_load_dwordx4 v4, s[8:11], s48 offen lds
    s_add_u32 s48, s48, 131072
    s_add_u32 s49, s49, 4096
    s_mov_b32 m0, s49
    s_nop 0
    buffer_load_dwordx4 v4, s[8:11], s48 offen lds
    s_add_u32 s48, s48, 131072
    s_add_u32 s49, s49, 4096
    s_mov_b32 m0, s49
    s_nop 0
    buffer_load_dwordx4 v4, s[8:11], s48 offen lds
    s_add_u32 s48, s48, 131072
    s_add_u32 s49, s49, 4096
    s_mov_b32 m0, s49
    s_nop 0
    buffer_load_dwordx4 v4, s[8:11], s48 offen lds
    s_add_u32 s48, s48, 131072
    s_add_u32 s49, s49, 4096
    s_mov_b32 m0, s49
    s_nop 0
    buffer_load_dwordx4 v4, s[8:11], s48 offen lds
    s_add_u32 s48, s48, 131072
    s_add_u32 s49, s49, 4096
    s_mov_b32 m0, s49
    s_nop 0
    buffer_load_dwordx4 v4, s[8:11], s48 offen lds
    s_add_u32 s48, s48, 131072
    s_add_u32 s49, s49, 4096
    s_mov_b32 m0, s49
    s_nop 0
    buffer_load_dwordx4 v4, s[8:11], s48 offen lds
    s_add_u32 s48, s48, 131072
    s_add_u32 s49, s49, 4096
    s_mov_b32 m0, s49
    s_nop 0
    buffer_load_dwordx4 v4, s[8:11], s48 offen lds
    s_add_u32 s48, s48, 131072
    s_add_u32 s49, s49, 4096
    s_mov_b32 m0, s49
    s_nop 0
    buffer_load_dwordx4 v4, s[8:11], s48 offen lds
    s_add_u32 s48, s48, 131072
    s_add_u32 s49, s49, 4096
    s_mov_b32 m0, s49
    s_nop 0
    buffer_load_dwordx4 v4, s[8:11], s48 offen lds
    s_add_u32 s48, s48, 131072
    s_add_u32 s49, s49, 4096
    s_mov_b32 m0, s49
    s_nop 0
    buffer_load_dwordx4 v4, s[8:11], s48 offen lds
    s_add_u32 s48, s48, 131072
    s_add_u32 s49, s49, 4096
    s_mov_b32 m0, s49
    s_nop 0
    buffer_load_dwordx4 v4, s[8:11], s48 offen lds
    s_add_u32 s48, s48, 131072
    s_add_u32 s49, s49, 4096
    s_mov_b32 m0, s49
    s_nop 0
    buffer_load_dwordx4 v4, s[8:11], s48 offen lds
    s_waitcnt vmcnt(16)
    s_barrier
    s_cmp_eq_u32 s44, 1
    s_cbranch_scc1 L_hk_67
    s_cmp_lg_u32 s33, 0
    s_cbranch_scc1 L_na_68
    v_mov_b32 v23, 1
    s_mov_b64 exec, 1
    buffer_atomic_add v23, off, s[84:87], 0 offset:128
    s_mov_b64 exec, -1
L_na_68:
L_hk_67:
    ds_read_b64_tr_b16 a[128:129], v10 offset:0
    ds_read_b64_tr_b16 a[130:131], v10 offset:1024
    ds_read_b64_tr_b16 a[132:133], v10 offset:8192
    ds_read_b64_tr_b16 a[134:135], v10 offset:9216
    ds_read_b64_tr_b16 a[136:137], v10 offset:16384
    ds_read_b64_tr_b16 a[138:139], v10 offset:17408
    ds_read_b64_tr_b16 a[140:141], v10 offset:24576
    ds_read_b64_tr_b16 a[142:143], v10 offset:25600
    ds_read_b64_tr_b16 a[144:145], v10 offset:32768
    ds_read_b64_tr_b16 a[146:147], v10 offset:33792
    ds_read_b64_tr_b16 a[148:149], v10 offset:40960
    ds_read_b64_tr_b16 a[150:151], v10 offset:41984
    s_waitcnt lgkmcnt(8)
    ds_read_b64_tr_b16 a[152:153], v10 offset:49152
    ds_read_b64_tr_b16 a[154:155], v10 offset:50176
    ds_read_b64_tr_b16 a[156:157], v10 offset:57344
    ds_read_b64_tr_b16 a[158:159], v10 offset:58368
    s_waitcnt lgkmcnt(8)
    ds_read_b64_tr_b16 a[192:193], v11 offset:0
    ds_read_b64_tr_b16 a[194:195], v11 offset:1024
    ds_read_b64_tr_b16 a[196:197], v11 offset:8192
    ds_read_b64_tr_b16 a[198:199], v11 offset:9216
    s_waitcnt lgkmcnt(8)
    ds_read_b64_tr_b16 a[200:201], v11 offset:16384
    ds_read_b64_tr_b16 a[202:203], v11 offset:17408
    ds_read_b64_tr_b16 a[204:205], v11 offset:24576
    ds_read_b64_tr_b16 a[206:207], v11 offset:25600
    s_waitcnt lgkmcnt(8)
    ds_read_b64_tr_b16 a[208:209], v11 offset:32768
    ds_read_b64_tr_b16 a[210:211], v11 offset:33792
    ds_read_b64_tr_b16 a[212:213], v11 offset:40960
    ds_read_b64_tr_b16 a[214:215], v11 offset:41984
    s_waitcnt lgkmcnt(8)
    ds_read_b64_tr_b16 a[216:217], v11 offset:49152
    ds_read_b64_tr_b16 a[218:219], v11 offset:50176
    ds_read_b64_tr_b16 a[220:221], v11 offset:57344
    ds_read_b64_tr_b16 a[222:223], v11 offset:58368
    s_waitcnt lgkmcnt(0)
    s_barrier
    s_mov_b32 s8, s24
    s_and_b32 s9, s25, 0xffff
    s_mov_b32 s10, 0x400000
    s_mov_b32 s11, 0x20000
    s_lshl_b32 s48, s33, 15
    s_lshl_b32 s49, s32, 8
    s_add_u32 s48, s48, s49
    s_add_u32 s48, s48, 0
    s_lshl_b32 s49, s33, 10
    s_add_u32 s49, s49, 0
    s_mov_b32 m0, s49
    s_nop 0
    buffer_load_dwordx4 v4, s[8:11], s48 offen lds
    s_add_u32 s48, s48, 131072
    s_add_u32 s49, s49, 4096
    s_mov_b32 m0, s49
    s_nop 0
    buffer_load_dwordx4 v4, s[8:11], s48 offen lds
    s_add_u32 s48, s48, 131072
    s_add_u32 s49, s49, 4096
    s_mov_b32 m0, s49
    s_nop 0
    buffer_load_dwordx4 v4, s[8:11], s48 offen lds
    s_add_u32 s48, s48, 131072
    s_add_u32 s49, s49, 4096
    s_mov_b32 m0, s49
    s_nop 0
    buffer_load_dwordx4 v4, s[8:11], s48 offen lds
    s_add_u32 s48, s48, 131072
    s_add_u32 s49, s49, 4096
    s_mov_b32 m0, s49
    s_nop 0
    buffer_load_dwordx4 v4, s[8:11], s48 offen lds
    s_add_u32 s48, s48, 131072
    s_add_u32 s49, s49, 4096
    s_mov_b32 m0, s49
    s_nop 0
    buffer_load_dwordx4 v4, s[8:11], s48 offen lds
    s_add_u32 s48, s48, 131072
    s_add_u32 s49, s49, 4096
    s_mov_b32 m0, s49
    s_nop 0
    buffer_load_dwordx4 v4, s[8:11], s48 offen lds
    s_add_u32 s48, s48, 131072
    s_add_u32 s49, s49, 4096
    s_mov_b32 m0, s49
    s_nop 0
    buffer_load_dwordx4 v4, s[8:11], s48 offen lds
    s_add_u32 s48, s48, 131072
    s_add_u32 s49, s49, 4096
    s_mov_b32 m0, s49
    s_nop 0
    buffer_load_dwordx4 v4, s[8:11], s48 offen lds
    s_add_u32 s48, s48, 131072
    s_add_u32 s49, s49, 4096
    s_mov_b32 m0, s49
    s_nop 0
    buffer_load_dwordx4 v4, s[8:11], s48 offen lds
    s_add_u32 s48, s48, 131072
    s_add_u32 s49, s49, 4096
    s_mov_b32 m0, s49
    s_nop 0
    buffer_load_dwordx4 v4, s[8:11], s48 offen lds
    s_add_u32 s48, s48, 131072
    s_add_u32 s49, s49, 4096
    s_mov_b32 m0, s49
    s_nop 0
    buffer_load_dwordx4 v4, s[8:11], s48 offen lds
    s_add_u32 s48, s48, 131072
    s_add_u32 s49, s49, 4096
    s_mov_b32 m0, s49
    s_nop 0
    buffer_load_dwordx4 v4, s[8:11], s48 offen lds
    s_add_u32 s48, s48, 131072
    s_add_u32 s49, s49, 4096
    s_mov_b32 m0, s49
    s_nop 0
    buffer_load_dwordx4 v4, s[8:11], s48 offen lds
    s_add_u32 s48, s48, 131072
    s_add_u32 s49, s49, 4096
    s_mov_b32 m0, s49
    s_nop 0
    buffer_load_dwordx4 v4, s[8:11], s48 offen lds
    s_add_u32 s48, s48, 131072
    s_add_u32 s49, s49, 4096
    s_mov_b32 m0, s49
    s_nop 0
    buffer_load_dwordx4 v4, s[8:11], s48 offen lds
    s_waitcnt vmcnt(16)
    s_barrier
    ds_read_b64_tr_b16 a[160:161], v12 offset:0
    ds_read_b64_tr_b16 a[162:163], v12 offset:1024
    ds_read_b64_tr_b16 a[164:165], v12 offset:8192
    ds_read_b64_tr_b16 a[166:167], v12 offset:9216
    ds_read_b64_tr_b16 a[168:169], v12 offset:16384
    ds_read_b64_tr_b16 a[170:171], v12 offset:17408
    ds_read_b64_tr_b16 a[172:173], v12 offset:24576
    ds_read_b64_tr_b16 a[174:175], v12 offset:25600
    ds_read_b64_tr_b16 a[176:177], v12 offset:32768
    ds_read_b64_tr_b16 a[178:179], v12 offset:33792
    ds_read_b64_tr_b16 a[180:181], v12 offset:40960
    ds_read_b64_tr_b16 a[182:183], v12 offset:41984
    s_waitcnt lgkmcnt(8)
    ds_read_b64_tr_b16 a[184:185], v12 offset:49152
    ds_read_b64_tr_b16 a[186:187], v12 offset:50176
    ds_read_b64_tr_b16 a[188:189], v12 offset:57344
    ds_read_b64_tr_b16 a[190:191], v12 offset:58368
    s_waitcnt lgkmcnt(8)
    ds_read_b64_tr_b16 a[224:225], v13 offset:0
    ds_read_b64_tr_b16 a[226:227], v13 offset:1024
    ds_read_b64_tr_b16 a[228:229], v13 offset:8192
    ds_read_b64_tr_b16 a[230:231], v13 offset:9216
    s_waitcnt lgkmcnt(8)
    ds_read_b64_tr_b16 a[232:233], v13 offset:16384
    ds_read_b64_tr_b16 a[234:235], v13 offset:17408
    ds_read_b64_tr_b16 a[236:237], v13 offset:24576
    ds_read_b64_tr_b16 a[238:239], v13 offset:25600
    s_waitcnt lgkmcnt(8)
    ds_read_b64_tr_b16 a[240:241], v13 offset:32768
    ds_read_b64_tr_b16 a[242:243], v13 offset:33792
    ds_read_b64_tr_b16 a[244:245], v13 offset:40960
    ds_read_b64_tr_b16 a[246:247], v13 offset:41984
    s_waitcnt lgkmcnt(8)
    ds_read_b64_tr_b16 a[248:249], v13 offset:49152
    ds_read_b64_tr_b16 a[250:251], v13 offset:50176
    ds_read_b64_tr_b16 a[252:253], v13 offset:57344
    ds_read_b64_tr_b16 a[254:255], v13 offset:58368
    s_waitcnt lgkmcnt(0)
    s_barrier
    s_mov_b32 s8, s24
    s_and_b32 s9, s25, 0xffff
    s_mov_b32 s10, 0x400000
    s_mov_b32 s11, 0x20000
    s_lshl_b32 s48, s33, 15
    s_lshl_b32 s49, s32, 8
    s_add_u32 s48, s48, s49
    s_add_u32 s48, s48, 2097152
    s_lshl_b32 s49, s33, 10
    s_add_u32 s49, s49, 65536
    s_mov_b32 m0, s49
    s_nop 0
    buffer_load_dwordx4 v4, s[8:11], s48 offen lds
    s_add_u32 s48, s48, 131072
    s_add_u32 s49, s49, 4096
    s_mov_b32 m0, s49
    s_nop 0
    buffer_load_dwordx4 v4, s[8:11], s48 offen lds
    s_add_u32 s48, s48, 131072
    s_add_u32 s49, s49, 4096
    s_mov_b32 m0, s49
    s_nop 0
    buffer_load_dwordx4 v4, s[8:11], s48 offen lds
    s_add_u32 s48, s48, 131072
    s_add_u32 s49, s49, 4096
    s_mov_b32 m0, s49
    s_nop 0
    buffer_load_dwordx4 v4, s[8:11], s48 offen lds
    s_add_u32 s48, s48, 131072
    s_add_u32 s49, s49, 4096
    s_mov_b32 m0, s49
    s_nop 0
    buffer_load_dwordx4 v4, s[8:11], s48 offen lds
    s_add_u32 s48, s48, 131072
    s_add_u32 s49, s49, 4096
    s_mov_b32 m0, s49
    s_nop 0
    buffer_load_dwordx4 v4, s[8:11], s48 offen lds
    s_add_u32 s48, s48, 131072
    s_add_u32 s49, s49, 4096
    s_mov_b32 m0, s49
    s_nop 0
    buffer_load_dwordx4 v4, s[8:11], s48 offen lds
    s_add_u32 s48, s48, 131072
    s_add_u32 s49, s49, 4096
    s_mov_b32 m0, s49
    s_nop 0
    buffer_load_dwordx4 v4, s[8:11], s48 offen lds
    s_add_u32 s48, s48, 131072
    s_add_u32 s49, s49, 4096
    s_mov_b32 m0, s49
    s_nop 0
    buffer_load_dwordx4 v4, s[8:11], s48 offen lds
    s_add_u32 s48, s48, 131072
    s_add_u32 s49, s49, 4096
    s_mov_b32 m0, s49
    s_nop 0
    buffer_load_dwordx4 v4, s[8:11], s48 offen lds
    s_add_u32 s48, s48, 131072
    s_add_u32 s49, s49, 4096
    s_mov_b32 m0, s49
    s_nop 0
    buffer_load_dwordx4 v4, s[8:11], s48 offen lds
    s_add_u32 s48, s48, 131072
    s_add_u32 s49, s49, 4096
    s_mov_b32 m0, s49
    s_nop 0
    buffer_load_dwordx4 v4, s[8:11], s48 offen lds
    s_add_u32 s48, s48, 131072
    s_add_u32 s49, s49, 4096
    s_mov_b32 m0, s49
    s_nop 0
    buffer_load_dwordx4 v4, s[8:11], s48 offen lds
    s_add_u32 s48, s48, 131072
    s_add_u32 s49, s49, 4096
    s_mov_b32 m0, s49
    s_nop 0
    buffer_load_dwordx4 v4, s[8:11], s48 offen lds
    s_add_u32 s48, s48, 131072
    s_add_u32 s49, s49, 4096
    s_mov_b32 m0, s49
    s_nop 0
    buffer_load_dwordx4 v4, s[8:11], s48 offen lds
    s_add_u32 s48, s48, 131072
    s_add_u32 s49, s49, 4096
    s_mov_b32 m0, s49
    s_nop 0
    buffer_load_dwordx4 v4, s[8:11], s48 offen lds
    s_waitcnt vmcnt(16)
    s_barrier
    ds_read_b64_tr_b16 v[128:129], v10 offset:0
    ds_read_b64_tr_b16 v[130:131], v10 offset:1024
    ds_read_b64_tr_b16 v[132:133], v10 offset:8192
    ds_read_b64_tr_b16 v[134:135], v10 offset:9216
    ds_read_b64_tr_b16 v[136:137], v10 offset:16384
    ds_read_b64_tr_b16 v[138:139], v10 offset:17408
    ds_read_b64_tr_b16 v[140:141], v10 offset:24576
    ds_read_b64_tr_b16 v[142:143], v10 offset:25600
    ds_read_b64_tr_b16 v[144:145], v10 offset:32768
    ds_read_b64_tr_b16 v[146:147], v10 offset:33792
    ds_read_b64_tr_b16 v[148:149], v10 offset:40960
    ds_read_b64_tr_b16 v[150:151], v10 offset:41984
    s_waitcnt lgkmcnt(8)
    ds_read_b64_tr_b16 v[152:153], v10 offset:49152
    ds_read_b64_tr_b16 v[154:155], v10 offset:50176
    ds_read_b64_tr_b16 v[156:157], v10 offset:57344
    ds_read_b64_tr_b16 v[158:159], v10 offset:58368
    s_waitcnt lgkmcnt(8)
    ds_read_b64_tr_b16 v[192:193], v11 offset:0
    ds_read_b64_tr_b16 v[194:195], v11 offset:1024
    ds_read_b64_tr_b16 v[196:197], v11 offset:8192
    ds_read_b64_tr_b16 v[198:199], v11 offset:9216
    s_waitcnt lgkmcnt(8)
    ds_read_b64_tr_b16 v[200:201], v11 offset:16384
    ds_read_b64_tr_b16 v[202:203], v11 offset:17408
    ds_read_b64_tr_b16 v[204:205], v11 offset:24576
    ds_read_b64_tr_b16 v[206:207], v11 offset:25600
    s_waitcnt lgkmcnt(8)
    ds_read_b64_tr_b16 v[208:209], v11 offset:32768
    ds_read_b64_tr_b16 v[210:211], v11 offset:33792
    ds_read_b64_tr_b16 v[212:213], v11 offset:40960
    ds_read_b64_tr_b16 v[214:215], v11 offset:41984
    s_waitcnt lgkmcnt(8)
    ds_read_b64_tr_b16 v[216:217], v11 offset:49152
    ds_read_b64_tr_b16 v[218:219], v11 offset:50176
    ds_read_b64_tr_b16 v[220:221], v11 offset:57344
    ds_read_b64_tr_b16 v[222:223], v11 offset:58368
    s_waitcnt lgkmcnt(0)
    s_barrier
    s_mov_b32 s8, s20
    s_and_b32 s9, s21, 0xffff
    s_mov_b32 s10, 0x400000
    s_mov_b32 s11, 0x20000
    s_lshl_b32 s48, s33, 15
    s_lshl_b32 s49, s32, 8
    s_add_u32 s48, s48, s49
    s_add_u32 s48, s48, 0
    s_lshl_b32 s49, s33, 10
    s_add_u32 s49, s49, 0
    s_mov_b32 m0, s49
    s_nop 0
    buffer_load_dwordx4 v4, s[8:11], s48 offen lds
    s_add_u32 s48, s48, 131072
    s_add_u32 s49, s49, 4096
    s_mov_b32 m0, s49
    s_nop 0
    buffer_load_dwordx4 v4, s[8:11], s48 offen lds
    s_add_u32 s48, s48, 131072
    s_add_u32 s49, s49, 4096
    s_mov_b32 m0, s49
    s_nop 0
    buffer_load_dwordx4 v4, s[8:11], s48 offen lds
    s_add_u32 s48, s48, 131072
    s_add_u32 s49, s49, 4096
    s_mov_b32 m0, s49
    s_nop 0
    buffer_load_dwordx4 v4, s[8:11], s48 offen lds
    s_add_u32 s48, s48, 131072
    s_add_u32 s49, s49, 4096
    s_mov_b32 m0, s49
    s_nop 0
    buffer_load_dwordx4 v4, s[8:11], s48 offen lds
    s_add_u32 s48, s48, 131072
    s_add_u32 s49, s49, 4096
    s_mov_b32 m0, s49
    s_nop 0
    buffer_load_dwordx4 v4, s[8:11], s48 offen lds
    s_add_u32 s48, s48, 131072
    s_add_u32 s49, s49, 4096
    s_mov_b32 m0, s49
    s_nop 0
    buffer_load_dwordx4 v4, s[8:11], s48 offen lds
    s_add_u32 s48, s48, 131072
    s_add_u32 s49, s49, 4096
    s_mov_b32 m0, s49
    s_nop 0
    buffer_load_dwordx4 v4, s[8:11], s48 offen lds
    s_add_u32 s48, s48, 131072
    s_add_u32 s49, s49, 4096
    s_mov_b32 m0, s49
    s_nop 0
    buffer_load_dwordx4 v4, s[8:11], s48 offen lds
    s_add_u32 s48, s48, 131072
    s_add_u32 s49, s49, 4096
    s_mov_b32 m0, s49
    s_nop 0
    buffer_load_dwordx4 v4, s[8:11], s48 offen lds
    s_add_u32 s48, s48, 131072
    s_add_u32 s49, s49, 4096
    s_mov_b32 m0, s49
    s_nop 0
    buffer_load_dwordx4 v4, s[8:11], s48 offen lds
    s_add_u32 s48, s48, 131072
    s_add_u32 s49, s49, 4096
    s_mov_b32 m0, s49
    s_nop 0
    buffer_load_dwordx4 v4, s[8:11], s48 offen lds
    s_add_u32 s48, s48, 131072
    s_add_u32 s49, s49, 4096
    s_mov_b32 m0, s49
    s_nop 0
    buffer_load_dwordx4 v4, s[8:11], s48 offen lds
    s_add_u32 s48, s48, 131072
    s_add_u32 s49, s49, 4096
    s_mov_b32 m0, s49
    s_nop 0
    buffer_load_dwordx4 v4, s[8:11], s48 offen lds
    s_add_u32 s48, s48, 131072
    s_add_u32 s49, s49, 4096
    s_mov_b32 m0, s49
    s_nop 0
    buffer_load_dwordx4 v4, s[8:11], s48 offen lds
    s_add_u32 s48, s48, 131072
    s_add_u32 s49, s49, 4096
    s_mov_b32 m0, s49
    s_nop 0
    buffer_load_dwordx4 v4, s[8:11], s48 offen lds
    s_waitcnt vmcnt(16)
    s_barrier
    ds_read_b64_tr_b16 v[160:161], v12 offset:0
    ds_read_b64_tr_b16 v[162:163], v12 offset:1024
    ds_read_b64_tr_b16 v[164:165], v12 offset:8192
    ds_read_b64_tr_b16 v[166:167], v12 offset:9216
    ds_read_b64_tr_b16 v[168:169], v12 offset:16384
    ds_read_b64_tr_b16 v[170:171], v12 offset:17408
    ds_read_b64_tr_b16 v[172:173], v12 offset:24576
    ds_read_b64_tr_b16 v[174:175], v12 offset:25600
    ds_read_b64_tr_b16 v[176:177], v12 offset:32768
    ds_read_b64_tr_b16 v[178:179], v12 offset:33792
    ds_read_b64_tr_b16 v[180:181], v12 offset:40960
    ds_read_b64_tr_b16 v[182:183], v12 offset:41984
    s_waitcnt lgkmcnt(8)
    ds_read_b64_tr_b16 v[184:185], v12 offset:49152
    ds_read_b64_tr_b16 v[186:187], v12 offset:50176
    ds_read_b64_tr_b16 v[188:189], v12 offset:57344
    ds_read_b64_tr_b16 v[190:191], v12 offset:58368
    s_waitcnt lgkmcnt(8)
    ds_read_b64_tr_b16 v[224:225], v13 offset:0
    ds_read_b64_tr_b16 v[226:227], v13 offset:1024
    ds_read_b64_tr_b16 v[228:229], v13 offset:8192
    ds_read_b64_tr_b16 v[230:231], v13 offset:9216
    s_waitcnt lgkmcnt(8)
    ds_read_b64_tr_b16 v[232:233], v13 offset:16384
    ds_read_b64_tr_b16 v[234:235], v13 offset:17408
    ds_read_b64_tr_b16 v[236:237], v13 offset:24576
    ds_read_b64_tr_b16 v[238:239], v13 offset:25600
    s_waitcnt lgkmcnt(8)
    ds_read_b64_tr_b16 v[240:241], v13 offset:32768
    ds_read_b64_tr_b16 v[242:243], v13 offset:33792
    ds_read_b64_tr_b16 v[244:245], v13 offset:40960
    ds_read_b64_tr_b16 v[246:247], v13 offset:41984
    s_waitcnt lgkmcnt(8)
    ds_read_b64_tr_b16 v[248:249], v13 offset:49152
    ds_read_b64_tr_b16 v[250:251], v13 offset:50176
    ds_read_b64_tr_b16 v[252:253], v13 offset:57344
    ds_read_b64_tr_b16 v[254:255], v13 offset:58368
    s_waitcnt lgkmcnt(0)
    s_barrier
    s_mov_b32 s8, s20
    s_and_b32 s9, s21, 0xffff
    s_mov_b32 s10, 0x400000
    s_mov_b32 s11, 0x20000
    s_lshl_b32 s48, s33, 15
    s_lshl_b32 s49, s32, 8
    s_add_u32 s48, s48, s49
    s_add_u32 s48, s48, 2097152
    s_lshl_b32 s49, s33, 10
    s_add_u32 s49, s49, 65536
    s_mov_b32 m0, s49
    s_nop 0
    buffer_load_dwordx4 v4, s[8:11], s48 offen lds
    s_add_u32 s48, s48, 131072
    s_add_u32 s49, s49, 4096
    s_mov_b32 m0, s49
    s_nop 0
    buffer_load_dwordx4 v4, s[8:11], s48 offen lds
    s_add_u32 s48, s48, 131072
    s_add_u32 s49, s49, 4096
    s_mov_b32 m0, s49
    s_nop 0
    buffer_load_dwordx4 v4, s[8:11], s48 offen lds
    s_add_u32 s48, s48, 131072
    s_add_u32 s49, s49, 4096
    s_mov_b32 m0, s49
    s_nop 0
    buffer_load_dwordx4 v4, s[8:11], s48 offen lds
    s_add_u32 s48, s48, 131072
    s_add_u32 s49, s49, 4096
    s_mov_b32 m0, s49
    s_nop 0
    buffer_load_dwordx4 v4, s[8:11], s48 offen lds
    s_add_u32 s48, s48, 131072
    s_add_u32 s49, s49, 4096
    s_mov_b32 m0, s49
    s_nop 0
    buffer_load_dwordx4 v4, s[8:11], s48 offen lds
    s_add_u32 s48, s48, 131072
    s_add_u32 s49, s49, 4096
    s_mov_b32 m0, s49
    s_nop 0
    buffer_load_dwordx4 v4, s[8:11], s48 offen lds
    s_add_u32 s48, s48, 131072
    s_add_u32 s49, s49, 4096
    s_mov_b32 m0, s49
    s_nop 0
    buffer_load_dwordx4 v4, s[8:11], s48 offen lds
    s_add_u32 s48, s48, 131072
    s_add_u32 s49, s49, 4096
    s_mov_b32 m0, s49
    s_nop 0
    buffer_load_dwordx4 v4, s[8:11], s48 offen lds
    s_add_u32 s48, s48, 131072
    s_add_u32 s49, s49, 4096
    s_mov_b32 m0, s49
    s_nop 0
    buffer_load_dwordx4 v4, s[8:11], s48 offen lds
    s_add_u32 s48, s48, 131072
    s_add_u32 s49, s49, 4096
    s_mov_b32 m0, s49
    s_nop 0
    buffer_load_dwordx4 v4, s[8:11], s48 offen lds
    s_add_u32 s48, s48, 131072
    s_add_u32 s49, s49, 4096
    s_mov_b32 m0, s49
    s_nop 0
    buffer_load_dwordx4 v4, s[8:11], s48 offen lds
    s_add_u32 s48, s48, 131072
    s_add_u32 s49, s49, 4096
    s_mov_b32 m0, s49
    s_nop 0
    buffer_load_dwordx4 v4, s[8:11], s48 offen lds
    s_add_u32 s48, s48, 131072
    s_add_u32 s49, s49, 4096
    s_mov_b32 m0, s49
    s_nop 0
    buffer_load_dwordx4 v4, s[8:11], s48 offen lds
    s_add_u32 s48, s48, 131072
    s_add_u32 s49, s49, 4096
    s_mov_b32 m0, s49
    s_nop 0
    buffer_load_dwordx4 v4, s[8:11], s48 offen lds
    s_add_u32 s48, s48, 131072
    s_add_u32 s49, s49, 4096
    s_mov_b32 m0, s49
    s_nop 0
    buffer_load_dwordx4 v4, s[8:11], s48 offen lds
    s_waitcnt vmcnt(16)
    s_barrier
    ds_read_b64_tr_b16 a[0:1], v10 offset:0
    ds_read_b64_tr_b16 a[2:3], v10 offset:1024
    ds_read_b64_tr_b16 a[4:5], v10 offset:8192
    ds_read_b64_tr_b16 a[6:7], v10 offset:9216
    ds_read_b64_tr_b16 a[8:9], v10 offset:16384
    ds_read_b64_tr_b16 a[10:11], v10 offset:17408
    ds_read_b64_tr_b16 a[12:13], v10 offset:24576
    ds_read_b64_tr_b16 a[14:15], v10 offset:25600
    ds_read_b64_tr_b16 a[16:17], v10 offset:32768
    ds_read_b64_tr_b16 a[18:19], v10 offset:33792
    ds_read_b64_tr_b16 a[20:21], v10 offset:40960
    ds_read_b64_tr_b16 a[22:23], v10 offset:41984
    s_waitcnt lgkmcnt(8)
    ds_read_b64_tr_b16 a[24:25], v10 offset:49152
    ds_read_b64_tr_b16 a[26:27], v10 offset:50176
    ds_read_b64_tr_b16 a[28:29], v10 offset:57344
    ds_read_b64_tr_b16 a[30:31], v10 offset:58368
    s_waitcnt lgkmcnt(8)
    ds_read_b64_tr_b16 a[64:65], v11 offset:0
    ds_read_b64_tr_b16 a[66:67], v11 offset:1024
    ds_read_b64_tr_b16 a[68:69], v11 offset:8192
    ds_read_b64_tr_b16 a[70:71], v11 offset:9216
    s_waitcnt lgkmcnt(8)
    ds_read_b64_tr_b16 a[72:73], v11 offset:16384
    ds_read_b64_tr_b16 a[74:75], v11 offset:17408
    ds_read_b64_tr_b16 a[76:77], v11 offset:24576
    ds_read_b64_tr_b16 a[78:79], v11 offset:25600
    s_waitcnt lgkmcnt(8)
    ds_read_b64_tr_b16 a[80:81], v11 offset:32768
    ds_read_b64_tr_b16 a[82:83], v11 offset:33792
    ds_read_b64_tr_b16 a[84:85], v11 offset:40960
    ds_read_b64_tr_b16 a[86:87], v11 offset:41984
    s_waitcnt lgkmcnt(8)
    ds_read_b64_tr_b16 a[88:89], v11 offset:49152
    ds_read_b64_tr_b16 a[90:91], v11 offset:50176
    ds_read_b64_tr_b16 a[92:93], v11 offset:57344
    ds_read_b64_tr_b16 a[94:95], v11 offset:58368
    s_waitcnt lgkmcnt(0)
    s_barrier
    s_waitcnt vmcnt(0)
    s_barrier
    ds_read_b64_tr_b16 a[32:33], v12 offset:0
    ds_read_b64_tr_b16 a[34:35], v12 offset:1024
    ds_read_b64_tr_b16 a[36:37], v12 offset:8192
    ds_read_b64_tr_b16 a[38:39], v12 offset:9216
    ds_read_b64_tr_b16 a[40:41], v12 offset:16384
    ds_read_b64_tr_b16 a[42:43], v12 offset:17408
    ds_read_b64_tr_b16 a[44:45], v12 offset:24576
    ds_read_b64_tr_b16 a[46:47], v12 offset:25600
    ds_read_b64_tr_b16 a[48:49], v12 offset:32768
    ds_read_b64_tr_b16 a[50:51], v12 offset:33792
    ds_read_b64_tr_b16 a[52:53], v12 offset:40960
    ds_read_b64_tr_b16 a[54:55], v12 offset:41984
    s_waitcnt lgkmcnt(8)
    ds_read_b64_tr_b16 a[56:57], v12 offset:49152
    ds_read_b64_tr_b16 a[58:59], v12 offset:50176
    ds_read_b64_tr_b16 a[60:61], v12 offset:57344
    ds_read_b64_tr_b16 a[62:63], v12 offset:58368
    s_waitcnt lgkmcnt(8)
    ds_read_b64_tr_b16 a[96:97], v13 offset:0
    ds_read_b64_tr_b16 a[98:99], v13 offset:1024
    ds_read_b64_tr_b16 a[100:101], v13 offset:8192
    ds_read_b64_tr_b16 a[102:103], v13 offset:9216
    s_waitcnt lgkmcnt(8)
    ds_read_b64_tr_b16 a[104:105], v13 offset:16384
    ds_read_b64_tr_b16 a[106:107], v13 offset:17408
    ds_read_b64_tr_b16 a[108:109], v13 offset:24576
    ds_read_b64_tr_b16 a[110:111], v13 offset:25600
    s_waitcnt lgkmcnt(8)
    ds_read_b64_tr_b16 a[112:113], v13 offset:32768
    ds_read_b64_tr_b16 a[114:115], v13 offset:33792
    ds_read_b64_tr_b16 a[116:117], v13 offset:40960
    ds_read_b64_tr_b16 a[118:119], v13 offset:41984
    s_waitcnt lgkmcnt(8)
    ds_read_b64_tr_b16 a[120:121], v13 offset:49152
    ds_read_b64_tr_b16 a[122:123], v13 offset:50176
    ds_read_b64_tr_b16 a[124:125], v13 offset:57344
    ds_read_b64_tr_b16 a[126:127], v13 offset:58368
    s_waitcnt lgkmcnt(0)
    s_barrier
L_nost_61:
    s_cmp_lg_u32 s33, 0
    s_cbranch_scc1 L_wgp_69
L_poll_70:
    buffer_load_dword v2, off, s[84:87], 0 offset:128 sc1
    s_sub_u32 s35, s35, 1
    s_cbranch_scc1 L_exit_1
    s_waitcnt vmcnt(0)
    v_readfirstlane_b32 s48, v2
    s_nop 1
    s_cmp_eq_u32 s48, 256
    s_cbranch_scc1 L_pd_71
    s_sleep 8
    s_branch L_poll_70
L_pd_71:
L_wgp_69:
    s_barrier
    s_lshl_b32 s48, s34, 2
    buffer_load_dword v2, off, s[84:87], s48 offset:4 sc1
    buffer_load_dword v3, off, s[84:87], 0 offset:40 sc1
    s_waitcnt vmcnt(0)
    v_readfirstlane_b32 s50, v2
    v_readfirstlane_b32 s51, v3
    s_nop 0
    s_cmp_ge_u32 s50, 32
    s_cselect_b32 s83, 1, 0
    s_cmp_eq_u32 s51, 0
    s_cselect_b32 s83, s83, 0
    s_cmp_ge_u32 s34, 4
    s_cbranch_scc1 L_nop1_72
    s_lshr_b32 s48, s34, 1
    s_lshl_b32 s48, s48, 5
    s_add_u32 s43, s48, 32
    s_and_b32 s41, s34, 1
    s_add_u32 s41, s41, s48
    v_mov_b32 v2, 0
    v_lshlrev_b32 v1, 4, v0
    s_mov_b32 s36, s41
    s_lshl_b32 s37, s36, 15
    s_add_u32 s37, s37, 0x0
    s_add_u32 s48, s37, 0
    buffer_load_dwordx4 v[56:59], v1, s[4:7], s48 offen offset:0
    s_add_u32 s49, s37, 16384
    buffer_load_dwordx4 v[60:63], v1, s[4:7], s49 offen offset:0
    s_add_u32 s48, s37, 0
    buffer_load_dwordx4 v[64:67], v1, s[4:7], s48 offen offset:1024
    s_add_u32 s49, s37, 16384
    buffer_load_dwordx4 v[68:71], v1, s[4:7], s49 offen offset:1024
    s_add_u32 s48, s37, 0
    buffer_load_dwordx4 v[72:75], v1, s[4:7], s48 offen offset:2048
    s_add_u32 s49, s37, 16384
    buffer_load_dwordx4 v[76:79], v1, s[4:7], s49 offen offset:2048
    s_add_u32 s48, s37, 0
    buffer_load_dwordx4 v[80:83], v1, s[4:7], s48 offen offset:3072
    s_add_u32 s49, s37, 16384
    buffer_load_dwordx4 v[84:87], v1, s[4:7], s49 offen offset:3072
    s_add_u32 s48, s37, 4096
    buffer_load_dwordx4 v[88:91], v1, s[4:7], s48 offen offset:0
    s_add_u32 s49, s37, 20480
    buffer_load_dwordx4 v[92:95], v1, s[4:7], s49 offen offset:0
    s_add_u32 s48, s37, 4096
    buffer_load_dwordx4 v[96:99], v1, s[4:7], s48 offen offset:1024
    s_add_u32 s49, s37, 20480
    buffer_load_dwordx4 v[100:103], v1, s[4:7], s49 offen offset:1024
    s_add_u32 s48, s37, 4096
    buffer_load_dwordx4 v[104:107], v1, s[4:7], s48 offen offset:2048
    s_add_u32 s49, s37, 20480
    buffer_load_dwordx4 v[108:111], v1, s[4:7], s49 offen offset:2048
L_seg_73:
    s_add_u32 s50, s36, 2
    s_cmp_lt_u32 s50, s43
    s_cselect_b32 s50, s50, s36
    s_lshl_b32 s38, s50, 15
    s_add_u32 s38, s38, 0x0
    s_waitcnt vmcnt(12)
    v_mfma_f32_16x16x32_bf16 v[24:27], a[128:131], v[56:59], 0
    v_mfma_f32_16x16x32_bf16 v[28:31], a[128:131], v[60:63], 0
    s_add_u32 s48, s37, 4096
    buffer_load_dwordx4 v[112:115], v1, s[4:7], s48 offen offset:3072
    v_mfma_f32_16x16x32_bf16 v[32:35], a[192:195], v[56:59], 0
    v_mfma_f32_16x16x32_bf16 v[36:39], a[192:195], v[60:63], 0
    s_add_u32 s49, s37, 20480
    buffer_load_dwordx4 v[116:119], v1, s[4:7], s49 offen offset:3072
    v_mfma_f32_16x16x32_bf16 v[40:43], v[56:59], v[128:131], 0
    v_mfma_f32_16x16x32_bf16 v[44:47], v[60:63], v[128:131], 0
    v_mfma_f32_16x16x32_bf16 v[48:51], v[56:59], v[192:195], 0
    v_mfma_f32_16x16x32_bf16 v[52:55], v[60:63], v[192:195], 0
    v_mfma_f32_16x16x32_bf16 v[8:11], a[0:3], v[56:59], 0
    v_mfma_f32_16x16x32_bf16 v[12:15], a[0:3], v[60:63], 0
    v_mfma_f32_16x16x32_bf16 v[16:19], a[64:67], v[56:59], 0
    v_mfma_f32_16x16x32_bf16 v[20:23], a[64:67], v[60:63], 0
    s_waitcnt vmcnt(12)
    v_mfma_f32_16x16x32_bf16 v[24:27], a[132:135], v[64:67], v[24:27]
    v_mfma_f32_16x16x32_bf16 v[28:31], a[132:135], v[68:71], v[28:31]
    s_add_u32 s48, s37, 8192
    buffer_load_dwordx4 v[56:59], v1, s[4:7], s48 offen offset:0
    v_mfma_f32_16x16x32_bf16 v[32:35], a[196:199], v[64:67], v[32:35]
    v_mfma_f32_16x16x32_bf16 v[36:39], a[196:199], v[68:71], v[36:39]
    s_add_u32 s49, s37, 24576
    buffer_load_dwordx4 v[60:63], v1, s[4:7], s49 offen offset:0
    v_mfma_f32_16x16x32_bf16 v[40:43], v[64:67], v[132:135], v[40:43]
    v_mfma_f32_16x16x32_bf16 v[44:47], v[68:71], v[132:135], v[44:47]
    v_mfma_f32_16x16x32_bf16 v[48:51], v[64:67], v[196:199], v[48:51]
    v_mfma_f32_16x16x32_bf16 v[52:55], v[68:71], v[196:199], v[52:55]
    v_mfma_f32_16x16x32_bf16 v[8:11], a[4:7], v[64:67], v[8:11]
    v_mfma_f32_16x16x32_bf16 v[12:15], a[4:7], v[68:71], v[12:15]
    v_mfma_f32_16x16x32_bf16 v[16:19], a[68:71], v[64:67], v[16:19]
    v_mfma_f32_16x16x32_bf16 v[20:23], a[68:71], v[68:71], v[20:23]
    s_waitcnt vmcnt(12)
    v_mfma_f32_16x16x32_bf16 v[24:27], a[136:139], v[72:75], v[24:27]
    v_mfma_f32_16x16x32_bf16 v[28:31], a[136:139], v[76:79], v[28:31]
    s_add_u32 s48, s37, 8192
    buffer_load_dwordx4 v[64:67], v1, s[4:7], s48 offen offset:1024
    v_mfma_f32_16x16x32_bf16 v[32:35], a[200:203], v[72:75], v[32:35]
    v_mfma_f32_16x16x32_bf16 v[36:39], a[200:203], v[76:79], v[36:39]
    s_add_u32 s49, s37, 24576
    buffer_load_dwordx4 v[68:71], v1, s[4:7], s49 offen offset:1024
    v_mfma_f32_16x16x32_bf16 v[40:43], v[72:75], v[136:139], v[40:43]
    v_mfma_f32_16x16x32_bf16 v[44:47], v[76:79], v[136:139], v[44:47]
    v_mfma_f32_16x16x32_bf16 v[48:51], v[72:75], v[200:203], v[48:51]
    v_mfma_f32_16x16x32_bf16 v[52:55], v[76:79], v[200:203], v[52:55]
    v_mfma_f32_16x16x32_bf16 v[8:11], a[8:11], v[72:75], v[8:11]
    v_mfma_f32_16x16x32_bf16 v[12:15], a[8:11], v[76:79], v[12:15]
    v_mfma_f32_16x16x32_bf16 v[16:19], a[72:75], v[72:75], v[16:19]
    v_mfma_f32_16x16x32_bf16 v[20:23], a[72:75], v[76:79], v[20:23]
    s_waitcnt vmcnt(12)
    v_mfma_f32_16x16x32_bf16 v[24:27], a[140:143], v[80:83], v[24:27]
    v_mfma_f32_16x16x32_bf16 v[28:31], a[140:143], v[84:87], v[28:31]
    s_add_u32 s48, s37, 8192
    buffer_load_dwordx4 v[72:75], v1, s[4:7], s48 offen offset:2048
    v_mfma_f32_16x16x32_bf16 v[32:35], a[204:207], v[80:83], v[32:35]
    v_mfma_f32_16x16x32_bf16 v[36:39], a[204:207], v[84:87], v[36:39]
    s_add_u32 s49, s37, 24576
    buffer_load_dwordx4 v[76:79], v1, s[4:7], s49 offen offset:2048
    v_mfma_f32_16x16x32_bf16 v[40:43], v[80:83], v[140:143], v[40:43]
    v_mfma_f32_16x16x32_bf16 v[44:47], v[84:87], v[140:143], v[44:47]
    v_mfma_f32_16x16x32_bf16 v[48:51], v[80:83], v[204:207], v[48:51]
    v_mfma_f32_16x16x32_bf16 v[52:55], v[84:87], v[204:207], v[52:55]
    v_mfma_f32_16x16x32_bf16 v[8:11], a[12:15], v[80:83], v[8:11]
    v_mfma_f32_16x16x32_bf16 v[12:15], a[12:15], v[84:87], v[12:15]
    v_mfma_f32_16x16x32_bf16 v[16:19], a[76:79], v[80:83], v[16:19]
    v_mfma_f32_16x16x32_bf16 v[20:23], a[76:79], v[84:87], v[20:23]
    s_waitcnt vmcnt(12)
    v_mfma_f32_16x16x32_bf16 v[24:27], a[144:147], v[88:91], v[24:27]
    v_mfma_f32_16x16x32_bf16 v[28:31], a[144:147], v[92:95], v[28:31]
    s_add_u32 s48, s37, 8192
    buffer_load_dwordx4 v[80:83], v1, s[4:7], s48 offen offset:3072
    v_mfma_f32_16x16x32_bf16 v[32:35], a[208:211], v[88:91], v[32:35]
    v_mfma_f32_16x16x32_bf16 v[36:39], a[208:211], v[92:95], v[36:39]
    s_add_u32 s49, s37, 24576
    buffer_load_dwordx4 v[84:87], v1, s[4:7], s49 offen offset:3072
    v_mfma_f32_16x16x32_bf16 v[40:43], v[88:91], v[144:147], v[40:43]
    v_mfma_f32_16x16x32_bf16 v[44:47], v[92:95], v[144:147], v[44:47]
    v_mfma_f32_16x16x32_bf16 v[48:51], v[88:91], v[208:211], v[48:51]
    v_mfma_f32_16x16x32_bf16 v[52:55], v[92:95], v[208:211], v[52:55]
    v_mfma_f32_16x16x32_bf16 v[8:11], a[16:19], v[88:91], v[8:11]
    v_mfma_f32_16x16x32_bf16 v[12:15], a[16:19], v[92:95], v[12:15]
    v_mfma_f32_16x16x32_bf16 v[16:19], a[80:83], v[88:91], v[16:19]
    v_mfma_f32_16x16x32_bf16 v[20:23], a[80:83], v[92:95], v[20:23]
    s_waitcnt vmcnt(12)
    v_mfma_f32_16x16x32_bf16 v[24:27], a[148:151], v[96:99], v[24:27]
    v_mfma_f32_16x16x32_bf16 v[28:31], a[148:151], v[100:103], v[28:31]
    s_add_u32 s48, s37, 12288
    buffer_load_dwordx4 v[88:91], v1, s[4:7], s48 offen offset:0
    v_mfma_f32_16x16x32_bf16 v[32:35], a[212:215], v[96:99], v[32:35]
    v_mfma_f32_16x16x32_bf16 v[36:39], a[212:215], v[100:103], v[36:39]
    s_add_u32 s49, s37, 28672
    buffer_load_dwordx4 v[92:95], v1, s[4:7], s49 offen offset:0
    v_mfma_f32_16x16x32_bf16 v[40:43], v[96:99], v[148:151], v[40:43]
    v_mfma_f32_16x16x32_bf16 v[44:47], v[100:103], v[148:151], v[44:47]
    v_mfma_f32_16x16x32_bf16 v[48:51], v[96:99], v[212:215], v[48:51]
    v_mfma_f32_16x16x32_bf16 v[52:55], v[100:103], v[212:215], v[52:55]
    v_mfma_f32_16x16x32_bf16 v[8:11], a[20:23], v[96:99], v[8:11]
    v_mfma_f32_16x16x32_bf16 v[12:15], a[20:23], v[100:103], v[12:15]
    v_mfma_f32_16x16x32_bf16 v[16:19], a[84:87], v[96:99], v[16:19]
    v_mfma_f32_16x16x32_bf16 v[20:23], a[84:87], v[100:103], v[20:23]
    s_waitcnt vmcnt(12)
    v_mfma_f32_16x16x32_bf16 v[24:27], a[152:155], v[104:107], v[24:27]
    v_mfma_f32_16x16x32_bf16 v[28:31], a[152:155], v[108:111], v[28:31]
    s_add_u32 s48, s37, 12288
    buffer_load_dwordx4 v[96:99], v1, s[4:7], s48 offen offset:1024
    v_mfma_f32_16x16x32_bf16 v[32:35], a[216:219], v[104:107], v[32:35]
    v_mfma_f32_16x16x32_bf16 v[36:39], a[216:219], v[108:111], v[36:39]
    s_add_u32 s49, s37, 28672
    buffer_load_dwordx4 v[100:103], v1, s[4:7], s49 offen offset:1024
    v_mfma_f32_16x16x32_bf16 v[40:43], v[104:107], v[152:155], v[40:43]
    v_mfma_f32_16x16x32_bf16 v[44:47], v[108:111], v[152:155], v[44:47]
    v_mfma_f32_16x16x32_bf16 v[48:51], v[104:107], v[216:219], v[48:51]
    v_mfma_f32_16x16x32_bf16 v[52:55], v[108:111], v[216:219], v[52:55]
    v_mfma_f32_16x16x32_bf16 v[8:11], a[24:27], v[104:107], v[8:11]
    v_mfma_f32_16x16x32_bf16 v[12:15], a[24:27], v[108:111], v[12:15]
    v_mfma_f32_16x16x32_bf16 v[16:19], a[88:91], v[104:107], v[16:19]
    v_mfma_f32_16x16x32_bf16 v[20:23], a[88:91], v[108:111], v[20:23]
    s_waitcnt vmcnt(12)
    v_mfma_f32_16x16x32_bf16 v[24:27], a[156:159], v[112:115], v[24:27]
    v_mfma_f32_16x16x32_bf16 v[28:31], a[156:159], v[116:119], v[28:31]
    s_add_u32 s48, s37, 12288
    buffer_load_dwordx4 v[104:107], v1, s[4:7], s48 offen offset:2048
    v_mfma_f32_16x16x32_bf16 v[32:35], a[220:223], v[112:115], v[32:35]
    v_mfma_f32_16x16x32_bf16 v[36:39], a[220:223], v[116:119], v[36:39]
    s_add_u32 s49, s37, 28672
    buffer_load_dwordx4 v[108:111], v1, s[4:7], s49 offen offset:2048
    v_mfma_f32_16x16x32_bf16 v[40:43], v[112:115], v[156:159], v[40:43]
    v_mfma_f32_16x16x32_bf16 v[44:47], v[116:119], v[156:159], v[44:47]
    v_mfma_f32_16x16x32_bf16 v[48:51], v[112:115], v[220:223], v[48:51]
    v_mfma_f32_16x16x32_bf16 v[52:55], v[116:119], v[220:223], v[52:55]
    v_mfma_f32_16x16x32_bf16 v[8:11], a[28:31], v[112:115], v[8:11]
    v_mfma_f32_16x16x32_bf16 v[12:15], a[28:31], v[116:119], v[12:15]
    v_mfma_f32_16x16x32_bf16 v[16:19], a[92:95], v[112:115], v[16:19]
    v_mfma_f32_16x16x32_bf16 v[20:23], a[92:95], v[116:119], v[20:23]
    s_waitcnt vmcnt(12)
    s_mov_b64 exec, 1
    buffer_store_dword v2, off, s[4:7], s42 sc1
    s_mov_b64 exec, -1
    v_mfma_f32_16x16x32_bf16 v[24:27], a[160:163], v[56:59], v[24:27]
    v_mfma_f32_16x16x32_bf16 v[28:31], a[160:163], v[60:63], v[28:31]
    s_add_u32 s48, s37, 12288
    buffer_load_dwordx4 v[112:115], v1, s[4:7], s48 offen offset:3072
    v_mfma_f32_16x16x32_bf16 v[32:35], a[224:227], v[56:59], v[32:35]
    v_mfma_f32_16x16x32_bf16 v[36:39], a[224:227], v[60:63], v[36:39]
    s_add_u32 s49, s37, 28672
    buffer_load_dwordx4 v[116:119], v1, s[4:7], s49 offen offset:3072
    v_mfma_f32_16x16x32_bf16 v[40:43], v[56:59], v[160:163], v[40:43]
    v_mfma_f32_16x16x32_bf16 v[44:47], v[60:63], v[160:163], v[44:47]
    v_mfma_f32_16x16x32_bf16 v[48:51], v[56:59], v[224:227], v[48:51]
    v_mfma_f32_16x16x32_bf16 v[52:55], v[60:63], v[224:227], v[52:55]
    v_mfma_f32_16x16x32_bf16 v[8:11], a[32:35], v[56:59], v[8:11]
    v_mfma_f32_16x16x32_bf16 v[12:15], a[32:35], v[60:63], v[12:15]
    v_mfma_f32_16x16x32_bf16 v[16:19], a[96:99], v[56:59], v[16:19]
    v_mfma_f32_16x16x32_bf16 v[20:23], a[96:99], v[60:63], v[20:23]
    s_waitcnt vmcnt(12)
    v_mfma_f32_16x16x32_bf16 v[24:27], a[164:167], v[64:67], v[24:27]
    v_mfma_f32_16x16x32_bf16 v[28:31], a[164:167], v[68:71], v[28:31]
    s_add_u32 s48, s38, 0
    buffer_load_dwordx4 v[56:59], v1, s[4:7], s48 offen offset:0
    v_mfma_f32_16x16x32_bf16 v[32:35], a[228:231], v[64:67], v[32:35]
    v_mfma_f32_16x16x32_bf16 v[36:39], a[228:231], v[68:71], v[36:39]
    s_add_u32 s49, s38, 16384
    buffer_load_dwordx4 v[60:63], v1, s[4:7], s49 offen offset:0
    v_mfma_f32_16x16x32_bf16 v[40:43], v[64:67], v[164:167], v[40:43]
    v_mfma_f32_16x16x32_bf16 v[44:47], v[68:71], v[164:167], v[44:47]
    v_mfma_f32_16x16x32_bf16 v[48:51], v[64:67], v[228:231], v[48:51]
    v_mfma_f32_16x16x32_bf16 v[52:55], v[68:71], v[228:231], v[52:55]
    v_mfma_f32_16x16x32_bf16 v[8:11], a[36:39], v[64:67], v[8:11]
    v_mfma_f32_16x16x32_bf16 v[12:15], a[36:39], v[68:71], v[12:15]
    v_mfma_f32_16x16x32_bf16 v[16:19], a[100:103], v[64:67], v[16:19]
    v_mfma_f32_16x16x32_bf16 v[20:23], a[100:103], v[68:71], v[20:23]
    s_waitcnt vmcnt(12)
    v_mfma_f32_16x16x32_bf16 v[24:27], a[168:171], v[72:75], v[24:27]
    v_mfma_f32_16x16x32_bf16 v[28:31], a[168:171], v[76:79], v[28:31]
    s_add_u32 s48, s38, 0
    buffer_load_dwordx4 v[64:67], v1, s[4:7], s48 offen offset:1024
    v_mfma_f32_16x16x32_bf16 v[32:35], a[232:235], v[72:75], v[32:35]
    v_mfma_f32_16x16x32_bf16 v[36:39], a[232:235], v[76:79], v[36:39]
    s_add_u32 s49, s38, 16384
    buffer_load_dwordx4 v[68:71], v1, s[4:7], s49 offen offset:1024
    v_mfma_f32_16x16x32_bf16 v[40:43], v[72:75], v[168:171], v[40:43]
    v_mfma_f32_16x16x32_bf16 v[44:47], v[76:79], v[168:171], v[44:47]
    v_mfma_f32_16x16x32_bf16 v[48:51], v[72:75], v[232:235], v[48:51]
    v_mfma_f32_16x16x32_bf16 v[52:55], v[76:79], v[232:235], v[52:55]
    v_mfma_f32_16x16x32_bf16 v[8:11], a[40:43], v[72:75], v[8:11]
    v_mfma_f32_16x16x32_bf16 v[12:15], a[40:43], v[76:79], v[12:15]
    v_mfma_f32_16x16x32_bf16 v[16:19], a[104:107], v[72:75], v[16:19]
    v_mfma_f32_16x16x32_bf16 v[20:23], a[104:107], v[76:79], v[20:23]
    s_waitcnt vmcnt(12)
    v_mfma_f32_16x16x32_bf16 v[24:27], a[172:175], v[80:83], v[24:27]
    v_mfma_f32_16x16x32_bf16 v[28:31], a[172:175], v[84:87], v[28:31]
    s_add_u32 s48, s38, 0
    buffer_load_dwordx4 v[72:75], v1, s[4:7], s48 offen offset:2048
    v_mfma_f32_16x16x32_bf16 v[32:35], a[236:239], v[80:83], v[32:35]
    v_mfma_f32_16x16x32_bf16 v[36:39], a[236:239], v[84:87], v[36:39]
    s_add_u32 s49, s38, 16384
    buffer_load_dwordx4 v[76:79], v1, s[4:7], s49 offen offset:2048
    v_mfma_f32_16x16x32_bf16 v[40:43], v[80:83], v[172:175], v[40:43]
    v_mfma_f32_16x16x32_bf16 v[44:47], v[84:87], v[172:175], v[44:47]
    v_mfma_f32_16x16x32_bf16 v[48:51], v[80:83], v[236:239], v[48:51]
    v_mfma_f32_16x16x32_bf16 v[52:55], v[84:87], v[236:239], v[52:55]
    v_mfma_f32_16x16x32_bf16 v[8:11], a[44:47], v[80:83], v[8:11]
    v_mfma_f32_16x16x32_bf16 v[12:15], a[44:47], v[84:87], v[12:15]
    v_mfma_f32_16x16x32_bf16 v[16:19], a[108:111], v[80:83], v[16:19]
    v_mfma_f32_16x16x32_bf16 v[20:23], a[108:111], v[84:87], v[20:23]
    s_waitcnt vmcnt(12)
    v_mfma_f32_16x16x32_bf16 v[24:27], a[176:179], v[88:91], v[24:27]
    v_mfma_f32_16x16x32_bf16 v[28:31], a[176:179], v[92:95], v[28:31]
    s_add_u32 s48, s38, 0
    buffer_load_dwordx4 v[80:83], v1, s[4:7], s48 offen offset:3072
    v_mfma_f32_16x16x32_bf16 v[32:35], a[240:243], v[88:91], v[32:35]
    v_mfma_f32_16x16x32_bf16 v[36:39], a[240:243], v[92:95], v[36:39]
    s_add_u32 s49, s38, 16384
    buffer_load_dwordx4 v[84:87], v1, s[4:7], s49 offen offset:3072
    v_mfma_f32_16x16x32_bf16 v[40:43], v[88:91], v[176:179], v[40:43]
    v_mfma_f32_16x16x32_bf16 v[44:47], v[92:95], v[176:179], v[44:47]
    v_mfma_f32_16x16x32_bf16 v[48:51], v[88:91], v[240:243], v[48:51]
    v_mfma_f32_16x16x32_bf16 v[52:55], v[92:95], v[240:243], v[52:55]
    v_mfma_f32_16x16x32_bf16 v[8:11], a[48:51], v[88:91], v[8:11]
    v_mfma_f32_16x16x32_bf16 v[12:15], a[48:51], v[92:95], v[12:15]
    v_mfma_f32_16x16x32_bf16 v[16:19], a[112:115], v[88:91], v[16:19]
    v_mfma_f32_16x16x32_bf16 v[20:23], a[112:115], v[92:95], v[20:23]
    s_waitcnt vmcnt(12)
    v_mfma_f32_16x16x32_bf16 v[24:27], a[180:183], v[96:99], v[24:27]
    v_mfma_f32_16x16x32_bf16 v[28:31], a[180:183], v[100:103], v[28:31]
    s_add_u32 s48, s38, 4096
    buffer_load_dwordx4 v[88:91], v1, s[4:7], s48 offen offset:0
    v_mfma_f32_16x16x32_bf16 v[32:35], a[244:247], v[96:99], v[32:35]
    v_mfma_f32_16x16x32_bf16 v[36:39], a[244:247], v[100:103], v[36:39]
    s_add_u32 s49, s38, 20480
    buffer_load_dwordx4 v[92:95], v1, s[4:7], s49 offen offset:0
    v_mfma_f32_16x16x32_bf16 v[40:43], v[96:99], v[180:183], v[40:43]
    v_mfma_f32_16x16x32_bf16 v[44:47], v[100:103], v[180:183], v[44:47]
    v_mfma_f32_16x16x32_bf16 v[48:51], v[96:99], v[244:247], v[48:51]
    v_mfma_f32_16x16x32_bf16 v[52:55], v[100:103], v[244:247], v[52:55]
    v_mfma_f32_16x16x32_bf16 v[8:11], a[52:55], v[96:99], v[8:11]
    v_mfma_f32_16x16x32_bf16 v[12:15], a[52:55], v[100:103], v[12:15]
    v_mfma_f32_16x16x32_bf16 v[16:19], a[116:119], v[96:99], v[16:19]
    v_mfma_f32_16x16x32_bf16 v[20:23], a[116:119], v[100:103], v[20:23]
    s_waitcnt vmcnt(12)
    v_mfma_f32_16x16x32_bf16 v[24:27], a[184:187], v[104:107], v[24:27]
    v_mfma_f32_16x16x32_bf16 v[28:31], a[184:187], v[108:111], v[28:31]
    s_add_u32 s48, s38, 4096
    buffer_load_dwordx4 v[96:99], v1, s[4:7], s48 offen offset:1024
    v_mfma_f32_16x16x32_bf16 v[32:35], a[248:251], v[104:107], v[32:35]
    v_mfma_f32_16x16x32_bf16 v[36:39], a[248:251], v[108:111], v[36:39]
    s_add_u32 s49, s38, 20480
    buffer_load_dwordx4 v[100:103], v1, s[4:7], s49 offen offset:1024
    v_mfma_f32_16x16x32_bf16 v[40:43], v[104:107], v[184:187], v[40:43]
    v_mfma_f32_16x16x32_bf16 v[44:47], v[108:111], v[184:187], v[44:47]
    v_mfma_f32_16x16x32_bf16 v[48:51], v[104:107], v[248:251], v[48:51]
    v_mfma_f32_16x16x32_bf16 v[52:55], v[108:111], v[248:251], v[52:55]
    v_mfma_f32_16x16x32_bf16 v[8:11], a[56:59], v[104:107], v[8:11]
    v_mfma_f32_16x16x32_bf16 v[12:15], a[56:59], v[108:111], v[12:15]
    v_mfma_f32_16x16x32_bf16 v[16:19], a[120:123], v[104:107], v[16:19]
    v_mfma_f32_16x16x32_bf16 v[20:23], a[120:123], v[108:111], v[20:23]
    s_waitcnt vmcnt(12)
    v_mfma_f32_16x16x32_bf16 v[24:27], a[188:191], v[112:115], v[24:27]
    v_mfma_f32_16x16x32_bf16 v[28:31], a[188:191], v[116:119], v[28:31]
    s_add_u32 s48, s38, 4096
    buffer_load_dwordx4 v[104:107], v1, s[4:7], s48 offen offset:2048
    v_mfma_f32_16x16x32_bf16 v[32:35], a[252:255], v[112:115], v[32:35]
    v_mfma_f32_16x16x32_bf16 v[36:39], a[252:255], v[116:119], v[36:39]
    s_add_u32 s49, s38, 20480
    buffer_load_dwordx4 v[108:111], v1, s[4:7], s49 offen offset:2048
    v_mfma_f32_16x16x32_bf16 v[40:43], v[112:115], v[188:191], v[40:43]
    v_mfma_f32_16x16x32_bf16 v[44:47], v[116:119], v[188:191], v[44:47]
    v_mfma_f32_16x16x32_bf16 v[48:51], v[112:115], v[252:255], v[48:51]
    v_mfma_f32_16x16x32_bf16 v[52:55], v[116:119], v[252:255], v[52:55]
    v_mfma_f32_16x16x32_bf16 v[8:11], a[60:63], v[112:115], v[8:11]
    v_mfma_f32_16x16x32_bf16 v[12:15], a[60:63], v[116:119], v[12:15]
    v_mfma_f32_16x16x32_bf16 v[16:19], a[124:127], v[112:115], v[16:19]
    v_mfma_f32_16x16x32_bf16 v[20:23], a[124:127], v[116:119], v[20:23]
    s_lshl_b32 s39, s36, 5
    s_add_u32 s39, s39, s32
    s_lshl_b32 s39, s39, 13
    s_lshl_b32 s50, s33, 10
    s_add_u32 s51, s39, s50
    s_add_u32 s48, s51, 0x1200000
    v_cvt_pk_bf16_f32 v24, v24, v32
    v_cvt_pk_bf16_f32 v25, v25, v33
    v_cvt_pk_bf16_f32 v26, v26, v34
    v_cvt_pk_bf16_f32 v27, v27, v35
    buffer_store_dwordx4 v[24:27], v1, s[4:7], s48 offen sc1
    s_add_u32 s48, s51, 0x1201000
    v_cvt_pk_bf16_f32 v28, v28, v36
    v_cvt_pk_bf16_f32 v29, v29, v37
    v_cvt_pk_bf16_f32 v30, v30, v38
    v_cvt_pk_bf16_f32 v31, v31, v39
    buffer_store_dwordx4 v[28:31], v1, s[4:7], s48 offen sc1
    s_add_u32 s48, s51, s50
    s_add_u32 s48, s48, 0x2200000
    v_cvt_pk_bf16_f32 v40, v40, v41
    v_cvt_pk_bf16_f32 v41, v42, v43
    v_cvt_pk_bf16_f32 v42, v44, v45
    v_cvt_pk_bf16_f32 v43, v46, v47
    buffer_store_dwordx4 v[40:43], v1, s[4:7], s48 offen offset:0 sc1
    v_cvt_pk_bf16_f32 v48, v48, v49
    v_cvt_pk_bf16_f32 v49, v50, v51
    v_cvt_pk_bf16_f32 v50, v52, v53
    v_cvt_pk_bf16_f32 v51, v54, v55
    buffer_store_dwordx4 v[48:51], v1, s[4:7], s48 offen offset:1024 sc1
    s_add_u32 s48, s51, 0x200000
    v_cvt_pk_bf16_f32 v8, v8, v16
    v_cvt_pk_bf16_f32 v9, v9, v17
    v_cvt_pk_bf16_f32 v10, v10, v18
    v_cvt_pk_bf16_f32 v11, v11, v19
    buffer_store_dwordx4 v[8:11], v1, s[4:7], s48 offen sc1
    s_add_u32 s48, s51, 0x201000
    v_cvt_pk_bf16_f32 v12, v12, v20
    v_cvt_pk_bf16_f32 v13, v13, v21
    v_cvt_pk_bf16_f32 v14, v14, v22
    v_cvt_pk_bf16_f32 v15, v15, v23
    buffer_store_dwordx4 v[12:15], v1, s[4:7], s48 offen sc1
    v_add_u32 v2, 1, v2
    s_add_u32 s36, s36, 2
    s_mov_b32 s37, s38
    s_cmp_lt_u32 s36, s43
    s_cbranch_scc1 L_seg_73
    s_waitcnt vmcnt(0)
    s_mov_b64 exec, 1
    buffer_store_dword v2, off, s[4:7], s42 sc1
    s_mov_b64 exec, -1
L_nop1_72:
    v_and_b32 v3, 15, v0
    v_lshrrev_b32 v2, 4, v0
    v_lshlrev_b32 v1, 4, v0
    s_mov_b32 s8, s26
    s_and_b32 s9, s27, 0xffff
    s_mov_b32 s10, 0x400000
    s_mov_b32 s11, 0x20000
    s_lshl_b32 s48, s32, 17
    s_lshl_b32 s49, s33, 13
    s_add_u32 s48, s48, s49
    s_lshl_b32 s49, s33, 10
    s_add_u32 m0, s49, 0
    s_add_u32 s51, s48, 0
    buffer_load_dwordx4 v1, s[8:11], s51 offen lds
    s_add_u32 m0, s49, 4096
    s_add_u32 s51, s48, 32768
    buffer_load_dwordx4 v1, s[8:11], s51 offen lds
    s_add_u32 m0, s49, 8192
    s_add_u32 s51, s48, 65536
    buffer_load_dwordx4 v1, s[8:11], s51 offen lds
    s_add_u32 m0, s49, 12288
    s_add_u32 s51, s48, 98304
    buffer_load_dwordx4 v1, s[8:11], s51 offen lds
    s_add_u32 m0, s49, 16416
    s_add_u32 s51, s48, 1024
    buffer_load_dwordx4 v1, s[8:11], s51 offen lds
    s_add_u32 m0, s49, 20512
    s_add_u32 s51, s48, 33792
    buffer_load_dwordx4 v1, s[8:11], s51 offen lds
    s_add_u32 m0, s49, 24608
    s_add_u32 s51, s48, 66560
    buffer_load_dwordx4 v1, s[8:11], s51 offen lds
    s_add_u32 m0, s49, 28704
    s_add_u32 s51, s48, 99328
    buffer_load_dwordx4 v1, s[8:11], s51 offen lds
    s_add_u32 m0, s49, 32832
    s_add_u32 s51, s48, 2048
    buffer_load_dwordx4 v1, s[8:11], s51 offen lds
    s_add_u32 m0, s49, 36928
    s_add_u32 s51, s48, 34816
    buffer_load_dwordx4 v1, s[8:11], s51 offen lds
    s_add_u32 m0, s49, 41024
    s_add_u32 s51, s48, 67584
    buffer_load_dwordx4 v1, s[8:11], s51 offen lds
    s_add_u32 m0, s49, 45120
    s_add_u32 s51, s48, 100352
    buffer_load_dwordx4 v1, s[8:11], s51 offen lds
    s_add_u32 m0, s49, 49248
    s_add_u32 s51, s48, 3072
    buffer_load_dwordx4 v1, s[8:11], s51 offen lds
    s_add_u32 m0, s49, 53344
    s_add_u32 s51, s48, 35840
    buffer_load_dwordx4 v1, s[8:11], s51 offen lds
    s_add_u32 m0, s49, 57440
    s_add_u32 s51, s48, 68608
    buffer_load_dwordx4 v1, s[8:11], s51 offen lds
    s_add_u32 m0, s49, 61536
    s_add_u32 s51, s48, 101376
    buffer_load_dwordx4 v1, s[8:11], s51 offen lds
    s_add_u32 m0, s49, 65664
    s_add_u32 s51, s48, 4096
    buffer_load_dwordx4 v1, s[8:11], s51 offen lds
    s_add_u32 m0, s49, 69760
    s_add_u32 s51, s48, 36864
    buffer_load_dwordx4 v1, s[8:11], s51 offen lds
    s_add_u32 m0, s49, 73856
    s_add_u32 s51, s48, 69632
    buffer_load_dwordx4 v1, s[8:11], s51 offen lds
    s_add_u32 m0, s49, 77952
    s_add_u32 s51, s48, 102400
    buffer_load_dwordx4 v1, s[8:11], s51 offen lds
    s_add_u32 m0, s49, 82080
    s_add_u32 s51, s48, 5120
    buffer_load_dwordx4 v1, s[8:11], s51 offen lds
    s_add_u32 m0, s49, 86176
    s_add_u32 s51, s48, 37888
    buffer_load_dwordx4 v1, s[8:11], s51 offen lds
    s_add_u32 m0, s49, 90272
    s_add_u32 s51, s48, 70656
    buffer_load_dwordx4 v1, s[8:11], s51 offen lds
    s_add_u32 m0, s49, 94368
    s_add_u32 s51, s48, 103424
    buffer_load_dwordx4 v1, s[8:11], s51 offen lds
    s_add_u32 m0, s49, 98496
    s_add_u32 s51, s48, 6144
    buffer_load_dwordx4 v1, s[8:11], s51 offen lds
    s_add_u32 m0, s49, 102592
    s_add_u32 s51, s48, 38912
    buffer_load_dwordx4 v1, s[8:11], s51 offen lds
    s_add_u32 m0, s49, 106688
    s_add_u32 s51, s48, 71680
    buffer_load_dwordx4 v1, s[8:11], s51 offen lds
    s_add_u32 m0, s49, 110784
    s_add_u32 s51, s48, 104448
    buffer_load_dwordx4 v1, s[8:11], s51 offen lds
    s_add_u32 m0, s49, 114912
    s_add_u32 s51, s48, 7168
    buffer_load_dwordx4 v1, s[8:11], s51 offen lds
    s_add_u32 m0, s49, 119008
    s_add_u32 s51, s48, 39936
    buffer_load_dwordx4 v1, s[8:11], s51 offen lds
    s_add_u32 m0, s49, 123104
    s_add_u32 s51, s48, 72704
    buffer_load_dwordx4 v1, s[8:11], s51 offen lds
    s_add_u32 m0, s49, 127200
    s_add_u32 s51, s48, 105472
    buffer_load_dwordx4 v1, s[8:11], s51 offen lds
    v_lshrrev_b32 v6, 2, v3
    v_and_b32 v7, 3, v3
    v_and_b32 v8, 1, v2
    v_lshl_add_u32 v8, v8, 2, v6
    v_lshrrev_b32 v9, 1, v2
    v_lshlrev_b32 v10, 14, v8
    v_lshl_add_u32 v10, v9, 10, v10
    v_lshl_add_u32 v10, v8, 5, v10
    v_lshl_add_u32 v10, v7, 3, v10
    s_lshl_b32 s48, s33, 8
    v_add_u32 v10, s48, v10
    s_waitcnt vmcnt(0)
    s_barrier
    ds_read_b64_tr_b16 a[0:1], v10 offset:0
    ds_read_b64_tr_b16 a[2:3], v10 offset:2048
    ds_read_b64_tr_b16 a[4:5], v10 offset:4096
    ds_read_b64_tr_b16 a[6:7], v10 offset:6144
    ds_read_b64_tr_b16 a[8:9], v10 offset:8192
    ds_read_b64_tr_b16 a[10:11], v10 offset:10240
    ds_read_b64_tr_b16 a[12:13], v10 offset:12288
    ds_read_b64_tr_b16 a[14:15], v10 offset:14336
    ds_read_b64_tr_b16 a[16:17], v10 offset:32
    ds_read_b64_tr_b16 a[18:19], v10 offset:2080
    ds_read_b64_tr_b16 a[20:21], v10 offset:4128
    ds_read_b64_tr_b16 a[22:23], v10 offset:6176
    s_waitcnt lgkmcnt(8)
    ds_read_b64_tr_b16 a[24:25], v10 offset:8224
    ds_read_b64_tr_b16 a[26:27], v10 offset:10272
    ds_read_b64_tr_b16 a[28:29], v10 offset:12320
    ds_read_b64_tr_b16 a[30:31], v10 offset:14368
    s_waitcnt lgkmcnt(8)
    ds_read_b64_tr_b16 a[32:33], v10 offset:64
    ds_read_b64_tr_b16 a[34:35], v10 offset:2112
    ds_read_b64_tr_b16 a[36:37], v10 offset:4160
    ds_read_b64_tr_b16 a[38:39], v10 offset:6208
    s_waitcnt lgkmcnt(8)
    ds_read_b64_tr_b16 a[40:41], v10 offset:8256
    ds_read_b64_tr_b16 a[42:43], v10 offset:10304
    ds_read_b64_tr_b16 a[44:45], v10 offset:12352
    ds_read_b64_tr_b16 a[46:47], v10 offset:14400
    s_waitcnt lgkmcnt(8)
    ds_read_b64_tr_b16 a[48:49], v10 offset:96
    ds_read_b64_tr_b16 a[50:51], v10 offset:2144
    ds_read_b64_tr_b16 a[52:53], v10 offset:4192
    ds_read_b64_tr_b16 a[54:55], v10 offset:6240
    s_waitcnt lgkmcnt(8)
    ds_read_b64_tr_b16 a[56:57], v10 offset:8288
    ds_read_b64_tr_b16 a[58:59], v10 offset:10336
    ds_read_b64_tr_b16 a[60:61], v10 offset:12384
    ds_read_b64_tr_b16 a[62:63], v10 offset:14432
    s_waitcnt lgkmcnt(8)
    ds_read_b64_tr_b16 a[64:65], v10 offset:128
    ds_read_b64_tr_b16 a[66:67], v10 offset:2176
    ds_read_b64_tr_b16 a[68:69], v10 offset:4224
    ds_read_b64_tr_b16 a[70:71], v10 offset:6272
    s_waitcnt lgkmcnt(8)
    ds_read_b64_tr_b16 a[72:73], v10 offset:8320
    ds_read_b64_tr_b16 a[74:75], v10 offset:10368
    ds_read_b64_tr_b16 a[76:77], v10 offset:12416
    ds_read_b64_tr_b16 a[78:79], v10 offset:14464
    s_waitcnt lgkmcnt(8)
    ds_read_b64_tr_b16 a[80:81], v10 offset:160
    ds_read_b64_tr_b16 a[82:83], v10 offset:2208
    ds_read_b64_tr_b16 a[84:85], v10 offset:4256
    ds_read_b64_tr_b16 a[86:87], v10 offset:6304
    s_waitcnt lgkmcnt(8)
    ds_read_b64_tr_b16 a[88:89], v10 offset:8352
    ds_read_b64_tr_b16 a[90:91], v10 offset:10400
    ds_read_b64_tr_b16 a[92:93], v10 offset:12448
    ds_read_b64_tr_b16 a[94:95], v10 offset:14496
    s_waitcnt lgkmcnt(8)
    ds_read_b64_tr_b16 a[96:97], v10 offset:192
    ds_read_b64_tr_b16 a[98:99], v10 offset:2240
    ds_read_b64_tr_b16 a[100:101], v10 offset:4288
    ds_read_b64_tr_b16 a[102:103], v10 offset:6336
    s_waitcnt lgkmcnt(8)
    ds_read_b64_tr_b16 a[104:105], v10 offset:8384
    ds_read_b64_tr_b16 a[106:107], v10 offset:10432
    ds_read_b64_tr_b16 a[108:109], v10 offset:12480
    ds_read_b64_tr_b16 a[110:111], v10 offset:14528
    s_waitcnt lgkmcnt(8)
    ds_read_b64_tr_b16 a[112:113], v10 offset:224
    ds_read_b64_tr_b16 a[114:115], v10 offset:2272
    ds_read_b64_tr_b16 a[116:117], v10 offset:4320
    ds_read_b64_tr_b16 a[118:119], v10 offset:6368
    s_waitcnt lgkmcnt(8)
    ds_read_b64_tr_b16 a[120:121], v10 offset:8416
    ds_read_b64_tr_b16 a[122:123], v10 offset:10464
    ds_read_b64_tr_b16 a[124:125], v10 offset:12512
    ds_read_b64_tr_b16 a[126:127], v10 offset:14560
    s_waitcnt lgkmcnt(0)
    s_barrier
    v_and_b32 v3, 15, v0
    v_lshrrev_b32 v2, 4, v0
    v_lshlrev_b32 v1, 4, v0
    s_and_b32 s48, s33, 1
    s_lshl_b32 s48, s48, 4
    v_add_u32 v4, s48, v3
    v_lshlrev_b32 v5, 2, v2
    v_sub_u32 v4, v4, v5
    v_cmp_le_i32 s[64:65], 0, v4
    v_cmp_le_i32 s[66:67], 1, v4
    v_cmp_le_i32 s[68:69], 2, v4
    v_cmp_le_i32 s[70:71], 3, v4
    v_cmp_le_i32 s[72:73], 16, v4
    v_cmp_le_i32 s[74:75], 17, v4
    v_cmp_le_i32 s[76:77], 18, v4
    v_cmp_le_i32 s[78:79], 19, v4
    s_mov_b32 s52, 0x3e0293ee
    s_mov_b32 s53, 0x3e0293ee
    v_lshlrev_b32 v5, 15, v3
    v_lshl_add_u32 v3, v2, 4, v5
    v_lshlrev_b32 v2, 3, v0
    v_mov_b32 v4, 0xd028965f
    v_mov_b32 v8, 0x3f803f80
    v_mov_b32 v9, 0x3f803f80
    v_mov_b32 v10, 0x3f803f80
    v_mov_b32 v11, 0x3f803f80
    s_load_dwordx4 s[16:19], s[0:1], 64
    s_waitcnt lgkmcnt(0)
    s_mov_b32 s88, s16
    s_and_b32 s89, s17, 0xffff
    s_mov_b32 s90, 0x700000
    s_mov_b32 s91, 0x20000
    s_mov_b32 s92, s18
    s_and_b32 s93, s19, 0xffff
    s_mov_b32 s94, 0xe00
    s_mov_b32 s95, 0x20000
    s_load_dwordx2 s[16:17], s[0:1], 80
    s_waitcnt lgkmcnt(0)
    s_mov_b32 s96, s16
    s_and_b32 s97, s17, 0xffff
    s_mov_b32 s98, 0x700000
    s_mov_b32 s99, 0x20000
    s_load_dwordx4 s[16:19], s[0:1], 88
    s_waitcnt lgkmcnt(0)
    v_lshrrev_b32 v144, 3, v0
    v_and_b32 v145, 7, v0
    v_lshrrev_b32 v146, 4, v0
    v_lshlrev_b32 v146, 1, v146
    v_xor_b32 v145, v145, v146
    v_lshlrev_b32 v145, 4, v145
    v_lshl_add_u32 v142, v144, 12, v145
    s_lshl_b32 s101, s33, 15
    s_lshr_b32 s48, s63, 3
    s_lshl_b32 s48, s48, 7
    s_add_u32 s101, s101, s48
    s_lshl_b32 s3, s33, 10
    s_mov_b32 s62, 0
    v_mov_b32 v120, 0
    v_mov_b32 v121, 0
    v_mov_b32 v122, 0
    v_mov_b32 v123, 0
    v_mov_b32 v124, 0
    v_mov_b32 v125, 0
    v_mov_b32 v126, 0
    v_mov_b32 v127, 0
    v_mov_b32 v128, 0
    v_mov_b32 v129, 0
    v_mov_b32 v130, 0
    v_mov_b32 v131, 0
    v_mov_b32 v132, 0
    v_mov_b32 v133, 0
    v_mov_b32 v134, 0
    v_mov_b32 v135, 0
    s_mov_b32 s44, 0
    v_lshrrev_b32 v144, 3, v0
    v_and_b32 v145, 7, v0
    v_bfe_u32 v146, v0, 4, 1
    s_and_b32 s48, s33, 1
    s_lshl_b32 s48, s48, 1
    v_or_b32 v146, s48, v146
    v_lshlrev_b32 v146, 1, v146
    v_xor_b32 v145, v145, v146
    v_lshlrev_b32 v145, 4, v145
    v_mul_u32_u24 v136, 3584, v144
    v_add_u32 v136, v136, v145
    v_lshl_add_u32 v137, v144, 10, v145
    v_and_b32 v144, 15, v0
    v_lshrrev_b32 v145, 4, v0
    v_lshrrev_b32 v146, 2, v144
    v_and_b32 v147, 3, v144
    v_lshl_add_u32 v148, v145, 3, v146
    v_lshlrev_b32 v148, 7, v148
    v_lshl_add_u32 v148, v147, 3, v148
    v_lshrrev_b32 v149, 1, v146
    v_and_b32 v150, 1, v145
    v_lshl_add_u32 v149, v150, 1, v149
    v_xor_b32 v150, s48, v149
    v_lshl_add_u32 v138, v150, 5, v148
    v_xor_b32 v139, 32, v138
    s_and_b32 s48, s33, 2
    v_xor_b32 v150, s48, v149
    v_lshl_add_u32 v140, v150, 5, v148
    v_add_u32 v140, 16384, v140
    v_xor_b32 v141, 32, v140
    s_add_u32 s50, s44, 0
    s_mul_i32 s48, s50, 458752
    s_mul_i32 s49, s33, 28672
    s_add_u32 s48, s48, s49
    s_lshr_b32 s49, s100, 3
    s_lshl_b32 s49, s49, 7
    s_add_u32 s48, s48, s49
    s_and_b32 s49, s50, 1
    s_lshl_b32 s49, s49, 15
    s_lshl_b32 s50, s33, 10
    s_add_u32 s49, s49, s50
    s_add_u32 m0, s49, 0
    s_add_u32 s50, s48, 0
    buffer_load_dwordx4 v136, s[88:91], s50 offen lds
    s_add_u32 m0, s49, 4096
    s_add_u32 s50, s48, 114688
    buffer_load_dwordx4 v136, s[88:91], s50 offen lds
    s_add_u32 m0, s49, 8192
    s_add_u32 s50, s48, 229376
    buffer_load_dwordx4 v136, s[88:91], s50 offen lds
    s_add_u32 m0, s49, 12288
    s_add_u32 s50, s48, 344064
    buffer_load_dwordx4 v136, s[88:91], s50 offen lds
    s_lshl_b32 s47, s34, 1
    s_cmp_eq_u32 s34, 0
    s_cselect_b32 s56, 0x81084000, s56
    s_cselect_b32 s57, 0x8102040, s57
    s_cmp_eq_u32 s34, 1
    s_cselect_b32 s56, 0x2108000, s56
    s_cselect_b32 s57, 0x10204081, s57
    s_cmp_eq_u32 s34, 2
    s_cselect_b32 s56, 0x8000000, s56
    s_cselect_b32 s57, 0x40810204, s57
    s_cmp_eq_u32 s34, 3
    s_cselect_b32 s56, 0x10000000, s56
    s_cselect_b32 s57, 0x81020408, s57
    s_cmp_eq_u32 s34, 4
    s_cselect_b32 s56, 0x20421249, s56
    s_cselect_b32 s57, 0x2040810, s57
    s_cmp_eq_u32 s34, 5
    s_cselect_b32 s56, 0x40842492, s56
    s_cselect_b32 s57, 0x4081020, s57
    s_cmp_eq_u32 s34, 6
    s_cselect_b32 s56, 0x4210924, s56
    s_cselect_b32 s57, 0x20408102, s57
    s_ff1_i32_b64 s36, s[56:57]
    s_bitset0_b64 s[56:57], s36
    s_mov_b32 s45, 0
    s_lshl_b32 s46, s32, 7
    s_add_u32 s46, s46, 0x3f80000
L_kvw_74:
    v_lshrrev_b32 v193, 2, v1
    v_and_b32 v193, 0x7c, v193
    buffer_load_dword v192, v193, s[4:7], s46 offen sc1
    s_sub_u32 s35, s35, 1
    s_cbranch_scc1 L_exit_1
    s_waitcnt vmcnt(0)
    v_bfe_u32 v193, v1, 6, 1
    v_lshl_add_u32 v193, v192, 1, v193
    v_bfe_u32 v194, v1, 7, 1
    v_lshl_add_u32 v193, v194, 5, v193
    v_cmp_le_u32 vcc, 16, v192
    v_mov_b32 v194, 64
    s_nop 0
    v_cndmask_b32 v193, v193, v194, vcc
    s_nop 1
    v_min_u32_dpp v193, v193, v193 row_ror:8 row_mask:0xf bank_mask:0xf
    s_nop 1
    v_min_u32_dpp v193, v193, v193 row_ror:4 row_mask:0xf bank_mask:0xf
    s_nop 1
    v_min_u32_dpp v193, v193, v193 row_ror:2 row_mask:0xf bank_mask:0xf
    s_nop 1
    v_min_u32_dpp v193, v193, v193 row_ror:1 row_mask:0xf bank_mask:0xf
    s_nop 0
    v_readfirstlane_b32 s45, v193
    s_nop 1
    s_cmp_gt_u32 s45, s36
    s_cbranch_scc1 L_kvd_75
    s_sleep 4
    s_branch L_kvw_74
L_kvd_75:
    s_lshl_b32 s48, s36, 5
    s_add_u32 s48, s48, s32
    s_lshl_b32 s48, s48, 13
    s_and_b32 s49, s33, 1
    s_lshl_b32 s49, s49, 12
    s_add_u32 s49, s49, s48
    s_add_u32 s49, s49, 0x200000
    buffer_load_dwordx4 v[16:19], v1, s[4:7], s49 offen offset:0
    buffer_load_dwordx4 v[20:23], v1, s[4:7], s49 offen offset:1024
    buffer_load_dwordx4 v[24:27], v1, s[4:7], s49 offen offset:2048
    buffer_load_dwordx4 v[28:31], v1, s[4:7], s49 offen offset:3072
    s_add_u32 s49, s48, 0x1200000
    buffer_load_dwordx4 v[32:35], v1, s[4:7], s49 offen offset:0
    buffer_load_dwordx4 v[36:39], v1, s[4:7], s49 offen offset:1024
    buffer_load_dwordx4 v[40:43], v1, s[4:7], s49 offen offset:2048
    buffer_load_dwordx4 v[44:47], v1, s[4:7], s49 offen offset:3072
    s_add_u32 s49, s48, 0x1201000
    buffer_load_dwordx4 v[48:51], v1, s[4:7], s49 offen offset:0
    buffer_load_dwordx4 v[52:55], v1, s[4:7], s49 offen offset:1024
    buffer_load_dwordx4 v[56:59], v1, s[4:7], s49 offen offset:2048
    buffer_load_dwordx4 v[60:63], v1, s[4:7], s49 offen offset:3072
    s_add_u32 s49, s48, 0x2200000
    buffer_load_dwordx4 v[64:67], v1, s[4:7], s49 offen offset:0
    buffer_load_dwordx4 v[68:71], v1, s[4:7], s49 offen offset:1024
    buffer_load_dwordx4 v[72:75], v1, s[4:7], s49 offen offset:2048
    buffer_load_dwordx4 v[76:79], v1, s[4:7], s49 offen offset:3072
    s_add_u32 s49, s48, 0x2201000
    buffer_load_dwordx4 v[80:83], v1, s[4:7], s49 offen offset:0
    buffer_load_dwordx4 v[84:87], v1, s[4:7], s49 offen offset:1024
    buffer_load_dwordx4 v[88:91], v1, s[4:7], s49 offen offset:2048
    buffer_load_dwordx4 v[92:95], v1, s[4:7], s49 offen offset:3072
    v_lshrrev_b32 v6, 2, v0
    v_lshlrev_b32 v6, 6, v6
    v_and_b32 v7, 3, v0
    v_lshl_add_u32 v6, v7, 3, v6
    s_lshl_b32 s51, s36, 5
    s_add_u32 s51, s51, s32
    s_lshl_b32 s51, s51, 10
    buffer_load_dwordx2 v[12:13], v6, s[12:15], s51 offen
    buffer_load_dwordx2 v[14:15], v6, s[12:15], s51 offen offset:32
L_p2_76:
    s_cmp_ge_u32 s44, 16
    s_cbranch_scc1 L_p2fin_78
    s_cmp_lg_u32 s33, 0
    s_cbranch_scc1 L_dec_80
    s_lshl_b32 s42, s32, 6
    s_add_u32 s42, s42, 0x3f83000
    s_add_u32 s40, s36, 2
    s_lshl_b32 s49, s44, 4
    s_lshl_b32 s50, s34, 9
    s_add_u32 s49, s49, s50
    s_add_u32 s49, s49, 0x3f88600
L_lp_81:
    buffer_load_dwordx4 v[192:195], off, s[4:7], s42 sc1
    buffer_load_dwordx4 v[196:199], off, s[4:7], s49 sc1
    buffer_load_dwordx4 v[200:203], off, s[4:7], s49 offset:16 sc1
    s_sub_u32 s35, s35, 1
    s_cbranch_scc1 L_exit_1
    s_waitcnt vmcnt(0)
    v_min_u32 v6, v192, v193
    v_min3_u32 v6, v6, v194, v195
    s_nop 0
    v_readfirstlane_b32 s48, v6
    v_min_u32 v7, v196, v197
    v_min3_u32 v7, v7, v198, v199
    v_cmp_eq_u32 vcc, 0, v7
    s_mov_b32 s51, 1
    s_cmp_ge_u32 s48, s40
    s_cbranch_scc1 L_go_82
    s_nop 1
L_nk_83:
    s_add_u32 s48, s48, 2
    s_cmp_lt_u32 s40, 62
    s_cselect_b32 s48, 0, s48
    s_cmp_ge_u32 s48, s40
    s_cbranch_scc1 L_lp_81
    s_mul_i32 s50, s62, 3
    s_add_u32 s50, s50, 5
    s_cmp_lt_u32 s62, 2
    s_cselect_b32 s50, s50, 99
    s_mov_b32 s51, 3
    s_cmp_ge_u32 s44, s50
    s_cbranch_scc1 L_go_82
    v_min_u32 v6, v200, v201
    v_min3_u32 v6, v6, v202, v203
    s_nop 0
    v_readfirstlane_b32 s50, v6
    s_cmp_eq_u32 s44, 15
    s_nop 0
    s_cselect_b32 s50, 0, s50
    s_cmp_eq_u32 s50, 0
    s_cselect_b32 s51, 2, 4
    s_cbranch_vccz L_go_82
    s_mov_b32 s51, 3
    s_cmp_lt_u32 s44, 3
    s_cbranch_scc1 L_nsl_85
    s_cmp_lt_u32 s36, 64
    s_cselect_b32 s50, 2, 3
    s_cmp_lt_u32 s62, s50
    s_cbranch_scc1 L_go_82
L_nsl_85:
    s_sleep 4
    s_cmp_ge_u32 s44, 14
    s_cbranch_scc1 L_lp_81
    s_sleep 12
    s_branch L_lp_81
L_go_82:
    v_mov_b32 v6, s51
    v_mov_b32 v7, 156000
    ds_write_b32 v7, v6
    s_waitcnt lgkmcnt(0)
L_dec_80:
    s_barrier
    v_mov_b32 v7, 156000
    ds_read_b32 v6, v7
    s_waitcnt lgkmcnt(0)
    v_readfirstlane_b32 s48, v6
    s_nop 1
    s_cmp_eq_u32 s48, 1
    s_nop 1
    s_cbranch_scc1 L_lp2_79
    s_mov_b32 s41, s48
    s_cmp_lg_u32 s48, 3
    s_cbranch_scc1 L_ch_86
    s_cmp_lg_u32 s62, 0
    s_cbranch_scc1 L_pr_87
    v_and_b32 v144, 15, v0
    v_lshrrev_b32 v145, 4, v0
    v_lshrrev_b32 v146, 2, v144
    v_and_b32 v147, 3, v144
    v_lshl_add_u32 v146, v145, 2, v146
    v_bfe_u32 v145, v146, 1, 2
    v_lshlrev_b32 v146, 7, v146
    v_lshl_add_u32 v146, v147, 3, v146
    v_lshl_add_u32 v146, v145, 5, v146
    s_lshl_b32 s48, s33, 12
    s_add_u32 s48, s48, 73728
    v_xor_b32 v148, 0, v146
    v_add_u32 v148, s48, v148
    v_add_u32 v152, 49152, v148
    v_xor_b32 v149, 32, v146
    v_add_u32 v149, s48, v149
    v_add_u32 v153, 49152, v149
    v_xor_b32 v150, 64, v146
    v_add_u32 v150, s48, v150
    v_add_u32 v154, 49152, v150
    v_xor_b32 v151, 96, v146
    v_add_u32 v151, s48, v151
    v_add_u32 v155, 49152, v151
    s_waitcnt vmcnt(0)
    s_barrier
    ds_read_b64_tr_b16 a[128:129], v148 offset:0
    ds_read_b64_tr_b16 a[130:131], v148 offset:2048
    ds_read_b64_tr_b16 a[132:133], v149 offset:0
    ds_read_b64_tr_b16 a[134:135], v149 offset:2048
    ds_read_b64_tr_b16 a[136:137], v150 offset:0
    ds_read_b64_tr_b16 a[138:139], v150 offset:2048
    ds_read_b64_tr_b16 a[140:141], v151 offset:0
    ds_read_b64_tr_b16 a[142:143], v151 offset:2048
    s_waitcnt lgkmcnt(4)
    ds_read_b64_tr_b16 a[144:145], v148 offset:16384
    ds_read_b64_tr_b16 a[146:147], v148 offset:18432
    ds_read_b64_tr_b16 a[148:149], v149 offset:16384
    ds_read_b64_tr_b16 a[150:151], v149 offset:18432
    ds_read_b64_tr_b16 a[152:153], v150 offset:16384
    ds_read_b64_tr_b16 a[154:155], v150 offset:18432
    ds_read_b64_tr_b16 a[156:157], v151 offset:16384
    ds_read_b64_tr_b16 a[158:159], v151 offset:18432
    s_waitcnt lgkmcnt(4)
    ds_read_b64_tr_b16 a[160:161], v148 offset:32768
    ds_read_b64_tr_b16 a[162:163], v148 offset:34816
    ds_read_b64_tr_b16 a[164:165], v149 offset:32768
    ds_read_b64_tr_b16 a[166:167], v149 offset:34816
    ds_read_b64_tr_b16 a[168:169], v150 offset:32768
    ds_read_b64_tr_b16 a[170:171], v150 offset:34816
    ds_read_b64_tr_b16 a[172:173], v151 offset:32768
    ds_read_b64_tr_b16 a[174:175], v151 offset:34816
    s_waitcnt lgkmcnt(4)
    ds_read_b64_tr_b16 a[176:177], v152 offset:0
    ds_read_b64_tr_b16 a[178:179], v152 offset:2048
    ds_read_b64_tr_b16 a[180:181], v153 offset:0
    ds_read_b64_tr_b16 a[182:183], v153 offset:2048
    ds_read_b64_tr_b16 a[184:185], v154 offset:0
    ds_read_b64_tr_b16 a[186:187], v154 offset:2048
    ds_read_b64_tr_b16 a[188:189], v155 offset:0
    ds_read_b64_tr_b16 a[190:191], v155 offset:2048
    s_waitcnt lgkmcnt(4)
    ds_read_b64_tr_b16 a[192:193], v152 offset:16384
    ds_read_b64_tr_b16 a[194:195], v152 offset:18432
    ds_read_b64_tr_b16 a[196:197], v153 offset:16384
    ds_read_b64_tr_b16 a[198:199], v153 offset:18432
    ds_read_b64_tr_b16 a[200:201], v154 offset:16384
    ds_read_b64_tr_b16 a[202:203], v154 offset:18432
    ds_read_b64_tr_b16 a[204:205], v155 offset:16384
    ds_read_b64_tr_b16 a[206:207], v155 offset:18432
    s_waitcnt lgkmcnt(4)
    s_waitcnt lgkmcnt(0)
    s_barrier
    s_add_u32 m0, s3, 73728
    s_add_u32 s48, s101, 2621440
    buffer_load_dwordx4 v142, s[96:99], s48 offen lds
    s_add_u32 m0, s3, 77824
    s_add_u32 s48, s101, 2752512
    buffer_load_dwordx4 v142, s[96:99], s48 offen lds
    s_add_u32 m0, s3, 81920
    s_add_u32 s48, s101, 2883584
    buffer_load_dwordx4 v142, s[96:99], s48 offen lds
    s_add_u32 m0, s3, 86016
    s_add_u32 s48, s101, 3014656
    buffer_load_dwordx4 v142, s[96:99], s48 offen lds
    s_add_u32 m0, s3, 90112
    s_add_u32 s48, s101, 3145728
    buffer_load_dwordx4 v142, s[96:99], s48 offen lds
    s_add_u32 m0, s3, 94208
    s_add_u32 s48, s101, 3276800
    buffer_load_dwordx4 v142, s[96:99], s48 offen lds
    s_add_u32 m0, s3, 98304
    s_add_u32 s48, s101, 3407872
    buffer_load_dwordx4 v142, s[96:99], s48 offen lds
    s_add_u32 m0, s3, 102400
    s_add_u32 s48, s101, 3538944
    buffer_load_dwordx4 v142, s[96:99], s48 offen lds
    s_add_u32 m0, s3, 106496
    s_add_u32 s48, s101, 3670016
    buffer_load_dwordx4 v142, s[96:99], s48 offen lds
    s_add_u32 m0, s3, 110592
    s_add_u32 s48, s101, 3801088
    buffer_load_dwordx4 v142, s[96:99], s48 offen lds
    s_add_u32 m0, s3, 114688
    s_add_u32 s48, s101, 3932160
    buffer_load_dwordx4 v142, s[96:99], s48 offen lds
    s_add_u32 m0, s3, 118784
    s_add_u32 s48, s101, 4063232
    buffer_load_dwordx4 v142, s[96:99], s48 offen lds
    s_add_u32 m0, s3, 122880
    s_add_u32 s48, s101, 4194304
    buffer_load_dwordx4 v142, s[96:99], s48 offen lds
    s_add_u32 m0, s3, 126976
    s_add_u32 s48, s101, 4325376
    buffer_load_dwordx4 v142, s[96:99], s48 offen lds
    s_add_u32 m0, s3, 131072
    s_add_u32 s48, s101, 4456448
    buffer_load_dwordx4 v142, s[96:99], s48 offen lds
    s_add_u32 m0, s3, 135168
    s_add_u32 s48, s101, 4587520
    buffer_load_dwordx4 v142, s[96:99], s48 offen lds
    s_add_u32 m0, s3, 139264
    s_add_u32 s48, s101, 4718592
    buffer_load_dwordx4 v142, s[96:99], s48 offen lds
    s_add_u32 m0, s3, 143360
    s_add_u32 s48, s101, 4849664
    buffer_load_dwordx4 v142, s[96:99], s48 offen lds
    s_add_u32 m0, s3, 147456
    s_add_u32 s48, s101, 4980736
    buffer_load_dwordx4 v142, s[96:99], s48 offen lds
    s_add_u32 m0, s3, 151552
    s_add_u32 s48, s101, 5111808
    buffer_load_dwordx4 v142, s[96:99], s48 offen lds
    s_mov_b32 s62, 1
    s_branch L_p2_76
L_pr_87:
    s_cmp_lg_u32 s62, 1
    s_cbranch_scc1 L_pr_88
    v_and_b32 v144, 15, v0
    v_lshrrev_b32 v145, 4, v0
    v_lshrrev_b32 v146, 2, v144
    v_and_b32 v147, 3, v144
    v_lshl_add_u32 v146, v145, 2, v146
    v_bfe_u32 v145, v146, 1, 2
    v_lshlrev_b32 v146, 7, v146
    v_lshl_add_u32 v146, v147, 3, v146
    v_lshl_add_u32 v146, v145, 5, v146
    s_lshl_b32 s48, s33, 12
    s_add_u32 s48, s48, 73728
    v_xor_b32 v148, 0, v146
    v_add_u32 v148, s48, v148
    v_add_u32 v152, 49152, v148
    v_xor_b32 v149, 32, v146
    v_add_u32 v149, s48, v149
    v_add_u32 v153, 49152, v149
    v_xor_b32 v150, 64, v146
    v_add_u32 v150, s48, v150
    v_add_u32 v154, 49152, v150
    v_xor_b32 v151, 96, v146
    v_add_u32 v151, s48, v151
    v_add_u32 v155, 49152, v151
    s_waitcnt vmcnt(0)
    s_barrier
    ds_read_b64_tr_b16 a[208:209], v148 offset:0
    ds_read_b64_tr_b16 a[210:211], v148 offset:2048
    ds_read_b64_tr_b16 a[212:213], v149 offset:0
    ds_read_b64_tr_b16 a[214:215], v149 offset:2048
    ds_read_b64_tr_b16 a[216:217], v150 offset:0
    ds_read_b64_tr_b16 a[218:219], v150 offset:2048
    ds_read_b64_tr_b16 a[220:221], v151 offset:0
    ds_read_b64_tr_b16 a[222:223], v151 offset:2048
    s_waitcnt lgkmcnt(4)
    ds_read_b64_tr_b16 a[224:225], v148 offset:16384
    ds_read_b64_tr_b16 a[226:227], v148 offset:18432
    ds_read_b64_tr_b16 a[228:229], v149 offset:16384
    ds_read_b64_tr_b16 a[230:231], v149 offset:18432
    ds_read_b64_tr_b16 a[232:233], v150 offset:16384
    ds_read_b64_tr_b16 a[234:235], v150 offset:18432
    ds_read_b64_tr_b16 a[236:237], v151 offset:16384
    ds_read_b64_tr_b16 a[238:239], v151 offset:18432
    s_waitcnt lgkmcnt(4)
    ds_read_b64_tr_b16 a[240:241], v148 offset:32768
    ds_read_b64_tr_b16 a[242:243], v148 offset:34816
    ds_read_b64_tr_b16 a[244:245], v149 offset:32768
    ds_read_b64_tr_b16 a[246:247], v149 offset:34816
    ds_read_b64_tr_b16 a[248:249], v150 offset:32768
    ds_read_b64_tr_b16 a[250:251], v150 offset:34816
    ds_read_b64_tr_b16 a[252:253], v151 offset:32768
    ds_read_b64_tr_b16 a[254:255], v151 offset:34816
    s_waitcnt lgkmcnt(4)
    s_waitcnt lgkmcnt(0)
    s_barrier
    s_add_u32 m0, s3, 73728
    s_add_u32 s48, s101, 5242880
    buffer_load_dwordx4 v142, s[96:99], s48 offen lds
    s_add_u32 m0, s3, 77824
    s_add_u32 s48, s101, 5373952
    buffer_load_dwordx4 v142, s[96:99], s48 offen lds
    s_add_u32 m0, s3, 81920
    s_add_u32 s48, s101, 5505024
    buffer_load_dwordx4 v142, s[96:99], s48 offen lds
    s_add_u32 m0, s3, 86016
    s_add_u32 s48, s101, 5636096
    buffer_load_dwordx4 v142, s[96:99], s48 offen lds
    s_add_u32 m0, s3, 90112
    s_add_u32 s48, s101, 5767168
    buffer_load_dwordx4 v142, s[96:99], s48 offen lds
    s_add_u32 m0, s3, 94208
    s_add_u32 s48, s101, 5898240
    buffer_load_dwordx4 v142, s[96:99], s48 offen lds
    s_add_u32 m0, s3, 98304
    s_add_u32 s48, s101, 6029312
    buffer_load_dwordx4 v142, s[96:99], s48 offen lds
    s_add_u32 m0, s3, 102400
    s_add_u32 s48, s101, 6160384
    buffer_load_dwordx4 v142, s[96:99], s48 offen lds
    s_add_u32 m0, s3, 106496
    s_add_u32 s48, s101, 6291456
    buffer_load_dwordx4 v142, s[96:99], s48 offen lds
    s_add_u32 m0, s3, 110592
    s_add_u32 s48, s101, 6422528
    buffer_load_dwordx4 v142, s[96:99], s48 offen lds
    s_add_u32 m0, s3, 114688
    s_add_u32 s48, s101, 6553600
    buffer_load_dwordx4 v142, s[96:99], s48 offen lds
    s_add_u32 m0, s3, 118784
    s_add_u32 s48, s101, 6684672
    buffer_load_dwordx4 v142, s[96:99], s48 offen lds
    s_mov_b32 s62, 2
    s_branch L_p2_76
L_pr_88:
    s_cmp_lg_u32 s62, 2
    s_cbranch_scc1 L_pr_89
    v_and_b32 v144, 15, v0
    v_lshrrev_b32 v145, 4, v0
    v_lshrrev_b32 v146, 2, v144
    v_and_b32 v147, 3, v144
    v_lshl_add_u32 v146, v145, 2, v146
    v_bfe_u32 v145, v146, 1, 2
    v_lshlrev_b32 v146, 7, v146
    v_lshl_add_u32 v146, v147, 3, v146
    v_lshl_add_u32 v146, v145, 5, v146
    s_lshl_b32 s48, s33, 12
    s_add_u32 s48, s48, 73728
    v_xor_b32 v148, 0, v146
    v_add_u32 v148, s48, v148
    v_add_u32 v152, 49152, v148
    v_xor_b32 v149, 32, v146
    v_add_u32 v149, s48, v149
    v_add_u32 v153, 49152, v149
    v_xor_b32 v150, 64, v146
    v_add_u32 v150, s48, v150
    v_add_u32 v154, 49152, v150
    v_xor_b32 v151, 96, v146
    v_add_u32 v151, s48, v151
    v_add_u32 v155, 49152, v151
    s_waitcnt vmcnt(0)
    s_barrier
    ds_read_b64_tr_b16 a[0:1], v152 offset:0
    ds_read_b64_tr_b16 a[2:3], v152 offset:2048
    ds_read_b64_tr_b16 a[4:5], v153 offset:0
    ds_read_b64_tr_b16 a[6:7], v153 offset:2048
    ds_read_b64_tr_b16 a[8:9], v154 offset:0
    ds_read_b64_tr_b16 a[10:11], v154 offset:2048
    ds_read_b64_tr_b16 a[12:13], v155 offset:0
    ds_read_b64_tr_b16 a[14:15], v155 offset:2048
    s_waitcnt lgkmcnt(4)
    ds_read_b64_tr_b16 a[16:17], v152 offset:16384
    ds_read_b64_tr_b16 a[18:19], v152 offset:18432
    ds_read_b64_tr_b16 a[20:21], v153 offset:16384
    ds_read_b64_tr_b16 a[22:23], v153 offset:18432
    ds_read_b64_tr_b16 a[24:25], v154 offset:16384
    ds_read_b64_tr_b16 a[26:27], v154 offset:18432
    ds_read_b64_tr_b16 a[28:29], v155 offset:16384
    ds_read_b64_tr_b16 a[30:31], v155 offset:18432
    s_waitcnt lgkmcnt(4)
    ds_read_b64_tr_b16 a[32:33], v148 offset:0
    ds_read_b64_tr_b16 a[34:35], v148 offset:2048
    ds_read_b64_tr_b16 a[36:37], v149 offset:0
    ds_read_b64_tr_b16 a[38:39], v149 offset:2048
    ds_read_b64_tr_b16 a[40:41], v150 offset:0
    ds_read_b64_tr_b16 a[42:43], v150 offset:2048
    ds_read_b64_tr_b16 a[44:45], v151 offset:0
    ds_read_b64_tr_b16 a[46:47], v151 offset:2048
    s_waitcnt lgkmcnt(4)
    ds_read_b64_tr_b16 a[48:49], v148 offset:16384
    ds_read_b64_tr_b16 a[50:51], v148 offset:18432
    ds_read_b64_tr_b16 a[52:53], v149 offset:16384
    ds_read_b64_tr_b16 a[54:55], v149 offset:18432
    ds_read_b64_tr_b16 a[56:57], v150 offset:16384
    ds_read_b64_tr_b16 a[58:59], v150 offset:18432
    ds_read_b64_tr_b16 a[60:61], v151 offset:16384
    ds_read_b64_tr_b16 a[62:63], v151 offset:18432
    s_waitcnt lgkmcnt(4)
    ds_read_b64_tr_b16 a[64:65], v148 offset:32768
    ds_read_b64_tr_b16 a[66:67], v148 offset:34816
    ds_read_b64_tr_b16 a[68:69], v149 offset:32768
    ds_read_b64_tr_b16 a[70:71], v149 offset:34816
    ds_read_b64_tr_b16 a[72:73], v150 offset:32768
    ds_read_b64_tr_b16 a[74:75], v150 offset:34816
    ds_read_b64_tr_b16 a[76:77], v151 offset:32768
    ds_read_b64_tr_b16 a[78:79], v151 offset:34816
    s_waitcnt lgkmcnt(4)
    s_waitcnt lgkmcnt(0)
    s_mov_b32 s62, 3
    s_branch L_p2_76
L_pr_89:
    s_cmp_lg_u32 s62, 3
    s_cbranch_scc1 L_pr_90
    v_and_b32 v144, 15, v0
    v_lshrrev_b32 v145, 4, v0
    v_lshrrev_b32 v146, 2, v144
    v_and_b32 v147, 3, v144
    v_lshl_add_u32 v146, v145, 2, v146
    v_bfe_u32 v145, v146, 1, 2
    v_lshlrev_b32 v146, 7, v146
    v_lshl_add_u32 v146, v147, 3, v146
    v_lshl_add_u32 v146, v145, 5, v146
    s_lshl_b32 s48, s33, 12
    s_add_u32 s48, s48, 73728
    v_xor_b32 v148, 0, v146
    v_add_u32 v148, s48, v148
    v_add_u32 v152, 49152, v148
    v_xor_b32 v149, 32, v146
    v_add_u32 v149, s48, v149
    v_add_u32 v153, 49152, v149
    v_xor_b32 v150, 64, v146
    v_add_u32 v150, s48, v150
    v_add_u32 v154, 49152, v150
    v_xor_b32 v151, 96, v146
    v_add_u32 v151, s48, v151
    v_add_u32 v155, 49152, v151
    s_waitcnt vmcnt(0)
    s_barrier
    v_subrev_u32 v148, 73728, v148
    v_subrev_u32 v149, 73728, v149
    v_subrev_u32 v150, 73728, v150
    v_subrev_u32 v151, 73728, v151
    ds_read_b64_tr_b16 a[80:81], v148 offset:0
    ds_read_b64_tr_b16 a[82:83], v148 offset:2048
    ds_read_b64_tr_b16 a[84:85], v149 offset:0
    ds_read_b64_tr_b16 a[86:87], v149 offset:2048
    ds_read_b64_tr_b16 a[88:89], v150 offset:0
    ds_read_b64_tr_b16 a[90:91], v150 offset:2048
    ds_read_b64_tr_b16 a[92:93], v151 offset:0
    ds_read_b64_tr_b16 a[94:95], v151 offset:2048
    s_waitcnt lgkmcnt(4)
    s_waitcnt lgkmcnt(0)
    s_mov_b32 s62, 4
    s_branch L_p2_76
L_pr_90:
L_ch_86:
    s_lshl_b32 s48, s44, 17
    s_lshl_b32 s49, s33, 13
    s_add_u32 s48, s48, s49
    s_and_b32 s49, s100, 7
    s_lshl_b32 s49, s49, 7
    s_add_u32 s48, s48, s49
    s_add_u32 s48, s48, 0x8200000
    s_and_b32 s51, s44, 1
    s_lshl_b32 s51, s51, 15
    s_lshl_b32 s50, s33, 10
    s_add_u32 s49, s51, s50
    s_add_u32 m0, s49, 16384
    s_add_u32 s50, s48, 0
    buffer_load_dwordx4 v137, s[4:7], s50 offen lds
    s_add_u32 m0, s49, 20480
    s_add_u32 s50, s48, 32768
    buffer_load_dwordx4 v137, s[4:7], s50 offen lds
    s_add_u32 m0, s49, 24576
    s_add_u32 s50, s48, 65536
    buffer_load_dwordx4 v137, s[4:7], s50 offen lds
    s_add_u32 m0, s49, 28672
    s_add_u32 s50, s48, 98304
    buffer_load_dwordx4 v137, s[4:7], s50 offen lds
    v_add_u32 v144, s51, v138
    v_add_u32 v145, s51, v139
    v_add_u32 v146, s51, v140
    v_add_u32 v147, s51, v141
    s_cmp_eq_u32 s44, 15
    s_nop 0
    s_cbranch_scc1 L_13_91
    s_add_u32 s50, s44, 1
    s_mul_i32 s48, s50, 458752
    s_mul_i32 s49, s33, 28672
    s_add_u32 s48, s48, s49
    s_lshr_b32 s49, s100, 3
    s_lshl_b32 s49, s49, 7
    s_add_u32 s48, s48, s49
    s_and_b32 s49, s50, 1
    s_lshl_b32 s49, s49, 15
    s_lshl_b32 s50, s33, 10
    s_add_u32 s49, s49, s50
    s_add_u32 m0, s49, 0
    s_add_u32 s50, s48, 0
    buffer_load_dwordx4 v136, s[88:91], s50 offen lds
    s_add_u32 m0, s49, 4096
    s_add_u32 s50, s48, 114688
    buffer_load_dwordx4 v136, s[88:91], s50 offen lds
    s_add_u32 m0, s49, 8192
    s_add_u32 s50, s48, 229376
    buffer_load_dwordx4 v136, s[88:91], s50 offen lds
    s_add_u32 m0, s49, 12288
    s_add_u32 s50, s48, 344064
    buffer_load_dwordx4 v136, s[88:91], s50 offen lds
    s_branch L_14_92
L_13_91:
    s_lshr_b32 s50, s100, 3
    s_lshl_b32 s48, s50, 7
    s_and_b32 s49, s33, 1
    s_lshl_b32 s49, s49, 6
    s_add_u32 s48, s48, s49
    v_lshrrev_b32 v20, 4, v0
    v_lshlrev_b32 v20, 3, v20
    buffer_load_dwordx2 v[16:17], v20, s[92:95], s48 offen
    buffer_load_dwordx2 v[18:19], v20, s[92:95], s48 offen offset:32
    s_add_u32 m0, s3, 0
    s_add_u32 s48, s101, 6815744
    buffer_load_dwordx4 v142, s[96:99], s48 offen lds
    s_add_u32 m0, s3, 4096
    s_add_u32 s48, s101, 6946816
    buffer_load_dwordx4 v142, s[96:99], s48 offen lds
    s_add_u32 m0, s3, 8192
    s_add_u32 s48, s101, 7077888
    buffer_load_dwordx4 v142, s[96:99], s48 offen lds
    s_add_u32 m0, s3, 12288
    s_add_u32 s48, s101, 7208960
    buffer_load_dwordx4 v142, s[96:99], s48 offen lds
L_14_92:
    s_waitcnt vmcnt(4)
    s_barrier
    ds_read_b64_tr_b16 v[152:153], v144 offset:0
    ds_read_b64_tr_b16 v[154:155], v144 offset:512
    ds_read_b64_tr_b16 v[156:157], v145 offset:0
    ds_read_b64_tr_b16 v[158:159], v145 offset:512
    ds_read_b64_tr_b16 v[160:161], v146 offset:0
    ds_read_b64_tr_b16 v[162:163], v146 offset:512
    ds_read_b64_tr_b16 v[164:165], v147 offset:0
    ds_read_b64_tr_b16 v[166:167], v147 offset:512
    ds_read_b64_tr_b16 v[168:169], v144 offset:4096
    ds_read_b64_tr_b16 v[170:171], v144 offset:4608
    ds_read_b64_tr_b16 v[172:173], v145 offset:4096
    ds_read_b64_tr_b16 v[174:175], v145 offset:4608
    ds_read_b64_tr_b16 v[176:177], v146 offset:4096
    ds_read_b64_tr_b16 v[178:179], v146 offset:4608
    ds_read_b64_tr_b16 v[180:181], v147 offset:4096
    ds_read_b64_tr_b16 v[182:183], v147 offset:4608
    s_waitcnt lgkmcnt(8)
    v_mfma_f32_16x16x32_bf16 v[120:123], v[152:155], v[160:163], v[120:123]
    v_mfma_f32_16x16x32_bf16 v[124:127], v[152:155], v[164:167], v[124:127]
    v_mfma_f32_16x16x32_bf16 v[128:131], v[156:159], v[160:163], v[128:131]
    v_mfma_f32_16x16x32_bf16 v[132:135], v[156:159], v[164:167], v[132:135]
    ds_read_b64_tr_b16 v[184:185], v144 offset:8192
    ds_read_b64_tr_b16 v[186:187], v144 offset:8704
    ds_read_b64_tr_b16 v[188:189], v145 offset:8192
    ds_read_b64_tr_b16 v[190:191], v145 offset:8704
    ds_read_b64_tr_b16 v[192:193], v146 offset:8192
    ds_read_b64_tr_b16 v[194:195], v146 offset:8704
    ds_read_b64_tr_b16 v[196:197], v147 offset:8192
    ds_read_b64_tr_b16 v[198:199], v147 offset:8704
    s_waitcnt lgkmcnt(8)
    v_mfma_f32_16x16x32_bf16 v[120:123], v[168:171], v[176:179], v[120:123]
    v_mfma_f32_16x16x32_bf16 v[124:127], v[168:171], v[180:183], v[124:127]
    v_mfma_f32_16x16x32_bf16 v[128:131], v[172:175], v[176:179], v[128:131]
    v_mfma_f32_16x16x32_bf16 v[132:135], v[172:175], v[180:183], v[132:135]
    ds_read_b64_tr_b16 v[200:201], v144 offset:12288
    ds_read_b64_tr_b16 v[202:203], v144 offset:12800
    ds_read_b64_tr_b16 v[204:205], v145 offset:12288
    ds_read_b64_tr_b16 v[206:207], v145 offset:12800
    ds_read_b64_tr_b16 v[208:209], v146 offset:12288
    ds_read_b64_tr_b16 v[210:211], v146 offset:12800
    ds_read_b64_tr_b16 v[212:213], v147 offset:12288
    ds_read_b64_tr_b16 v[214:215], v147 offset:12800
    s_waitcnt lgkmcnt(8)
    v_mfma_f32_16x16x32_bf16 v[120:123], v[184:187], v[192:195], v[120:123]
    v_mfma_f32_16x16x32_bf16 v[124:127], v[184:187], v[196:199], v[124:127]
    v_mfma_f32_16x16x32_bf16 v[128:131], v[188:191], v[192:195], v[128:131]
    v_mfma_f32_16x16x32_bf16 v[132:135], v[188:191], v[196:199], v[132:135]
    s_waitcnt lgkmcnt(0)
    v_mfma_f32_16x16x32_bf16 v[120:123], v[200:203], v[208:211], v[120:123]
    v_mfma_f32_16x16x32_bf16 v[124:127], v[200:203], v[212:215], v[124:127]
    v_mfma_f32_16x16x32_bf16 v[128:131], v[204:207], v[208:211], v[128:131]
    v_mfma_f32_16x16x32_bf16 v[132:135], v[204:207], v[212:215], v[132:135]
    s_add_u32 s44, s44, 1
    s_cmp_lg_u32 s44, 3
    s_nop 5
    s_cbranch_scc1 L_w2_93
    s_add_u32 m0, s3, 73728
    s_add_u32 s48, s101, 0
    buffer_load_dwordx4 v142, s[96:99], s48 offen lds
    s_add_u32 m0, s3, 77824
    s_add_u32 s48, s101, 131072
    buffer_load_dwordx4 v142, s[96:99], s48 offen lds
    s_add_u32 m0, s3, 81920
    s_add_u32 s48, s101, 262144
    buffer_load_dwordx4 v142, s[96:99], s48 offen lds
    s_add_u32 m0, s3, 86016
    s_add_u32 s48, s101, 393216
    buffer_load_dwordx4 v142, s[96:99], s48 offen lds
    s_add_u32 m0, s3, 90112
    s_add_u32 s48, s101, 524288
    buffer_load_dwordx4 v142, s[96:99], s48 offen lds
    s_add_u32 m0, s3, 94208
    s_add_u32 s48, s101, 655360
    buffer_load_dwordx4 v142, s[96:99], s48 offen lds
    s_add_u32 m0, s3, 98304
    s_add_u32 s48, s101, 786432
    buffer_load_dwordx4 v142, s[96:99], s48 offen lds
    s_add_u32 m0, s3, 102400
    s_add_u32 s48, s101, 917504
    buffer_load_dwordx4 v142, s[96:99], s48 offen lds
    s_add_u32 m0, s3, 106496
    s_add_u32 s48, s101, 1048576
    buffer_load_dwordx4 v142, s[96:99], s48 offen lds
    s_add_u32 m0, s3, 110592
    s_add_u32 s48, s101, 1179648
    buffer_load_dwordx4 v142, s[96:99], s48 offen lds
    s_add_u32 m0, s3, 114688
    s_add_u32 s48, s101, 1310720
    buffer_load_dwordx4 v142, s[96:99], s48 offen lds
    s_add_u32 m0, s3, 118784
    s_add_u32 s48, s101, 1441792
    buffer_load_dwordx4 v142, s[96:99], s48 offen lds
    s_add_u32 m0, s3, 122880
    s_add_u32 s48, s101, 1572864
    buffer_load_dwordx4 v142, s[96:99], s48 offen lds
    s_add_u32 m0, s3, 126976
    s_add_u32 s48, s101, 1703936
    buffer_load_dwordx4 v142, s[96:99], s48 offen lds
    s_add_u32 m0, s3, 131072
    s_add_u32 s48, s101, 1835008
    buffer_load_dwordx4 v142, s[96:99], s48 offen lds
    s_add_u32 m0, s3, 135168
    s_add_u32 s48, s101, 1966080
    buffer_load_dwordx4 v142, s[96:99], s48 offen lds
    s_add_u32 m0, s3, 139264
    s_add_u32 s48, s101, 2097152
    buffer_load_dwordx4 v142, s[96:99], s48 offen lds
    s_add_u32 m0, s3, 143360
    s_add_u32 s48, s101, 2228224
    buffer_load_dwordx4 v142, s[96:99], s48 offen lds
    s_add_u32 m0, s3, 147456
    s_add_u32 s48, s101, 2359296
    buffer_load_dwordx4 v142, s[96:99], s48 offen lds
    s_add_u32 m0, s3, 151552
    s_add_u32 s48, s101, 2490368
    buffer_load_dwordx4 v142, s[96:99], s48 offen lds
L_w2_93:
    s_cmp_lg_u32 s41, 4
    s_cbranch_scc1 L_p2_76
    s_mov_b32 s41, 2
    s_barrier
    s_branch L_ch_86
L_lp2_79:
L_sn_94:
    s_lshl_b32 s48, s36, 5
    s_add_u32 s48, s48, s32
    s_lshl_b32 s49, s48, 12
    s_add_u32 s49, s49, 0xa020000
    buffer_load_dwordx4 v[96:99], v1, s[4:7], s49 offen offset:0 sc1
    buffer_load_dwordx4 v[100:103], v1, s[4:7], s49 offen offset:1024 sc1
    buffer_load_dwordx4 v[104:107], v1, s[4:7], s49 offen offset:2048 sc1
    buffer_load_dwordx4 v[108:111], v1, s[4:7], s49 offen offset:3072 sc1
    s_lshl_b32 s49, s48, 11
    s_add_u32 s49, s49, 0xaa10000
    buffer_load_dwordx2 v[112:113], v2, s[4:7], s49 offen offset:0 sc1
    buffer_load_dwordx2 v[114:115], v2, s[4:7], s49 offen offset:512 sc1
    buffer_load_dwordx2 v[116:117], v2, s[4:7], s49 offen offset:1024 sc1
    buffer_load_dwordx2 v[118:119], v2, s[4:7], s49 offen offset:1536 sc1
    s_waitcnt vmcnt(0)
    v_mfma_f32_16x16x32_bf16 v[192:195], v[32:35], v[16:19], 0
    v_mfma_f32_16x16x32_bf16 v[196:199], v[48:51], v[16:19], 0
    v_mfma_f32_16x16x32_bf16 v[200:203], v[96:99], v[16:19], 0
    v_mfma_f32_16x16x32_bf16 v[192:195], v[36:39], v[20:23], v[192:195]
    v_mfma_f32_16x16x32_bf16 v[196:199], v[52:55], v[20:23], v[196:199]
    v_mfma_f32_16x16x32_bf16 v[200:203], v[100:103], v[20:23], v[200:203]
    v_mfma_f32_16x16x32_bf16 v[192:195], v[40:43], v[24:27], v[192:195]
    v_mfma_f32_16x16x32_bf16 v[196:199], v[56:59], v[24:27], v[196:199]
    v_mfma_f32_16x16x32_bf16 v[200:203], v[104:107], v[24:27], v[200:203]
    v_mfma_f32_16x16x32_bf16 v[192:195], v[44:47], v[28:31], v[192:195]
    v_mfma_f32_16x16x32_bf16 v[196:199], v[60:63], v[28:31], v[196:199]
    v_mfma_f32_16x16x32_bf16 v[200:203], v[108:111], v[28:31], v[200:203]
    v_mov_b32 v209, 0
    v_mov_b32 v210, 0
    s_nop 3
    v_cndmask_b32 v192, v4, v192, s[64:65]
    v_cndmask_b32 v193, v4, v193, s[66:67]
    v_cndmask_b32 v194, v4, v194, s[68:69]
    v_cndmask_b32 v195, v4, v195, s[70:71]
    v_cndmask_b32 v196, v4, v196, s[72:73]
    v_cndmask_b32 v197, v4, v197, s[74:75]
    v_cndmask_b32 v198, v4, v198, s[76:77]
    v_cndmask_b32 v199, v4, v199, s[78:79]
    v_max3_f32 v6, v192, v193, v194
    v_max3_f32 v7, v195, v196, v197
    v_max3_f32 v6, v6, v198, v199
    v_max3_f32 v7, v7, v200, v201
    v_max_f32 v6, v6, v7
    v_mov_b32 v7, v6
    s_nop 1
    v_permlane32_swap_b32 v6, v7
    v_max_f32 v6, v6, v7
    v_mov_b32 v7, v6
    s_nop 1
    v_permlane16_swap_b32 v6, v7
    v_max_f32 v6, v6, v7
    v_mul_f32_e64 v6, -s52, v6
    v_pk_fma_f32 v[200:201], v[200:201], s[52:53], v[6:7] op_sel:[0,0,0] op_sel_hi:[1,1,0]
    v_pk_fma_f32 v[192:193], v[192:193], s[52:53], v[6:7] op_sel:[0,0,0] op_sel_hi:[1,1,0]
    v_pk_fma_f32 v[194:195], v[194:195], s[52:53], v[6:7] op_sel:[0,0,0] op_sel_hi:[1,1,0]
    v_pk_fma_f32 v[196:197], v[196:197], s[52:53], v[6:7] op_sel:[0,0,0] op_sel_hi:[1,1,0]
    v_pk_fma_f32 v[198:199], v[198:199], s[52:53], v[6:7] op_sel:[0,0,0] op_sel_hi:[1,1,0]
    v_exp_f32 v200, v200
    v_exp_f32 v201, v201
    v_exp_f32 v192, v192
    v_exp_f32 v193, v193
    v_exp_f32 v194, v194
    v_exp_f32 v195, v195
    v_exp_f32 v196, v196
    v_exp_f32 v197, v197
    v_exp_f32 v198, v198
    v_exp_f32 v199, v199
    v_cvt_pk_bf16_f32 v208, v200, v201
    v_cvt_pk_bf16_f32 v211, v200, v201
    v_cvt_pk_bf16_f32 v204, v192, v193
    v_cvt_pk_bf16_f32 v205, v194, v195
    v_cvt_pk_bf16_f32 v206, v196, v197
    v_cvt_pk_bf16_f32 v207, v198, v199
    v_mfma_f32_16x16x16_bf16 v[212:215], v[8:9], v[208:209], 0
    v_mfma_f32_16x16x16_bf16 v[144:147], v[112:113], v[208:209], 0
    v_mfma_f32_16x16x16_bf16 v[148:151], v[112:113], v[210:211], 0
    v_mfma_f32_16x16x16_bf16 v[152:155], v[114:115], v[208:209], 0
    v_mfma_f32_16x16x16_bf16 v[156:159], v[114:115], v[210:211], 0
    v_mfma_f32_16x16x16_bf16 v[160:163], v[116:117], v[208:209], 0
    v_mfma_f32_16x16x16_bf16 v[164:167], v[116:117], v[210:211], 0
    v_mfma_f32_16x16x16_bf16 v[168:171], v[118:119], v[208:209], 0
    v_mfma_f32_16x16x16_bf16 v[172:175], v[118:119], v[210:211], 0
    v_mfma_f32_16x16x32_bf16 v[212:215], v[8:11], v[204:207], v[212:215]
    v_mfma_f32_16x16x32_bf16 v[144:147], v[64:67], v[204:207], v[144:147]
    v_mfma_f32_16x16x32_bf16 v[148:151], v[68:71], v[204:207], v[148:151]
    v_mfma_f32_16x16x32_bf16 v[152:155], v[72:75], v[204:207], v[152:155]
    v_mfma_f32_16x16x32_bf16 v[156:159], v[76:79], v[204:207], v[156:159]
    v_mfma_f32_16x16x32_bf16 v[160:163], v[80:83], v[204:207], v[160:163]
    v_mfma_f32_16x16x32_bf16 v[164:167], v[84:87], v[204:207], v[164:167]
    v_mfma_f32_16x16x32_bf16 v[168:171], v[88:91], v[204:207], v[168:171]
    v_mfma_f32_16x16x32_bf16 v[172:175], v[92:95], v[204:207], v[172:175]
    v_rcp_f32 v6, v212
    s_nop 0
    v_mul_f32 v144, v144, v6
    v_mul_f32 v145, v145, v6
    v_mul_f32 v146, v146, v6
    v_mul_f32 v147, v147, v6
    v_cvt_pk_bf16_f32 v176, v144, v145
    v_cvt_pk_bf16_f32 v177, v146, v147
    v_mul_f32 v148, v148, v6
    v_mul_f32 v149, v149, v6
    v_mul_f32 v150, v150, v6
    v_mul_f32 v151, v151, v6
    v_cvt_pk_bf16_f32 v178, v148, v149
    v_cvt_pk_bf16_f32 v179, v150, v151
    v_mul_f32 v152, v152, v6
    v_mul_f32 v153, v153, v6
    v_mul_f32 v154, v154, v6
    v_mul_f32 v155, v155, v6
    v_cvt_pk_bf16_f32 v180, v152, v153
    v_cvt_pk_bf16_f32 v181, v154, v155
    v_mul_f32 v156, v156, v6
    v_mul_f32 v157, v157, v6
    v_mul_f32 v158, v158, v6
    v_mul_f32 v159, v159, v6
    v_cvt_pk_bf16_f32 v182, v156, v157
    v_cvt_pk_bf16_f32 v183, v158, v159
    v_mul_f32 v160, v160, v6
    v_mul_f32 v161, v161, v6
    v_mul_f32 v162, v162, v6
    v_mul_f32 v163, v163, v6
    v_cvt_pk_bf16_f32 v184, v160, v161
    v_cvt_pk_bf16_f32 v185, v162, v163
    v_mul_f32 v164, v164, v6
    v_mul_f32 v165, v165, v6
    v_mul_f32 v166, v166, v6
    v_mul_f32 v167, v167, v6
    v_cvt_pk_bf16_f32 v186, v164, v165
    v_cvt_pk_bf16_f32 v187, v166, v167
    v_mul_f32 v168, v168, v6
    v_mul_f32 v169, v169, v6
    v_mul_f32 v170, v170, v6
    v_mul_f32 v171, v171, v6
    v_cvt_pk_bf16_f32 v188, v168, v169
    v_cvt_pk_bf16_f32 v189, v170, v171
    v_mul_f32 v172, v172, v6
    v_mul_f32 v173, v173, v6
    v_mul_f32 v174, v174, v6
    v_mul_f32 v175, v175, v6
    v_cvt_pk_bf16_f32 v190, v172, v173
    v_cvt_pk_bf16_f32 v191, v174, v175
    s_and_b32 s50, s33, 1
    s_lshl_b32 s50, s50, 12
    s_add_u32 s50, s50, 65536
    v_add_u32 v6, s50, v1
    s_cmp_ge_u32 s33, 2
    s_nop 0
    s_cbranch_scc1 L_xc_95
    ds_write_b128 v6, v[176:179] offset:0
    ds_write_b128 v6, v[180:183] offset:1024
    ds_write_b128 v6, v[184:187] offset:2048
    ds_write_b128 v6, v[188:191] offset:3072
    s_waitcnt lgkmcnt(0)
L_xc_95:
    v_xor_b32 v6, 4096, v6
    s_barrier
    ds_read_b128 v[144:147], v6 offset:0
    ds_read_b128 v[148:151], v6 offset:1024
    ds_read_b128 v[152:155], v6 offset:2048
    ds_read_b128 v[156:159], v6 offset:3072
    s_cmp_eq_u32 s83, 0
    s_cbranch_scc1 L_c2s_96
    s_lshl_b32 s39, s47, 1
    s_and_b32 s50, s33, 1
    s_add_u32 s39, s39, s50
    s_lshl_b32 s39, s39, 19
    s_lshl_b32 s50, s32, 10
    s_add_u32 s39, s39, s50
    s_lshl_b32 s50, s33, 8
    s_add_u32 s39, s39, s50
    s_xor_b32 s38, s39, 0x80000
    s_add_u32 s39, s39, 0x4000000
    s_add_u32 s38, s38, 0x4000000
    v_mfma_f32_16x16x32_bf16 v[192:195], a[0:3], v[176:179], 0
    v_mfma_f32_16x16x32_bf16 v[196:199], a[16:19], v[176:179], 0
    v_mfma_f32_16x16x32_bf16 v[192:195], a[4:7], v[180:183], v[192:195]
    v_mfma_f32_16x16x32_bf16 v[196:199], a[20:23], v[180:183], v[196:199]
    v_mfma_f32_16x16x32_bf16 v[192:195], a[8:11], v[184:187], v[192:195]
    v_mfma_f32_16x16x32_bf16 v[196:199], a[24:27], v[184:187], v[196:199]
    v_mfma_f32_16x16x32_bf16 v[192:195], a[12:15], v[188:191], v[192:195]
    v_mfma_f32_16x16x32_bf16 v[196:199], a[28:31], v[188:191], v[196:199]
    v_mfma_f32_16x16x32_bf16 v[200:203], a[32:35], v[176:179], 0
    v_mfma_f32_16x16x32_bf16 v[204:207], a[48:51], v[176:179], 0
    v_mfma_f32_16x16x32_bf16 v[200:203], a[36:39], v[180:183], v[200:203]
    v_mfma_f32_16x16x32_bf16 v[204:207], a[52:55], v[180:183], v[204:207]
    s_nop 2
    v_cvt_pk_bf16_f32 v192, v192, v193
    v_mfma_f32_16x16x32_bf16 v[200:203], a[40:43], v[184:187], v[200:203]
    v_cvt_pk_bf16_f32 v193, v194, v195
    v_mfma_f32_16x16x32_bf16 v[204:207], a[56:59], v[184:187], v[204:207]
    v_cvt_pk_bf16_f32 v194, v196, v197
    v_mfma_f32_16x16x32_bf16 v[200:203], a[44:47], v[188:191], v[200:203]
    v_cvt_pk_bf16_f32 v195, v198, v199
    v_mfma_f32_16x16x32_bf16 v[204:207], a[60:63], v[188:191], v[204:207]
    buffer_store_dwordx4 v[192:195], v3, s[4:7], s39 offen offset:0
    v_mfma_f32_16x16x32_bf16 v[208:211], a[64:67], v[176:179], 0
    v_mfma_f32_16x16x32_bf16 v[212:215], a[80:83], v[176:179], 0
    v_mfma_f32_16x16x32_bf16 v[208:211], a[68:71], v[180:183], v[208:211]
    v_mfma_f32_16x16x32_bf16 v[212:215], a[84:87], v[180:183], v[212:215]
    s_nop 0
    v_cvt_pk_bf16_f32 v200, v200, v201
    v_mfma_f32_16x16x32_bf16 v[208:211], a[72:75], v[184:187], v[208:211]
    v_cvt_pk_bf16_f32 v201, v202, v203
    v_mfma_f32_16x16x32_bf16 v[212:215], a[88:91], v[184:187], v[212:215]
    v_cvt_pk_bf16_f32 v202, v204, v205
    v_mfma_f32_16x16x32_bf16 v[208:211], a[76:79], v[188:191], v[208:211]
    v_cvt_pk_bf16_f32 v203, v206, v207
    v_mfma_f32_16x16x32_bf16 v[212:215], a[92:95], v[188:191], v[212:215]
    buffer_store_dwordx4 v[200:203], v3, s[4:7], s39 offen offset:64
    v_mfma_f32_16x16x32_bf16 v[216:219], a[96:99], v[176:179], 0
    v_mfma_f32_16x16x32_bf16 v[220:223], a[112:115], v[176:179], 0
    v_mfma_f32_16x16x32_bf16 v[216:219], a[100:103], v[180:183], v[216:219]
    v_mfma_f32_16x16x32_bf16 v[220:223], a[116:119], v[180:183], v[220:223]
    s_nop 0
    v_cvt_pk_bf16_f32 v208, v208, v209
    v_mfma_f32_16x16x32_bf16 v[216:219], a[104:107], v[184:187], v[216:219]
    v_cvt_pk_bf16_f32 v209, v210, v211
    v_mfma_f32_16x16x32_bf16 v[220:223], a[120:123], v[184:187], v[220:223]
    v_cvt_pk_bf16_f32 v210, v212, v213
    v_mfma_f32_16x16x32_bf16 v[216:219], a[108:111], v[188:191], v[216:219]
    v_cvt_pk_bf16_f32 v211, v214, v215
    v_mfma_f32_16x16x32_bf16 v[220:223], a[124:127], v[188:191], v[220:223]
    buffer_store_dwordx4 v[208:211], v3, s[4:7], s39 offen offset:128
    s_waitcnt lgkmcnt(0)
    v_mfma_f32_16x16x32_bf16 v[224:227], a[0:3], v[144:147], 0
    v_mfma_f32_16x16x32_bf16 v[228:231], a[16:19], v[144:147], 0
    v_mfma_f32_16x16x32_bf16 v[224:227], a[4:7], v[148:151], v[224:227]
    v_mfma_f32_16x16x32_bf16 v[228:231], a[20:23], v[148:151], v[228:231]
    v_cvt_pk_bf16_f32 v216, v216, v217
    v_mfma_f32_16x16x32_bf16 v[224:227], a[8:11], v[152:155], v[224:227]
    v_cvt_pk_bf16_f32 v217, v218, v219
    v_mfma_f32_16x16x32_bf16 v[228:231], a[24:27], v[152:155], v[228:231]
    v_cvt_pk_bf16_f32 v218, v220, v221
    v_mfma_f32_16x16x32_bf16 v[224:227], a[12:15], v[156:159], v[224:227]
    v_cvt_pk_bf16_f32 v219, v222, v223
    v_mfma_f32_16x16x32_bf16 v[228:231], a[28:31], v[156:159], v[228:231]
    buffer_store_dwordx4 v[216:219], v3, s[4:7], s39 offen offset:192
    v_mfma_f32_16x16x32_bf16 v[232:235], a[32:35], v[144:147], 0
    v_mfma_f32_16x16x32_bf16 v[236:239], a[48:51], v[144:147], 0
    v_mfma_f32_16x16x32_bf16 v[232:235], a[36:39], v[148:151], v[232:235]
    v_mfma_f32_16x16x32_bf16 v[236:239], a[52:55], v[148:151], v[236:239]
    s_nop 0
    v_cvt_pk_bf16_f32 v224, v224, v225
    v_mfma_f32_16x16x32_bf16 v[232:235], a[40:43], v[152:155], v[232:235]
    v_cvt_pk_bf16_f32 v225, v226, v227
    v_mfma_f32_16x16x32_bf16 v[236:239], a[56:59], v[152:155], v[236:239]
    v_cvt_pk_bf16_f32 v226, v228, v229
    v_mfma_f32_16x16x32_bf16 v[232:235], a[44:47], v[156:159], v[232:235]
    v_cvt_pk_bf16_f32 v227, v230, v231
    v_mfma_f32_16x16x32_bf16 v[236:239], a[60:63], v[156:159], v[236:239]
    buffer_store_dwordx4 v[224:227], v3, s[4:7], s38 offen offset:0
    v_mfma_f32_16x16x32_bf16 v[240:243], a[64:67], v[144:147], 0
    v_mfma_f32_16x16x32_bf16 v[244:247], a[80:83], v[144:147], 0
    v_mfma_f32_16x16x32_bf16 v[240:243], a[68:71], v[148:151], v[240:243]
    v_mfma_f32_16x16x32_bf16 v[244:247], a[84:87], v[148:151], v[244:247]
    s_nop 0
    v_cvt_pk_bf16_f32 v232, v232, v233
    v_mfma_f32_16x16x32_bf16 v[240:243], a[72:75], v[152:155], v[240:243]
    v_cvt_pk_bf16_f32 v233, v234, v235
    v_mfma_f32_16x16x32_bf16 v[244:247], a[88:91], v[152:155], v[244:247]
    v_cvt_pk_bf16_f32 v234, v236, v237
    v_mfma_f32_16x16x32_bf16 v[240:243], a[76:79], v[156:159], v[240:243]
    v_cvt_pk_bf16_f32 v235, v238, v239
    v_mfma_f32_16x16x32_bf16 v[244:247], a[92:95], v[156:159], v[244:247]
    buffer_store_dwordx4 v[232:235], v3, s[4:7], s38 offen offset:64
    v_mfma_f32_16x16x32_bf16 v[248:251], a[96:99], v[144:147], 0
    v_mfma_f32_16x16x32_bf16 v[252:255], a[112:115], v[144:147], 0
    v_mfma_f32_16x16x32_bf16 v[248:251], a[100:103], v[148:151], v[248:251]
    v_mfma_f32_16x16x32_bf16 v[252:255], a[116:119], v[148:151], v[252:255]
    s_nop 0
    v_cvt_pk_bf16_f32 v240, v240, v241
    v_mfma_f32_16x16x32_bf16 v[248:251], a[104:107], v[152:155], v[248:251]
    v_cvt_pk_bf16_f32 v241, v242, v243
    v_mfma_f32_16x16x32_bf16 v[252:255], a[120:123], v[152:155], v[252:255]
    v_cvt_pk_bf16_f32 v242, v244, v245
    v_mfma_f32_16x16x32_bf16 v[248:251], a[108:111], v[156:159], v[248:251]
    v_cvt_pk_bf16_f32 v243, v246, v247
    v_mfma_f32_16x16x32_bf16 v[252:255], a[124:127], v[156:159], v[252:255]
    buffer_store_dwordx4 v[240:243], v3, s[4:7], s38 offen offset:128
    s_nop 4
    v_cvt_pk_bf16_f32 v248, v248, v249
    v_cvt_pk_bf16_f32 v249, v250, v251
    v_cvt_pk_bf16_f32 v250, v252, v253
    v_cvt_pk_bf16_f32 v251, v254, v255
    buffer_store_dwordx4 v[248:251], v3, s[4:7], s38 offen offset:192
    s_nop 1
    s_branch L_c2e_97
L_c2s_96:
    s_lshl_b32 s39, s47, 1
    s_and_b32 s50, s33, 1
    s_add_u32 s39, s39, s50
    s_lshl_b32 s39, s39, 19
    s_lshl_b32 s50, s32, 10
    s_add_u32 s39, s39, s50
    s_lshl_b32 s50, s33, 8
    s_add_u32 s39, s39, s50
    s_xor_b32 s38, s39, 0x80000
    s_add_u32 s39, s39, 0x4000000
    s_add_u32 s38, s38, 0x4000000
    v_mfma_f32_16x16x32_bf16 v[192:195], a[0:3], v[176:179], 0
    v_mfma_f32_16x16x32_bf16 v[196:199], a[16:19], v[176:179], 0
    v_mfma_f32_16x16x32_bf16 v[192:195], a[4:7], v[180:183], v[192:195]
    v_mfma_f32_16x16x32_bf16 v[196:199], a[20:23], v[180:183], v[196:199]
    v_mfma_f32_16x16x32_bf16 v[192:195], a[8:11], v[184:187], v[192:195]
    v_mfma_f32_16x16x32_bf16 v[196:199], a[24:27], v[184:187], v[196:199]
    v_mfma_f32_16x16x32_bf16 v[192:195], a[12:15], v[188:191], v[192:195]
    v_mfma_f32_16x16x32_bf16 v[196:199], a[28:31], v[188:191], v[196:199]
    v_mfma_f32_16x16x32_bf16 v[200:203], a[32:35], v[176:179], 0
    v_mfma_f32_16x16x32_bf16 v[204:207], a[48:51], v[176:179], 0
    v_mfma_f32_16x16x32_bf16 v[200:203], a[36:39], v[180:183], v[200:203]
    v_mfma_f32_16x16x32_bf16 v[204:207], a[52:55], v[180:183], v[204:207]
    s_nop 2
    v_cvt_pk_bf16_f32 v192, v192, v193
    v_mfma_f32_16x16x32_bf16 v[200:203], a[40:43], v[184:187], v[200:203]
    v_cvt_pk_bf16_f32 v193, v194, v195
    v_mfma_f32_16x16x32_bf16 v[204:207], a[56:59], v[184:187], v[204:207]
    v_cvt_pk_bf16_f32 v194, v196, v197
    v_mfma_f32_16x16x32_bf16 v[200:203], a[44:47], v[188:191], v[200:203]
    v_cvt_pk_bf16_f32 v195, v198, v199
    v_mfma_f32_16x16x32_bf16 v[204:207], a[60:63], v[188:191], v[204:207]
    buffer_store_dwordx4 v[192:195], v3, s[4:7], s39 offen offset:0 sc1
    v_mfma_f32_16x16x32_bf16 v[208:211], a[64:67], v[176:179], 0
    v_mfma_f32_16x16x32_bf16 v[212:215], a[80:83], v[176:179], 0
    v_mfma_f32_16x16x32_bf16 v[208:211], a[68:71], v[180:183], v[208:211]
    v_mfma_f32_16x16x32_bf16 v[212:215], a[84:87], v[180:183], v[212:215]
    s_nop 0
    v_cvt_pk_bf16_f32 v200, v200, v201
    v_mfma_f32_16x16x32_bf16 v[208:211], a[72:75], v[184:187], v[208:211]
    v_cvt_pk_bf16_f32 v201, v202, v203
    v_mfma_f32_16x16x32_bf16 v[212:215], a[88:91], v[184:187], v[212:215]
    v_cvt_pk_bf16_f32 v202, v204, v205
    v_mfma_f32_16x16x32_bf16 v[208:211], a[76:79], v[188:191], v[208:211]
    v_cvt_pk_bf16_f32 v203, v206, v207
    v_mfma_f32_16x16x32_bf16 v[212:215], a[92:95], v[188:191], v[212:215]
    buffer_store_dwordx4 v[200:203], v3, s[4:7], s39 offen offset:64 sc1
    v_mfma_f32_16x16x32_bf16 v[216:219], a[96:99], v[176:179], 0
    v_mfma_f32_16x16x32_bf16 v[220:223], a[112:115], v[176:179], 0
    v_mfma_f32_16x16x32_bf16 v[216:219], a[100:103], v[180:183], v[216:219]
    v_mfma_f32_16x16x32_bf16 v[220:223], a[116:119], v[180:183], v[220:223]
    s_nop 0
    v_cvt_pk_bf16_f32 v208, v208, v209
    v_mfma_f32_16x16x32_bf16 v[216:219], a[104:107], v[184:187], v[216:219]
    v_cvt_pk_bf16_f32 v209, v210, v211
    v_mfma_f32_16x16x32_bf16 v[220:223], a[120:123], v[184:187], v[220:223]
    v_cvt_pk_bf16_f32 v210, v212, v213
    v_mfma_f32_16x16x32_bf16 v[216:219], a[108:111], v[188:191], v[216:219]
    v_cvt_pk_bf16_f32 v211, v214, v215
    v_mfma_f32_16x16x32_bf16 v[220:223], a[124:127], v[188:191], v[220:223]
    buffer_store_dwordx4 v[208:211], v3, s[4:7], s39 offen offset:128 sc1
    s_waitcnt lgkmcnt(0)
    v_mfma_f32_16x16x32_bf16 v[224:227], a[0:3], v[144:147], 0
    v_mfma_f32_16x16x32_bf16 v[228:231], a[16:19], v[144:147], 0
    v_mfma_f32_16x16x32_bf16 v[224:227], a[4:7], v[148:151], v[224:227]
    v_mfma_f32_16x16x32_bf16 v[228:231], a[20:23], v[148:151], v[228:231]
    v_cvt_pk_bf16_f32 v216, v216, v217
    v_mfma_f32_16x16x32_bf16 v[224:227], a[8:11], v[152:155], v[224:227]
    v_cvt_pk_bf16_f32 v217, v218, v219
    v_mfma_f32_16x16x32_bf16 v[228:231], a[24:27], v[152:155], v[228:231]
    v_cvt_pk_bf16_f32 v218, v220, v221
    v_mfma_f32_16x16x32_bf16 v[224:227], a[12:15], v[156:159], v[224:227]
    v_cvt_pk_bf16_f32 v219, v222, v223
    v_mfma_f32_16x16x32_bf16 v[228:231], a[28:31], v[156:159], v[228:231]
    buffer_store_dwordx4 v[216:219], v3, s[4:7], s39 offen offset:192 sc1
    v_mfma_f32_16x16x32_bf16 v[232:235], a[32:35], v[144:147], 0
    v_mfma_f32_16x16x32_bf16 v[236:239], a[48:51], v[144:147], 0
    v_mfma_f32_16x16x32_bf16 v[232:235], a[36:39], v[148:151], v[232:235]
    v_mfma_f32_16x16x32_bf16 v[236:239], a[52:55], v[148:151], v[236:239]
    s_nop 0
    v_cvt_pk_bf16_f32 v224, v224, v225
    v_mfma_f32_16x16x32_bf16 v[232:235], a[40:43], v[152:155], v[232:235]
    v_cvt_pk_bf16_f32 v225, v226, v227
    v_mfma_f32_16x16x32_bf16 v[236:239], a[56:59], v[152:155], v[236:239]
    v_cvt_pk_bf16_f32 v226, v228, v229
    v_mfma_f32_16x16x32_bf16 v[232:235], a[44:47], v[156:159], v[232:235]
    v_cvt_pk_bf16_f32 v227, v230, v231
    v_mfma_f32_16x16x32_bf16 v[236:239], a[60:63], v[156:159], v[236:239]
    buffer_store_dwordx4 v[224:227], v3, s[4:7], s38 offen offset:0 sc1
    v_mfma_f32_16x16x32_bf16 v[240:243], a[64:67], v[144:147], 0
    v_mfma_f32_16x16x32_bf16 v[244:247], a[80:83], v[144:147], 0
    v_mfma_f32_16x16x32_bf16 v[240:243], a[68:71], v[148:151], v[240:243]
    v_mfma_f32_16x16x32_bf16 v[244:247], a[84:87], v[148:151], v[244:247]
    s_nop 0
    v_cvt_pk_bf16_f32 v232, v232, v233
    v_mfma_f32_16x16x32_bf16 v[240:243], a[72:75], v[152:155], v[240:243]
    v_cvt_pk_bf16_f32 v233, v234, v235
    v_mfma_f32_16x16x32_bf16 v[244:247], a[88:91], v[152:155], v[244:247]
    v_cvt_pk_bf16_f32 v234, v236, v237
    v_mfma_f32_16x16x32_bf16 v[240:243], a[76:79], v[156:159], v[240:243]
    v_cvt_pk_bf16_f32 v235, v238, v239
    v_mfma_f32_16x16x32_bf16 v[244:247], a[92:95], v[156:159], v[244:247]
    buffer_store_dwordx4 v[232:235], v3, s[4:7], s38 offen offset:64 sc1
    v_mfma_f32_16x16x32_bf16 v[248:251], a[96:99], v[144:147], 0
    v_mfma_f32_16x16x32_bf16 v[252:255], a[112:115], v[144:147], 0
    v_mfma_f32_16x16x32_bf16 v[248:251], a[100:103], v[148:151], v[248:251]
    v_mfma_f32_16x16x32_bf16 v[252:255], a[116:119], v[148:151], v[252:255]
    s_nop 0
    v_cvt_pk_bf16_f32 v240, v240, v241
    v_mfma_f32_16x16x32_bf16 v[248:251], a[104:107], v[152:155], v[248:251]
    v_cvt_pk_bf16_f32 v241, v242, v243
    v_mfma_f32_16x16x32_bf16 v[252:255], a[120:123], v[152:155], v[252:255]
    v_cvt_pk_bf16_f32 v242, v244, v245
    v_mfma_f32_16x16x32_bf16 v[248:251], a[108:111], v[156:159], v[248:251]
    v_cvt_pk_bf16_f32 v243, v246, v247
    v_mfma_f32_16x16x32_bf16 v[252:255], a[124:127], v[156:159], v[252:255]
    buffer_store_dwordx4 v[240:243], v3, s[4:7], s38 offen offset:128 sc1
    s_nop 4
    v_cvt_pk_bf16_f32 v248, v248, v249
    v_cvt_pk_bf16_f32 v249, v250, v251
    v_cvt_pk_bf16_f32 v250, v252, v253
    v_cvt_pk_bf16_f32 v251, v254, v255
    buffer_store_dwordx4 v[248:251], v3, s[4:7], s38 offen offset:192 sc1
    s_nop 1
L_c2e_97:
    s_waitcnt vmcnt(0)
    s_barrier
    s_lshl_b32 s42, s36, 7
    s_add_u32 s42, s42, 0x3f84000
    s_cmp_lg_u32 s33, 0
    s_cbranch_scc1 L_n0_98
    s_lshl_b32 s49, s32, 2
    s_add_u32 s49, s49, s42
    v_mov_b32 v6, 1
    s_mov_b64 exec, 1
    s_cmp_eq_u32 s83, 0
    s_cbranch_scc1 L_fs_99
    buffer_store_dword v6, off, s[4:7], s49
    s_branch L_fs_100
L_fs_99:
    buffer_store_dword v6, off, s[4:7], s49 sc1
L_fs_100:
    s_mov_b64 exec, -1
    v_lshlrev_b32 v7, 2, v0
    s_mov_b32 exec_lo, 0xffffffff
    s_mov_b32 exec_hi, 0
L_pf_101:
    buffer_load_dword v6, v7, s[4:7], s42 offen sc1
    s_sub_u32 s35, s35, 1
    s_cbranch_scc1 L_exit_1
    s_waitcnt vmcnt(0)
    v_cmp_eq_u32 vcc, 0, v6
    s_cbranch_vccz L_pfd_102
    s_nop 3
    s_branch L_pf_101
L_pfd_102:
    s_mov_b64 exec, -1
L_n0_98:
    s_barrier
    s_lshl_b32 s50, s36, 5
    s_add_u32 s50, s50, s32
    s_lshl_b32 s48, s47, 5
    s_add_u32 s48, s48, s32
    s_lshl_b32 s48, s48, 15
    s_xor_b32 s47, s47, 1
    s_lshl_b32 s49, s33, 13
    s_add_u32 s48, s48, s49
    s_add_u32 s48, s48, 0x4000000
    s_add_u32 s49, s48, 4096
    buffer_load_dwordx4 v[192:195], v1, s[4:7], s48 offen offset:0 sc1
    buffer_load_dwordx4 v[196:199], v1, s[4:7], s48 offen offset:1024 sc1
    buffer_load_dwordx4 v[200:203], v1, s[4:7], s48 offen offset:2048 sc1
    buffer_load_dwordx4 v[204:207], v1, s[4:7], s48 offen offset:3072 sc1
    buffer_load_dwordx4 v[208:211], v1, s[4:7], s49 offen offset:0 sc1
    buffer_load_dwordx4 v[212:215], v1, s[4:7], s49 offen offset:1024 sc1
    buffer_load_dwordx4 v[216:219], v1, s[4:7], s49 offen offset:2048 sc1
    buffer_load_dwordx4 v[220:223], v1, s[4:7], s49 offen offset:3072 sc1
    s_lshl_b32 s51, s50, 10
    v_lshrrev_b32 v162, 2, v0
    v_lshlrev_b32 v162, 6, v162
    v_and_b32 v160, 3, v0
    v_lshl_add_u32 v162, v160, 3, v162
    s_waitcnt vmcnt(7)
    v_lshlrev_b32 v144, 16, v192
    v_and_b32 v145, 0xffff0000, v192
    v_lshlrev_b32 v146, 16, v193
    v_and_b32 v147, 0xffff0000, v193
    v_lshlrev_b32 v148, 16, v194
    v_and_b32 v149, 0xffff0000, v194
    v_lshlrev_b32 v150, 16, v195
    v_and_b32 v151, 0xffff0000, v195
    s_waitcnt vmcnt(6)
    v_lshlrev_b32 v160, 16, v196
    v_and_b32 v161, 0xffff0000, v196
    v_add_f32 v144, v144, v160
    v_add_f32 v145, v145, v161
    v_lshlrev_b32 v160, 16, v197
    v_and_b32 v161, 0xffff0000, v197
    v_add_f32 v146, v146, v160
    v_add_f32 v147, v147, v161
    v_lshlrev_b32 v160, 16, v198
    v_and_b32 v161, 0xffff0000, v198
    v_add_f32 v148, v148, v160
    v_add_f32 v149, v149, v161
    v_lshlrev_b32 v160, 16, v199
    v_and_b32 v161, 0xffff0000, v199
    v_add_f32 v150, v150, v160
    v_add_f32 v151, v151, v161
    s_waitcnt vmcnt(5)
    v_lshlrev_b32 v160, 16, v200
    v_and_b32 v161, 0xffff0000, v200
    v_add_f32 v144, v144, v160
    v_add_f32 v145, v145, v161
    v_lshlrev_b32 v160, 16, v201
    v_and_b32 v161, 0xffff0000, v201
    v_add_f32 v146, v146, v160
    v_add_f32 v147, v147, v161
    v_lshlrev_b32 v160, 16, v202
    v_and_b32 v161, 0xffff0000, v202
    v_add_f32 v148, v148, v160
    v_add_f32 v149, v149, v161
    v_lshlrev_b32 v160, 16, v203
    v_and_b32 v161, 0xffff0000, v203
    v_add_f32 v150, v150, v160
    v_add_f32 v151, v151, v161
    s_waitcnt vmcnt(4)
    v_lshlrev_b32 v160, 16, v204
    v_and_b32 v161, 0xffff0000, v204
    v_add_f32 v144, v144, v160
    v_add_f32 v145, v145, v161
    v_lshlrev_b32 v160, 16, v205
    v_and_b32 v161, 0xffff0000, v205
    v_add_f32 v146, v146, v160
    v_add_f32 v147, v147, v161
    v_lshlrev_b32 v160, 16, v206
    v_and_b32 v161, 0xffff0000, v206
    v_add_f32 v148, v148, v160
    v_add_f32 v149, v149, v161
    v_lshlrev_b32 v160, 16, v207
    v_and_b32 v161, 0xffff0000, v207
    v_add_f32 v150, v150, v160
    v_add_f32 v151, v151, v161
    s_waitcnt vmcnt(3)
    v_lshlrev_b32 v160, 16, v208
    v_and_b32 v161, 0xffff0000, v208
    v_add_f32 v144, v144, v160
    v_add_f32 v145, v145, v161
    v_lshlrev_b32 v160, 16, v209
    v_and_b32 v161, 0xffff0000, v209
    v_add_f32 v146, v146, v160
    v_add_f32 v147, v147, v161
    v_lshlrev_b32 v160, 16, v210
    v_and_b32 v161, 0xffff0000, v210
    v_add_f32 v148, v148, v160
    v_add_f32 v149, v149, v161
    v_lshlrev_b32 v160, 16, v211
    v_and_b32 v161, 0xffff0000, v211
    v_add_f32 v150, v150, v160
    v_add_f32 v151, v151, v161
    s_waitcnt vmcnt(2)
    v_lshlrev_b32 v160, 16, v212
    v_and_b32 v161, 0xffff0000, v212
    v_add_f32 v144, v144, v160
    v_add_f32 v145, v145, v161
    v_lshlrev_b32 v160, 16, v213
    v_and_b32 v161, 0xffff0000, v213
    v_add_f32 v146, v146, v160
    v_add_f32 v147, v147, v161
    v_lshlrev_b32 v160, 16, v214
    v_and_b32 v161, 0xffff0000, v214
    v_add_f32 v148, v148, v160
    v_add_f32 v149, v149, v161
    v_lshlrev_b32 v160, 16, v215
    v_and_b32 v161, 0xffff0000, v215
    v_add_f32 v150, v150, v160
    v_add_f32 v151, v151, v161
    s_waitcnt vmcnt(1)
    v_lshlrev_b32 v160, 16, v216
    v_and_b32 v161, 0xffff0000, v216
    v_add_f32 v144, v144, v160
    v_add_f32 v145, v145, v161
    v_lshlrev_b32 v160, 16, v217
    v_and_b32 v161, 0xffff0000, v217
    v_add_f32 v146, v146, v160
    v_add_f32 v147, v147, v161
    v_lshlrev_b32 v160, 16, v218
    v_and_b32 v161, 0xffff0000, v218
    v_add_f32 v148, v148, v160
    v_add_f32 v149, v149, v161
    v_lshlrev_b32 v160, 16, v219
    v_and_b32 v161, 0xffff0000, v219
    v_add_f32 v150, v150, v160
    v_add_f32 v151, v151, v161
    s_waitcnt vmcnt(0)
    v_lshlrev_b32 v160, 16, v220
    v_and_b32 v161, 0xffff0000, v220
    v_add_f32 v144, v144, v160
    v_add_f32 v145, v145, v161
    v_lshlrev_b32 v160, 16, v221
    v_and_b32 v161, 0xffff0000, v221
    v_add_f32 v146, v146, v160
    v_add_f32 v147, v147, v161
    v_lshlrev_b32 v160, 16, v222
    v_and_b32 v161, 0xffff0000, v222
    v_add_f32 v148, v148, v160
    v_add_f32 v149, v149, v161
    v_lshlrev_b32 v160, 16, v223
    v_and_b32 v161, 0xffff0000, v223
    v_add_f32 v150, v150, v160
    v_add_f32 v151, v151, v161
    s_lshl_b32 s48, s33, 11
    v_add_u32 v160, s48, v1
    v_add_u32 v160, 65536, v160
    ds_write_b128 v160, v[144:147]
    ds_write_b128 v160, v[148:151] offset:1024
    s_waitcnt lgkmcnt(0) vmcnt(0)
    s_barrier
    s_cmp_lg_u32 s33, 0
    s_cbranch_scc1 L_r4_103
    ds_read_b128 v[200:203], v160 offset:2048
    ds_read_b128 v[204:207], v160 offset:3072
    ds_read_b128 v[208:211], v160 offset:4096
    ds_read_b128 v[212:215], v160 offset:5120
    ds_read_b128 v[216:219], v160 offset:6144
    ds_read_b128 v[220:223], v160 offset:7168
    s_waitcnt lgkmcnt(0)
    v_add_f32 v144, v144, v200
    v_add_f32 v145, v145, v201
    v_add_f32 v146, v146, v202
    v_add_f32 v147, v147, v203
    v_add_f32 v148, v148, v204
    v_add_f32 v149, v149, v205
    v_add_f32 v150, v150, v206
    v_add_f32 v151, v151, v207
    v_add_f32 v144, v144, v208
    v_add_f32 v145, v145, v209
    v_add_f32 v146, v146, v210
    v_add_f32 v147, v147, v211
    v_add_f32 v148, v148, v212
    v_add_f32 v149, v149, v213
    v_add_f32 v150, v150, v214
    v_add_f32 v151, v151, v215
    v_add_f32 v144, v144, v216
    v_add_f32 v145, v145, v217
    v_add_f32 v146, v146, v218
    v_add_f32 v147, v147, v219
    v_add_f32 v148, v148, v220
    v_add_f32 v149, v149, v221
    v_add_f32 v150, v150, v222
    v_add_f32 v151, v151, v223
    v_cvt_pk_bf16_f32 v152, v144, v145
    v_cvt_pk_bf16_f32 v153, v146, v147
    v_cvt_pk_bf16_f32 v154, v148, v149
    v_cvt_pk_bf16_f32 v155, v150, v151
    v_lshlrev_b32 v144, 16, v152
    v_and_b32 v145, 0xffff0000, v152
    v_lshlrev_b32 v146, 16, v153
    v_and_b32 v147, 0xffff0000, v153
    v_lshlrev_b32 v148, 16, v154
    v_and_b32 v149, 0xffff0000, v154
    v_lshlrev_b32 v150, 16, v155
    v_and_b32 v151, 0xffff0000, v155
    v_lshlrev_b32 v160, 16, v12
    v_and_b32 v161, 0xffff0000, v12
    v_add_f32 v144, v144, v160
    v_add_f32 v145, v145, v161
    v_lshlrev_b32 v160, 16, v13
    v_and_b32 v161, 0xffff0000, v13
    v_add_f32 v146, v146, v160
    v_add_f32 v147, v147, v161
    v_lshlrev_b32 v160, 16, v14
    v_and_b32 v161, 0xffff0000, v14
    v_add_f32 v148, v148, v160
    v_add_f32 v149, v149, v161
    v_lshlrev_b32 v160, 16, v15
    v_and_b32 v161, 0xffff0000, v15
    v_add_f32 v150, v150, v160
    v_add_f32 v151, v151, v161
    v_cvt_pk_bf16_f32 v152, v144, v145
    v_cvt_pk_bf16_f32 v153, v146, v147
    v_cvt_pk_bf16_f32 v154, v148, v149
    v_cvt_pk_bf16_f32 v155, v150, v151
    v_lshlrev_b32 v144, 16, v152
    v_and_b32 v145, 0xffff0000, v152
    v_lshlrev_b32 v146, 16, v153
    v_and_b32 v147, 0xffff0000, v153
    v_lshlrev_b32 v148, 16, v154
    v_and_b32 v149, 0xffff0000, v154
    v_lshlrev_b32 v150, 16, v155
    v_and_b32 v151, 0xffff0000, v155
    s_add_u32 s48, s51, 0x8000000
    buffer_store_dwordx2 v[152:153], v162, s[4:7], s48 offen sc1
    buffer_store_dwordx2 v[154:155], v162, s[4:7], s48 offen offset:32 sc1
    v_add_f32 v160, v144, v145
    v_add_f32 v160, v160, v146
    v_add_f32 v160, v160, v147
    v_add_f32 v160, v160, v148
    v_add_f32 v160, v160, v149
    v_add_f32 v160, v160, v150
    v_add_f32 v160, v160, v151
    s_nop 1
    v_add_f32_dpp v160, v160, v160 row_ror:8 row_mask:0xf bank_mask:0xf
    s_nop 1
    v_add_f32_dpp v160, v160, v160 row_ror:4 row_mask:0xf bank_mask:0xf
    s_nop 1
    v_add_f32_dpp v160, v160, v160 row_ror:2 row_mask:0xf bank_mask:0xf
    s_nop 1
    v_add_f32_dpp v160, v160, v160 row_ror:1 row_mask:0xf bank_mask:0xf
    v_mov_b32 v161, v160
    s_nop 1
    v_permlane32_swap_b32 v160, v161
    v_add_f32 v160, v160, v161
    v_mov_b32 v161, v160
    s_nop 1
    v_permlane16_swap_b32 v160, v161
    v_add_f32 v160, v160, v161
    v_mul_f32 v160, 0x3b000000, v160
    v_sub_f32 v144, v144, v160
    v_sub_f32 v145, v145, v160
    v_sub_f32 v146, v146, v160
    v_sub_f32 v147, v147, v160
    v_sub_f32 v148, v148, v160
    v_sub_f32 v149, v149, v160
    v_sub_f32 v150, v150, v160
    v_sub_f32 v151, v151, v160
    v_mul_f32 v160, v144, v144
    v_fmac_f32 v160, v145, v145
    v_fmac_f32 v160, v146, v146
    v_fmac_f32 v160, v147, v147
    v_fmac_f32 v160, v148, v148
    v_fmac_f32 v160, v149, v149
    v_fmac_f32 v160, v150, v150
    v_fmac_f32 v160, v151, v151
    s_nop 1
    v_add_f32_dpp v160, v160, v160 row_ror:8 row_mask:0xf bank_mask:0xf
    s_nop 1
    v_add_f32_dpp v160, v160, v160 row_ror:4 row_mask:0xf bank_mask:0xf
    s_nop 1
    v_add_f32_dpp v160, v160, v160 row_ror:2 row_mask:0xf bank_mask:0xf
    s_nop 1
    v_add_f32_dpp v160, v160, v160 row_ror:1 row_mask:0xf bank_mask:0xf
    v_mov_b32 v161, v160
    s_nop 1
    v_permlane32_swap_b32 v160, v161
    v_add_f32 v160, v160, v161
    v_mov_b32 v161, v160
    s_nop 1
    v_permlane16_swap_b32 v160, v161
    v_add_f32 v160, v160, v161
    v_mov_b32 v161, 0x3727c5ac
    v_fmac_f32 v161, 0x3b000000, v160
    v_rsq_f32 v161, v161
    s_nop 0
    v_mul_f32 v144, v144, v161
    v_mul_f32 v145, v145, v161
    v_mul_f32 v146, v146, v161
    v_mul_f32 v147, v147, v161
    v_mul_f32 v148, v148, v161
    v_mul_f32 v149, v149, v161
    v_mul_f32 v150, v150, v161
    v_mul_f32 v151, v151, v161
    v_cvt_pk_bf16_f32 v12, v144, v145
    v_cvt_pk_bf16_f32 v13, v146, v147
    v_cvt_pk_bf16_f32 v14, v148, v149
    v_cvt_pk_bf16_f32 v15, v150, v151
    v_lshlrev_b32 v144, 16, v12
    v_and_b32 v145, 0xffff0000, v12
    v_lshlrev_b32 v146, 16, v13
    v_and_b32 v147, 0xffff0000, v13
    v_lshlrev_b32 v148, 16, v14
    v_and_b32 v149, 0xffff0000, v14
    v_lshlrev_b32 v150, 16, v15
    v_and_b32 v151, 0xffff0000, v15
    v_add_f32 v160, v144, v145
    v_add_f32 v160, v160, v146
    v_add_f32 v160, v160, v147
    v_add_f32 v160, v160, v148
    v_add_f32 v160, v160, v149
    v_add_f32 v160, v160, v150
    v_add_f32 v160, v160, v151
    s_nop 1
    v_add_f32_dpp v160, v160, v160 row_ror:8 row_mask:0xf bank_mask:0xf
    s_nop 1
    v_add_f32_dpp v160, v160, v160 row_ror:4 row_mask:0xf bank_mask:0xf
    s_nop 1
    v_add_f32_dpp v160, v160, v160 row_ror:2 row_mask:0xf bank_mask:0xf
    s_nop 1
    v_add_f32_dpp v160, v160, v160 row_ror:1 row_mask:0xf bank_mask:0xf
    v_mov_b32 v161, v160
    s_nop 1
    v_permlane32_swap_b32 v160, v161
    v_add_f32 v160, v160, v161
    v_mov_b32 v161, v160
    s_nop 1
    v_permlane16_swap_b32 v160, v161
    v_add_f32 v160, v160, v161
    v_mul_f32 v160, 0x3b000000, v160
    v_sub_f32 v144, v144, v160
    v_sub_f32 v145, v145, v160
    v_sub_f32 v146, v146, v160
    v_sub_f32 v147, v147, v160
    v_sub_f32 v148, v148, v160
    v_sub_f32 v149, v149, v160
    v_sub_f32 v150, v150, v160
    v_sub_f32 v151, v151, v160
    v_mul_f32 v160, v144, v144
    v_fmac_f32 v160, v145, v145
    v_fmac_f32 v160, v146, v146
    v_fmac_f32 v160, v147, v147
    v_fmac_f32 v160, v148, v148
    v_fmac_f32 v160, v149, v149
    v_fmac_f32 v160, v150, v150
    v_fmac_f32 v160, v151, v151
    s_nop 1
    v_add_f32_dpp v160, v160, v160 row_ror:8 row_mask:0xf bank_mask:0xf
    s_nop 1
    v_add_f32_dpp v160, v160, v160 row_ror:4 row_mask:0xf bank_mask:0xf
    s_nop 1
    v_add_f32_dpp v160, v160, v160 row_ror:2 row_mask:0xf bank_mask:0xf
    s_nop 1
    v_add_f32_dpp v160, v160, v160 row_ror:1 row_mask:0xf bank_mask:0xf
    v_mov_b32 v161, v160
    s_nop 1
    v_permlane32_swap_b32 v160, v161
    v_add_f32 v160, v160, v161
    v_mov_b32 v161, v160
    s_nop 1
    v_permlane16_swap_b32 v160, v161
    v_add_f32 v160, v160, v161
    v_mov_b32 v161, 0x3727c5ac
    v_fmac_f32 v161, 0x3b000000, v160
    v_rsq_f32 v161, v161
    s_nop 0
    v_mul_f32 v144, v144, v161
    v_mul_f32 v145, v145, v161
    v_mul_f32 v146, v146, v161
    v_mul_f32 v147, v147, v161
    v_mul_f32 v148, v148, v161
    v_mul_f32 v149, v149, v161
    v_mul_f32 v150, v150, v161
    v_mul_f32 v151, v151, v161
    v_cvt_pk_bf16_f32 v12, v144, v145
    v_cvt_pk_bf16_f32 v13, v146, v147
    v_cvt_pk_bf16_f32 v14, v148, v149
    v_cvt_pk_bf16_f32 v15, v150, v151
    s_add_u32 s48, s51, 0x8200000
    buffer_store_dwordx2 v[12:13], v162, s[4:7], s48 offen sc1
    buffer_store_dwordx2 v[14:15], v162, s[4:7], s48 offen offset:32 sc1
    s_lshl_b32 s50, s36, 7
    s_add_u32 s50, s50, 0x3f86000
    s_lshl_b32 s51, s36, 2
    s_add_u32 s51, s51, 0x3f88400
    s_waitcnt vmcnt(0)
    s_lshl_b32 s49, s32, 2
    s_add_u32 s49, s49, s50
    v_mov_b32 v160, 1
    s_mov_b64 exec, 1
    s_cmp_eq_u32 s83, 0
    s_cbranch_scc1 L_fs_104
    buffer_store_dword v160, off, s[4:7], s49
    s_branch L_fs_105
L_fs_104:
    buffer_store_dword v160, off, s[4:7], s49 sc1
L_fs_105:
    s_mov_b64 exec, -1
    s_cmp_lg_u32 s32, 0
    s_cbranch_scc1 L_ga_106
    v_lshlrev_b32 v161, 2, v0
    s_mov_b32 exec_lo, 0xffffffff
    s_mov_b32 exec_hi, 0
L_pf_107:
    buffer_load_dword v160, v161, s[4:7], s50 offen sc1
    s_sub_u32 s35, s35, 1
    s_cbranch_scc1 L_exit_1
    s_waitcnt vmcnt(0)
    v_cmp_eq_u32 vcc, 0, v160
    s_cbranch_vccz L_pfd_108
    s_nop 3
    s_branch L_pf_107
L_pfd_108:
    s_mov_b64 exec, -1
    v_lshlrev_b32 v161, 9, v0
    v_mov_b32 v160, 1
    s_mov_b64 exec, 0xff
    buffer_store_dword v160, v161, s[4:7], s51 offen sc1
    s_mov_b64 exec, -1
L_ga_106:
L_r4_103:
    s_ff1_i32_b64 s36, s[56:57]
    s_bitset0_b64 s[56:57], s36
    s_cmp_lt_u32 s36, 64
    s_cbranch_scc1 L_nn_109
    s_mov_b32 s36, 999
    s_branch L_p2_76
L_nn_109:
    s_cmp_gt_u32 s45, s36
    s_cbranch_scc1 L_av_110
L_kvw_111:
    v_lshrrev_b32 v193, 2, v1
    v_and_b32 v193, 0x7c, v193
    buffer_load_dword v192, v193, s[4:7], s46 offen sc1
    s_sub_u32 s35, s35, 1
    s_cbranch_scc1 L_exit_1
    s_waitcnt vmcnt(0)
    v_bfe_u32 v193, v1, 6, 1
    v_lshl_add_u32 v193, v192, 1, v193
    v_bfe_u32 v194, v1, 7, 1
    v_lshl_add_u32 v193, v194, 5, v193
    v_cmp_le_u32 vcc, 16, v192
    v_mov_b32 v194, 64
    s_nop 0
    v_cndmask_b32 v193, v193, v194, vcc
    s_nop 1
    v_min_u32_dpp v193, v193, v193 row_ror:8 row_mask:0xf bank_mask:0xf
    s_nop 1
    v_min_u32_dpp v193, v193, v193 row_ror:4 row_mask:0xf bank_mask:0xf
    s_nop 1
    v_min_u32_dpp v193, v193, v193 row_ror:2 row_mask:0xf bank_mask:0xf
    s_nop 1
    v_min_u32_dpp v193, v193, v193 row_ror:1 row_mask:0xf bank_mask:0xf
    s_nop 0
    v_readfirstlane_b32 s45, v193
    s_nop 1
    s_cmp_gt_u32 s45, s36
    s_cbranch_scc1 L_kvd_112
    s_sleep 4
    s_branch L_kvw_111
L_kvd_112:
L_av_110:
    s_lshl_b32 s48, s36, 5
    s_add_u32 s48, s48, s32
    s_lshl_b32 s48, s48, 13
    s_and_b32 s49, s33, 1
    s_lshl_b32 s49, s49, 12
    s_add_u32 s49, s49, s48
    s_add_u32 s49, s49, 0x200000
    buffer_load_dwordx4 v[16:19], v1, s[4:7], s49 offen offset:0
    buffer_load_dwordx4 v[20:23], v1, s[4:7], s49 offen offset:1024
    buffer_load_dwordx4 v[24:27], v1, s[4:7], s49 offen offset:2048
    buffer_load_dwordx4 v[28:31], v1, s[4:7], s49 offen offset:3072
    s_add_u32 s49, s48, 0x1200000
    buffer_load_dwordx4 v[32:35], v1, s[4:7], s49 offen offset:0
    buffer_load_dwordx4 v[36:39], v1, s[4:7], s49 offen offset:1024
    buffer_load_dwordx4 v[40:43], v1, s[4:7], s49 offen offset:2048
    buffer_load_dwordx4 v[44:47], v1, s[4:7], s49 offen offset:3072
    s_add_u32 s49, s48, 0x1201000
    buffer_load_dwordx4 v[48:51], v1, s[4:7], s49 offen offset:0
    buffer_load_dwordx4 v[52:55], v1, s[4:7], s49 offen offset:1024
    buffer_load_dwordx4 v[56:59], v1, s[4:7], s49 offen offset:2048
    buffer_load_dwordx4 v[60:63], v1, s[4:7], s49 offen offset:3072
    s_add_u32 s49, s48, 0x2200000
    buffer_load_dwordx4 v[64:67], v1, s[4:7], s49 offen offset:0
    buffer_load_dwordx4 v[68:71], v1, s[4:7], s49 offen offset:1024
    buffer_load_dwordx4 v[72:75], v1, s[4:7], s49 offen offset:2048
    buffer_load_dwordx4 v[76:79], v1, s[4:7], s49 offen offset:3072
    s_add_u32 s49, s48, 0x2201000
    buffer_load_dwordx4 v[80:83], v1, s[4:7], s49 offen offset:0
    buffer_load_dwordx4 v[84:87], v1, s[4:7], s49 offen offset:1024
    buffer_load_dwordx4 v[88:91], v1, s[4:7], s49 offen offset:2048
    buffer_load_dwordx4 v[92:95], v1, s[4:7], s49 offen offset:3072
    v_lshrrev_b32 v6, 2, v0
    v_lshlrev_b32 v6, 6, v6
    v_and_b32 v7, 3, v0
    v_lshl_add_u32 v6, v7, 3, v6
    s_lshl_b32 s51, s36, 5
    s_add_u32 s51, s51, s32
    s_lshl_b32 s51, s51, 10
    buffer_load_dwordx2 v[12:13], v6, s[12:15], s51 offen
    buffer_load_dwordx2 v[14:15], v6, s[12:15], s51 offen offset:32
    s_branch L_p2_76
L_p2fin_78:
    s_lshr_b32 s50, s100, 3
    s_and_b32 s48, s100, 7
    s_lshl_b32 s48, s48, 2
    s_and_b32 s49, s33, 2
    s_add_u32 s48, s48, s49
    s_mul_i32 s48, s48, 56
    s_lshl_b32 s49, s50, 1
    s_add_u32 s48, s48, s49
    s_and_b32 s49, s33, 1
    s_add_u32 s48, s48, s49
    s_lshl_b32 s48, s48, 10
    s_add_u32 s48, s48, 0x8400000
    s_mov_b32 s50, 0xc0135761
    s_mov_b32 s51, 0xbdd2d3e8
    v_lshlrev_b32 v145, 4, v0
    v_lshlrev_b32 v150, 16, v16
    v_and_b32 v151, 0xffff0000, v16
    v_lshlrev_b32 v152, 16, v17
    v_and_b32 v153, 0xffff0000, v17
    v_lshlrev_b32 v154, 16, v18
    v_and_b32 v155, 0xffff0000, v18
    v_lshlrev_b32 v156, 16, v19
    v_and_b32 v157, 0xffff0000, v19
    v_mov_b32 v160, v120
    v_mov_b32 v161, v121
    v_mov_b32 v162, v122
    v_mov_b32 v163, v123
    v_mov_b32 v164, v128
    v_mov_b32 v165, v129
    v_mov_b32 v166, v130
    v_mov_b32 v167, v131
    v_cvt_pk_bf16_f32 v168, v160, v161
    v_cvt_pk_bf16_f32 v169, v162, v163
    v_cvt_pk_bf16_f32 v170, v164, v165
    v_cvt_pk_bf16_f32 v171, v166, v167
    v_lshlrev_b32 v160, 16, v168
    v_and_b32 v161, 0xffff0000, v168
    v_lshlrev_b32 v162, 16, v169
    v_and_b32 v163, 0xffff0000, v169
    v_lshlrev_b32 v164, 16, v170
    v_and_b32 v165, 0xffff0000, v170
    v_lshlrev_b32 v166, 16, v171
    v_and_b32 v167, 0xffff0000, v171
    v_add_f32 v160, v160, v150
    v_add_f32 v161, v161, v151
    v_add_f32 v162, v162, v152
    v_add_f32 v163, v163, v153
    v_add_f32 v164, v164, v154
    v_add_f32 v165, v165, v155
    v_add_f32 v166, v166, v156
    v_add_f32 v167, v167, v157
    v_cvt_pk_bf16_f32 v168, v160, v161
    v_cvt_pk_bf16_f32 v169, v162, v163
    v_cvt_pk_bf16_f32 v170, v164, v165
    v_cvt_pk_bf16_f32 v171, v166, v167
    v_lshlrev_b32 v160, 16, v168
    v_and_b32 v161, 0xffff0000, v168
    v_lshlrev_b32 v162, 16, v169
    v_and_b32 v163, 0xffff0000, v169
    v_lshlrev_b32 v164, 16, v170
    v_and_b32 v165, 0xffff0000, v170
    v_lshlrev_b32 v166, 16, v171
    v_and_b32 v167, 0xffff0000, v171
    v_mul_f32 v172, v160, v160
    v_mov_b32 v180, s50
    v_fmac_f32 v180, s51, v172
    v_mul_f32 v172, v180, v160
    v_exp_f32 v172, v172
    v_mul_f32 v173, v161, v161
    v_mov_b32 v181, s50
    v_fmac_f32 v181, s51, v173
    v_mul_f32 v173, v181, v161
    v_exp_f32 v173, v173
    v_mul_f32 v174, v162, v162
    v_mov_b32 v182, s50
    v_fmac_f32 v182, s51, v174
    v_mul_f32 v174, v182, v162
    v_exp_f32 v174, v174
    v_mul_f32 v175, v163, v163
    v_mov_b32 v183, s50
    v_fmac_f32 v183, s51, v175
    v_mul_f32 v175, v183, v163
    v_exp_f32 v175, v175
    v_mul_f32 v176, v164, v164
    v_mov_b32 v184, s50
    v_fmac_f32 v184, s51, v176
    v_mul_f32 v176, v184, v164
    v_exp_f32 v176, v176
    v_mul_f32 v177, v165, v165
    v_mov_b32 v185, s50
    v_fmac_f32 v185, s51, v177
    v_mul_f32 v177, v185, v165
    v_exp_f32 v177, v177
    v_mul_f32 v178, v166, v166
    v_mov_b32 v186, s50
    v_fmac_f32 v186, s51, v178
    v_mul_f32 v178, v186, v166
    v_exp_f32 v178, v178
    v_mul_f32 v179, v167, v167
    v_mov_b32 v187, s50
    v_fmac_f32 v187, s51, v179
    v_mul_f32 v179, v187, v167
    v_exp_f32 v179, v179
    v_add_f32 v172, 1.0, v172
    v_rcp_f32 v172, v172
    v_add_f32 v173, 1.0, v173
    v_rcp_f32 v173, v173
    v_add_f32 v174, 1.0, v174
    v_rcp_f32 v174, v174
    v_add_f32 v175, 1.0, v175
    v_rcp_f32 v175, v175
    v_add_f32 v176, 1.0, v176
    v_rcp_f32 v176, v176
    v_add_f32 v177, 1.0, v177
    v_rcp_f32 v177, v177
    v_add_f32 v178, 1.0, v178
    v_rcp_f32 v178, v178
    v_add_f32 v179, 1.0, v179
    v_rcp_f32 v179, v179
    v_mul_f32 v160, v160, v172
    v_mul_f32 v161, v161, v173
    v_mul_f32 v162, v162, v174
    v_mul_f32 v163, v163, v175
    v_mul_f32 v164, v164, v176
    v_mul_f32 v165, v165, v177
    v_mul_f32 v166, v166, v178
    v_mul_f32 v167, v167, v179
    v_cvt_pk_bf16_f32 v188, v160, v161
    v_cvt_pk_bf16_f32 v189, v162, v163
    v_cvt_pk_bf16_f32 v190, v164, v165
    v_cvt_pk_bf16_f32 v191, v166, v167
    buffer_store_dwordx4 v[188:191], v145, s[4:7], s48 offen sc1
    s_add_u32 s48, s48, 57344
    v_mov_b32 v160, v124
    v_mov_b32 v161, v125
    v_mov_b32 v162, v126
    v_mov_b32 v163, v127
    v_mov_b32 v164, v132
    v_mov_b32 v165, v133
    v_mov_b32 v166, v134
    v_mov_b32 v167, v135
    v_cvt_pk_bf16_f32 v168, v160, v161
    v_cvt_pk_bf16_f32 v169, v162, v163
    v_cvt_pk_bf16_f32 v170, v164, v165
    v_cvt_pk_bf16_f32 v171, v166, v167
    v_lshlrev_b32 v160, 16, v168
    v_and_b32 v161, 0xffff0000, v168
    v_lshlrev_b32 v162, 16, v169
    v_and_b32 v163, 0xffff0000, v169
    v_lshlrev_b32 v164, 16, v170
    v_and_b32 v165, 0xffff0000, v170
    v_lshlrev_b32 v166, 16, v171
    v_and_b32 v167, 0xffff0000, v171
    v_add_f32 v160, v160, v150
    v_add_f32 v161, v161, v151
    v_add_f32 v162, v162, v152
    v_add_f32 v163, v163, v153
    v_add_f32 v164, v164, v154
    v_add_f32 v165, v165, v155
    v_add_f32 v166, v166, v156
    v_add_f32 v167, v167, v157
    v_cvt_pk_bf16_f32 v168, v160, v161
    v_cvt_pk_bf16_f32 v169, v162, v163
    v_cvt_pk_bf16_f32 v170, v164, v165
    v_cvt_pk_bf16_f32 v171, v166, v167
    v_lshlrev_b32 v160, 16, v168
    v_and_b32 v161, 0xffff0000, v168
    v_lshlrev_b32 v162, 16, v169
    v_and_b32 v163, 0xffff0000, v169
    v_lshlrev_b32 v164, 16, v170
    v_and_b32 v165, 0xffff0000, v170
    v_lshlrev_b32 v166, 16, v171
    v_and_b32 v167, 0xffff0000, v171
    v_mul_f32 v172, v160, v160
    v_mov_b32 v180, s50
    v_fmac_f32 v180, s51, v172
    v_mul_f32 v172, v180, v160
    v_exp_f32 v172, v172
    v_mul_f32 v173, v161, v161
    v_mov_b32 v181, s50
    v_fmac_f32 v181, s51, v173
    v_mul_f32 v173, v181, v161
    v_exp_f32 v173, v173
    v_mul_f32 v174, v162, v162
    v_mov_b32 v182, s50
    v_fmac_f32 v182, s51, v174
    v_mul_f32 v174, v182, v162
    v_exp_f32 v174, v174
    v_mul_f32 v175, v163, v163
    v_mov_b32 v183, s50
    v_fmac_f32 v183, s51, v175
    v_mul_f32 v175, v183, v163
    v_exp_f32 v175, v175
    v_mul_f32 v176, v164, v164
    v_mov_b32 v184, s50
    v_fmac_f32 v184, s51, v176
    v_mul_f32 v176, v184, v164
    v_exp_f32 v176, v176
    v_mul_f32 v177, v165, v165
    v_mov_b32 v185, s50
    v_fmac_f32 v185, s51, v177
    v_mul_f32 v177, v185, v165
    v_exp_f32 v177, v177
    v_mul_f32 v178, v166, v166
    v_mov_b32 v186, s50
    v_fmac_f32 v186, s51, v178
    v_mul_f32 v178, v186, v166
    v_exp_f32 v178, v178
    v_mul_f32 v179, v167, v167
    v_mov_b32 v187, s50
    v_fmac_f32 v187, s51, v179
    v_mul_f32 v179, v187, v167
    v_exp_f32 v179, v179
    v_add_f32 v172, 1.0, v172
    v_rcp_f32 v172, v172
    v_add_f32 v173, 1.0, v173
    v_rcp_f32 v173, v173
    v_add_f32 v174, 1.0, v174
    v_rcp_f32 v174, v174
    v_add_f32 v175, 1.0, v175
    v_rcp_f32 v175, v175
    v_add_f32 v176, 1.0, v176
    v_rcp_f32 v176, v176
    v_add_f32 v177, 1.0, v177
    v_rcp_f32 v177, v177
    v_add_f32 v178, 1.0, v178
    v_rcp_f32 v178, v178
    v_add_f32 v179, 1.0, v179
    v_rcp_f32 v179, v179
    v_mul_f32 v160, v160, v172
    v_mul_f32 v161, v161, v173
    v_mul_f32 v162, v162, v174
    v_mul_f32 v163, v163, v175
    v_mul_f32 v164, v164, v176
    v_mul_f32 v165, v165, v177
    v_mul_f32 v166, v166, v178
    v_mul_f32 v167, v167, v179
    v_cvt_pk_bf16_f32 v192, v160, v161
    v_cvt_pk_bf16_f32 v193, v162, v163
    v_cvt_pk_bf16_f32 v194, v164, v165
    v_cvt_pk_bf16_f32 v195, v166, v167
    buffer_store_dwordx4 v[192:195], v145, s[4:7], s48 offen sc1
    s_add_u32 s48, s48, 57344
    s_waitcnt vmcnt(0)
    s_barrier
    s_cmp_lg_u32 s33, 0
    s_cbranch_scc1 L_ue_113
    s_lshl_b32 s50, s34, 7
    s_add_u32 s50, s50, 0x3f88000
    s_lshl_b32 s51, s34, 2
    s_add_u32 s51, s51, 0x3f88500
    s_lshl_b32 s49, s32, 2
    s_add_u32 s49, s49, s50
    v_mov_b32 v144, 1
    s_mov_b64 exec, 1
    s_cmp_eq_u32 s83, 0
    s_cbranch_scc1 L_fs_114
    buffer_store_dword v144, off, s[4:7], s49
    s_branch L_fs_115
L_fs_114:
    buffer_store_dword v144, off, s[4:7], s49 sc1
L_fs_115:
    s_mov_b64 exec, -1
    s_cmp_lg_u32 s32, 0
    s_cbranch_scc1 L_ga_116
    v_lshlrev_b32 v145, 2, v0
    s_mov_b32 exec_lo, 0xffffffff
    s_mov_b32 exec_hi, 0
L_pf_117:
    buffer_load_dword v144, v145, s[4:7], s50 offen sc1
    s_sub_u32 s35, s35, 1
    s_cbranch_scc1 L_exit_1
    s_waitcnt vmcnt(0)
    v_cmp_eq_u32 vcc, 0, v144
    s_cbranch_vccz L_pfd_118
    s_nop 3
    s_branch L_pf_117
L_pfd_118:
    s_mov_b64 exec, -1
    v_lshlrev_b32 v145, 9, v0
    v_mov_b32 v144, 1
    s_mov_b64 exec, 0xff
    buffer_store_dword v144, v145, s[4:7], s51 offen sc1
    s_mov_b64 exec, -1
L_ga_116:
L_ue_113:
    s_add_u32 s34, s34, 1
L_g2_12:
    s_cmp_gt_u32 s62, 0
    s_cbranch_scc1 L_pre_119
    v_and_b32 v144, 15, v0
    v_lshrrev_b32 v145, 4, v0
    v_lshrrev_b32 v146, 2, v144
    v_and_b32 v147, 3, v144
    v_lshl_add_u32 v146, v145, 2, v146
    v_bfe_u32 v145, v146, 1, 2
    v_lshlrev_b32 v146, 7, v146
    v_lshl_add_u32 v146, v147, 3, v146
    v_lshl_add_u32 v146, v145, 5, v146
    s_lshl_b32 s48, s33, 12
    s_add_u32 s48, s48, 73728
    v_xor_b32 v148, 0, v146
    v_add_u32 v148, s48, v148
    v_add_u32 v152, 49152, v148
    v_xor_b32 v149, 32, v146
    v_add_u32 v149, s48, v149
    v_add_u32 v153, 49152, v149
    v_xor_b32 v150, 64, v146
    v_add_u32 v150, s48, v150
    v_add_u32 v154, 49152, v150
    v_xor_b32 v151, 96, v146
    v_add_u32 v151, s48, v151
    v_add_u32 v155, 49152, v151
    s_waitcnt vmcnt(0)
    s_barrier
    ds_read_b64_tr_b16 a[128:129], v148 offset:0
    ds_read_b64_tr_b16 a[130:131], v148 offset:2048
    ds_read_b64_tr_b16 a[132:133], v149 offset:0
    ds_read_b64_tr_b16 a[134:135], v149 offset:2048
    ds_read_b64_tr_b16 a[136:137], v150 offset:0
    ds_read_b64_tr_b16 a[138:139], v150 offset:2048
    ds_read_b64_tr_b16 a[140:141], v151 offset:0
    ds_read_b64_tr_b16 a[142:143], v151 offset:2048
    s_waitcnt lgkmcnt(4)
    ds_read_b64_tr_b16 a[144:145], v148 offset:16384
    ds_read_b64_tr_b16 a[146:147], v148 offset:18432
    ds_read_b64_tr_b16 a[148:149], v149 offset:16384
    ds_read_b64_tr_b16 a[150:151], v149 offset:18432
    ds_read_b64_tr_b16 a[152:153], v150 offset:16384
    ds_read_b64_tr_b16 a[154:155], v150 offset:18432
    ds_read_b64_tr_b16 a[156:157], v151 offset:16384
    ds_read_b64_tr_b16 a[158:159], v151 offset:18432
    s_waitcnt lgkmcnt(4)
    ds_read_b64_tr_b16 a[160:161], v148 offset:32768
    ds_read_b64_tr_b16 a[162:163], v148 offset:34816
    ds_read_b64_tr_b16 a[164:165], v149 offset:32768
    ds_read_b64_tr_b16 a[166:167], v149 offset:34816
    ds_read_b64_tr_b16 a[168:169], v150 offset:32768
    ds_read_b64_tr_b16 a[170:171], v150 offset:34816
    ds_read_b64_tr_b16 a[172:173], v151 offset:32768
    ds_read_b64_tr_b16 a[174:175], v151 offset:34816
    s_waitcnt lgkmcnt(4)
    ds_read_b64_tr_b16 a[176:177], v152 offset:0
    ds_read_b64_tr_b16 a[178:179], v152 offset:2048
    ds_read_b64_tr_b16 a[180:181], v153 offset:0
    ds_read_b64_tr_b16 a[182:183], v153 offset:2048
    ds_read_b64_tr_b16 a[184:185], v154 offset:0
    ds_read_b64_tr_b16 a[186:187], v154 offset:2048
    ds_read_b64_tr_b16 a[188:189], v155 offset:0
    ds_read_b64_tr_b16 a[190:191], v155 offset:2048
    s_waitcnt lgkmcnt(4)
    ds_read_b64_tr_b16 a[192:193], v152 offset:16384
    ds_read_b64_tr_b16 a[194:195], v152 offset:18432
    ds_read_b64_tr_b16 a[196:197], v153 offset:16384
    ds_read_b64_tr_b16 a[198:199], v153 offset:18432
    ds_read_b64_tr_b16 a[200:201], v154 offset:16384
    ds_read_b64_tr_b16 a[202:203], v154 offset:18432
    ds_read_b64_tr_b16 a[204:205], v155 offset:16384
    ds_read_b64_tr_b16 a[206:207], v155 offset:18432
    s_waitcnt lgkmcnt(4)
    s_waitcnt lgkmcnt(0)
    s_barrier
    s_add_u32 m0, s3, 73728
    s_add_u32 s48, s101, 2621440
    buffer_load_dwordx4 v142, s[96:99], s48 offen lds
    s_add_u32 m0, s3, 77824
    s_add_u32 s48, s101, 2752512
    buffer_load_dwordx4 v142, s[96:99], s48 offen lds
    s_add_u32 m0, s3, 81920
    s_add_u32 s48, s101, 2883584
    buffer_load_dwordx4 v142, s[96:99], s48 offen lds
    s_add_u32 m0, s3, 86016
    s_add_u32 s48, s101, 3014656
    buffer_load_dwordx4 v142, s[96:99], s48 offen lds
    s_add_u32 m0, s3, 90112
    s_add_u32 s48, s101, 3145728
    buffer_load_dwordx4 v142, s[96:99], s48 offen lds
    s_add_u32 m0, s3, 94208
    s_add_u32 s48, s101, 3276800
    buffer_load_dwordx4 v142, s[96:99], s48 offen lds
    s_add_u32 m0, s3, 98304
    s_add_u32 s48, s101, 3407872
    buffer_load_dwordx4 v142, s[96:99], s48 offen lds
    s_add_u32 m0, s3, 102400
    s_add_u32 s48, s101, 3538944
    buffer_load_dwordx4 v142, s[96:99], s48 offen lds
    s_add_u32 m0, s3, 106496
    s_add_u32 s48, s101, 3670016
    buffer_load_dwordx4 v142, s[96:99], s48 offen lds
    s_add_u32 m0, s3, 110592
    s_add_u32 s48, s101, 3801088
    buffer_load_dwordx4 v142, s[96:99], s48 offen lds
    s_add_u32 m0, s3, 114688
    s_add_u32 s48, s101, 3932160
    buffer_load_dwordx4 v142, s[96:99], s48 offen lds
    s_add_u32 m0, s3, 118784
    s_add_u32 s48, s101, 4063232
    buffer_load_dwordx4 v142, s[96:99], s48 offen lds
    s_add_u32 m0, s3, 122880
    s_add_u32 s48, s101, 4194304
    buffer_load_dwordx4 v142, s[96:99], s48 offen lds
    s_add_u32 m0, s3, 126976
    s_add_u32 s48, s101, 4325376
    buffer_load_dwordx4 v142, s[96:99], s48 offen lds
    s_add_u32 m0, s3, 131072
    s_add_u32 s48, s101, 4456448
    buffer_load_dwordx4 v142, s[96:99], s48 offen lds
    s_add_u32 m0, s3, 135168
    s_add_u32 s48, s101, 4587520
    buffer_load_dwordx4 v142, s[96:99], s48 offen lds
    s_add_u32 m0, s3, 139264
    s_add_u32 s48, s101, 4718592
    buffer_load_dwordx4 v142, s[96:99], s48 offen lds
    s_add_u32 m0, s3, 143360
    s_add_u32 s48, s101, 4849664
    buffer_load_dwordx4 v142, s[96:99], s48 offen lds
    s_add_u32 m0, s3, 147456
    s_add_u32 s48, s101, 4980736
    buffer_load_dwordx4 v142, s[96:99], s48 offen lds
    s_add_u32 m0, s3, 151552
    s_add_u32 s48, s101, 5111808
    buffer_load_dwordx4 v142, s[96:99], s48 offen lds
    s_mov_b32 s62, 1
L_pre_119:
    s_cmp_gt_u32 s62, 1
    s_cbranch_scc1 L_pre_120
    v_and_b32 v144, 15, v0
    v_lshrrev_b32 v145, 4, v0
    v_lshrrev_b32 v146, 2, v144
    v_and_b32 v147, 3, v144
    v_lshl_add_u32 v146, v145, 2, v146
    v_bfe_u32 v145, v146, 1, 2
    v_lshlrev_b32 v146, 7, v146
    v_lshl_add_u32 v146, v147, 3, v146
    v_lshl_add_u32 v146, v145, 5, v146
    s_lshl_b32 s48, s33, 12
    s_add_u32 s48, s48, 73728
    v_xor_b32 v148, 0, v146
    v_add_u32 v148, s48, v148
    v_add_u32 v152, 49152, v148
    v_xor_b32 v149, 32, v146
    v_add_u32 v149, s48, v149
    v_add_u32 v153, 49152, v149
    v_xor_b32 v150, 64, v146
    v_add_u32 v150, s48, v150
    v_add_u32 v154, 49152, v150
    v_xor_b32 v151, 96, v146
    v_add_u32 v151, s48, v151
    v_add_u32 v155, 49152, v151
    s_waitcnt vmcnt(0)
    s_barrier
    ds_read_b64_tr_b16 a[208:209], v148 offset:0
    ds_read_b64_tr_b16 a[210:211], v148 offset:2048
    ds_read_b64_tr_b16 a[212:213], v149 offset:0
    ds_read_b64_tr_b16 a[214:215], v149 offset:2048
    ds_read_b64_tr_b16 a[216:217], v150 offset:0
    ds_read_b64_tr_b16 a[218:219], v150 offset:2048
    ds_read_b64_tr_b16 a[220:221], v151 offset:0
    ds_read_b64_tr_b16 a[222:223], v151 offset:2048
    s_waitcnt lgkmcnt(4)
    ds_read_b64_tr_b16 a[224:225], v148 offset:16384
    ds_read_b64_tr_b16 a[226:227], v148 offset:18432
    ds_read_b64_tr_b16 a[228:229], v149 offset:16384
    ds_read_b64_tr_b16 a[230:231], v149 offset:18432
    ds_read_b64_tr_b16 a[232:233], v150 offset:16384
    ds_read_b64_tr_b16 a[234:235], v150 offset:18432
    ds_read_b64_tr_b16 a[236:237], v151 offset:16384
    ds_read_b64_tr_b16 a[238:239], v151 offset:18432
    s_waitcnt lgkmcnt(4)
    ds_read_b64_tr_b16 a[240:241], v148 offset:32768
    ds_read_b64_tr_b16 a[242:243], v148 offset:34816
    ds_read_b64_tr_b16 a[244:245], v149 offset:32768
    ds_read_b64_tr_b16 a[246:247], v149 offset:34816
    ds_read_b64_tr_b16 a[248:249], v150 offset:32768
    ds_read_b64_tr_b16 a[250:251], v150 offset:34816
    ds_read_b64_tr_b16 a[252:253], v151 offset:32768
    ds_read_b64_tr_b16 a[254:255], v151 offset:34816
    s_waitcnt lgkmcnt(4)
    s_waitcnt lgkmcnt(0)
    s_barrier
    s_add_u32 m0, s3, 73728
    s_add_u32 s48, s101, 5242880
    buffer_load_dwordx4 v142, s[96:99], s48 offen lds
    s_add_u32 m0, s3, 77824
    s_add_u32 s48, s101, 5373952
    buffer_load_dwordx4 v142, s[96:99], s48 offen lds
    s_add_u32 m0, s3, 81920
    s_add_u32 s48, s101, 5505024
    buffer_load_dwordx4 v142, s[96:99], s48 offen lds
    s_add_u32 m0, s3, 86016
    s_add_u32 s48, s101, 5636096
    buffer_load_dwordx4 v142, s[96:99], s48 offen lds
    s_add_u32 m0, s3, 90112
    s_add_u32 s48, s101, 5767168
    buffer_load_dwordx4 v142, s[96:99], s48 offen lds
    s_add_u32 m0, s3, 94208
    s_add_u32 s48, s101, 5898240
    buffer_load_dwordx4 v142, s[96:99], s48 offen lds
    s_add_u32 m0, s3, 98304
    s_add_u32 s48, s101, 6029312
    buffer_load_dwordx4 v142, s[96:99], s48 offen lds
    s_add_u32 m0, s3, 102400
    s_add_u32 s48, s101, 6160384
    buffer_load_dwordx4 v142, s[96:99], s48 offen lds
    s_add_u32 m0, s3, 106496
    s_add_u32 s48, s101, 6291456
    buffer_load_dwordx4 v142, s[96:99], s48 offen lds
    s_add_u32 m0, s3, 110592
    s_add_u32 s48, s101, 6422528
    buffer_load_dwordx4 v142, s[96:99], s48 offen lds
    s_add_u32 m0, s3, 114688
    s_add_u32 s48, s101, 6553600
    buffer_load_dwordx4 v142, s[96:99], s48 offen lds
    s_add_u32 m0, s3, 118784
    s_add_u32 s48, s101, 6684672
    buffer_load_dwordx4 v142, s[96:99], s48 offen lds
    s_mov_b32 s62, 2
L_pre_120:
    s_cmp_gt_u32 s62, 2
    s_cbranch_scc1 L_pre_121
    v_and_b32 v144, 15, v0
    v_lshrrev_b32 v145, 4, v0
    v_lshrrev_b32 v146, 2, v144
    v_and_b32 v147, 3, v144
    v_lshl_add_u32 v146, v145, 2, v146
    v_bfe_u32 v145, v146, 1, 2
    v_lshlrev_b32 v146, 7, v146
    v_lshl_add_u32 v146, v147, 3, v146
    v_lshl_add_u32 v146, v145, 5, v146
    s_lshl_b32 s48, s33, 12
    s_add_u32 s48, s48, 73728
    v_xor_b32 v148, 0, v146
    v_add_u32 v148, s48, v148
    v_add_u32 v152, 49152, v148
    v_xor_b32 v149, 32, v146
    v_add_u32 v149, s48, v149
    v_add_u32 v153, 49152, v149
    v_xor_b32 v150, 64, v146
    v_add_u32 v150, s48, v150
    v_add_u32 v154, 49152, v150
    v_xor_b32 v151, 96, v146
    v_add_u32 v151, s48, v151
    v_add_u32 v155, 49152, v151
    s_waitcnt vmcnt(0)
    s_barrier
    ds_read_b64_tr_b16 a[0:1], v152 offset:0
    ds_read_b64_tr_b16 a[2:3], v152 offset:2048
    ds_read_b64_tr_b16 a[4:5], v153 offset:0
    ds_read_b64_tr_b16 a[6:7], v153 offset:2048
    ds_read_b64_tr_b16 a[8:9], v154 offset:0
    ds_read_b64_tr_b16 a[10:11], v154 offset:2048
    ds_read_b64_tr_b16 a[12:13], v155 offset:0
    ds_read_b64_tr_b16 a[14:15], v155 offset:2048
    s_waitcnt lgkmcnt(4)
    ds_read_b64_tr_b16 a[16:17], v152 offset:16384
    ds_read_b64_tr_b16 a[18:19], v152 offset:18432
    ds_read_b64_tr_b16 a[20:21], v153 offset:16384
    ds_read_b64_tr_b16 a[22:23], v153 offset:18432
    ds_read_b64_tr_b16 a[24:25], v154 offset:16384
    ds_read_b64_tr_b16 a[26:27], v154 offset:18432
    ds_read_b64_tr_b16 a[28:29], v155 offset:16384
    ds_read_b64_tr_b16 a[30:31], v155 offset:18432
    s_waitcnt lgkmcnt(4)
    ds_read_b64_tr_b16 a[32:33], v148 offset:0
    ds_read_b64_tr_b16 a[34:35], v148 offset:2048
    ds_read_b64_tr_b16 a[36:37], v149 offset:0
    ds_read_b64_tr_b16 a[38:39], v149 offset:2048
    ds_read_b64_tr_b16 a[40:41], v150 offset:0
    ds_read_b64_tr_b16 a[42:43], v150 offset:2048
    ds_read_b64_tr_b16 a[44:45], v151 offset:0
    ds_read_b64_tr_b16 a[46:47], v151 offset:2048
    s_waitcnt lgkmcnt(4)
    ds_read_b64_tr_b16 a[48:49], v148 offset:16384
    ds_read_b64_tr_b16 a[50:51], v148 offset:18432
    ds_read_b64_tr_b16 a[52:53], v149 offset:16384
    ds_read_b64_tr_b16 a[54:55], v149 offset:18432
    ds_read_b64_tr_b16 a[56:57], v150 offset:16384
    ds_read_b64_tr_b16 a[58:59], v150 offset:18432
    ds_read_b64_tr_b16 a[60:61], v151 offset:16384
    ds_read_b64_tr_b16 a[62:63], v151 offset:18432
    s_waitcnt lgkmcnt(4)
    ds_read_b64_tr_b16 a[64:65], v148 offset:32768
    ds_read_b64_tr_b16 a[66:67], v148 offset:34816
    ds_read_b64_tr_b16 a[68:69], v149 offset:32768
    ds_read_b64_tr_b16 a[70:71], v149 offset:34816
    ds_read_b64_tr_b16 a[72:73], v150 offset:32768
    ds_read_b64_tr_b16 a[74:75], v150 offset:34816
    ds_read_b64_tr_b16 a[76:77], v151 offset:32768
    ds_read_b64_tr_b16 a[78:79], v151 offset:34816
    s_waitcnt lgkmcnt(4)
    s_waitcnt lgkmcnt(0)
    s_mov_b32 s62, 3
L_pre_121:
    s_cmp_gt_u32 s62, 3
    s_cbranch_scc1 L_pre_122
    v_and_b32 v144, 15, v0
    v_lshrrev_b32 v145, 4, v0
    v_lshrrev_b32 v146, 2, v144
    v_and_b32 v147, 3, v144
    v_lshl_add_u32 v146, v145, 2, v146
    v_bfe_u32 v145, v146, 1, 2
    v_lshlrev_b32 v146, 7, v146
    v_lshl_add_u32 v146, v147, 3, v146
    v_lshl_add_u32 v146, v145, 5, v146
    s_lshl_b32 s48, s33, 12
    s_add_u32 s48, s48, 73728
    v_xor_b32 v148, 0, v146
    v_add_u32 v148, s48, v148
    v_add_u32 v152, 49152, v148
    v_xor_b32 v149, 32, v146
    v_add_u32 v149, s48, v149
    v_add_u32 v153, 49152, v149
    v_xor_b32 v150, 64, v146
    v_add_u32 v150, s48, v150
    v_add_u32 v154, 49152, v150
    v_xor_b32 v151, 96, v146
    v_add_u32 v151, s48, v151
    v_add_u32 v155, 49152, v151
    s_waitcnt vmcnt(0)
    s_barrier
    v_subrev_u32 v148, 73728, v148
    v_subrev_u32 v149, 73728, v149
    v_subrev_u32 v150, 73728, v150
    v_subrev_u32 v151, 73728, v151
    ds_read_b64_tr_b16 a[80:81], v148 offset:0
    ds_read_b64_tr_b16 a[82:83], v148 offset:2048
    ds_read_b64_tr_b16 a[84:85], v149 offset:0
    ds_read_b64_tr_b16 a[86:87], v149 offset:2048
    ds_read_b64_tr_b16 a[88:89], v150 offset:0
    ds_read_b64_tr_b16 a[90:91], v150 offset:2048
    ds_read_b64_tr_b16 a[92:93], v151 offset:0
    ds_read_b64_tr_b16 a[94:95], v151 offset:2048
    s_waitcnt lgkmcnt(4)
    s_waitcnt lgkmcnt(0)
    s_mov_b32 s62, 4
L_pre_122:
    s_waitcnt lgkmcnt(0)
    s_mov_b32 s92, s16
    s_and_b32 s93, s17, 0xffff
    s_mov_b32 s94, 0x1000
    s_mov_b32 s95, 0x20000
    s_mov_b32 s88, s18
    s_and_b32 s89, s19, 0xffff
    s_mov_b32 s90, 0x200000
    s_mov_b32 s91, 0x20000
    s_and_b32 s48, s63, 7
    s_mul_i32 s36, s48, 229376
    s_lshl_b32 s49, s33, 10
    s_add_u32 s36, s36, s49
    s_add_u32 s36, s36, 0x8400000
    s_lshl_b32 s48, s48, 2
    s_add_u32 s48, s48, s33
    s_lshr_b32 s49, s63, 3
    s_lshl_b32 s37, s49, 16
    s_lshl_b32 s48, s48, 5
    s_add_u32 s37, s37, s48
    v_lshlrev_b32 v5, 4, v0
    v_and_b32 v1, 15, v0
    v_lshrrev_b32 v2, 4, v0
    v_lshlrev_b32 v3, 10, v1
    v_lshl_add_u32 v3, v2, 3, v3
    v_lshlrev_b32 v4, 1, v1
    s_lshl_b32 s49, s49, 7
    s_mov_b32 s39, s49
    s_lshl_b32 s38, s34, 9
    s_add_u32 s38, s38, 0x3f88500
    s_cmp_lg_u32 s33, 0
    s_cbranch_scc1 L_g20_123
    v_lshlrev_b32 v7, 2, v0
    s_mov_b32 exec_lo, 0x7f
    s_mov_b32 exec_hi, 0
L_pf_124:
    buffer_load_dword v6, v7, s[4:7], s38 offen sc1
    s_sub_u32 s35, s35, 1
    s_cbranch_scc1 L_exit_1
    s_waitcnt vmcnt(0)
    v_cmp_eq_u32 vcc, 0, v6
    s_cbranch_vccz L_pfd_125
    s_sleep 1
    s_nop 2
    s_branch L_pf_124
L_pfd_125:
    s_mov_b64 exec, -1
L_g20_123:
    s_barrier
    s_add_u32 s49, s36, 0
    buffer_load_dwordx4 v[88:91], v5, s[4:7], s49 offen
    s_add_u32 s49, s36, 57344
    buffer_load_dwordx4 v[92:95], v5, s[4:7], s49 offen
    s_add_u32 s49, s36, 114688
    buffer_load_dwordx4 v[96:99], v5, s[4:7], s49 offen
    s_add_u32 s49, s36, 172032
    buffer_load_dwordx4 v[100:103], v5, s[4:7], s49 offen
    s_add_u32 s49, s36, 4096
    buffer_load_dwordx4 v[104:107], v5, s[4:7], s49 offen
    s_add_u32 s49, s36, 61440
    buffer_load_dwordx4 v[108:111], v5, s[4:7], s49 offen
    s_add_u32 s49, s36, 118784
    buffer_load_dwordx4 v[112:115], v5, s[4:7], s49 offen
    s_add_u32 s49, s36, 176128
    buffer_load_dwordx4 v[116:119], v5, s[4:7], s49 offen
    s_add_u32 s49, s36, 8192
    buffer_load_dwordx4 v[120:123], v5, s[4:7], s49 offen
    s_add_u32 s49, s36, 65536
    buffer_load_dwordx4 v[124:127], v5, s[4:7], s49 offen
    s_add_u32 s49, s36, 122880
    buffer_load_dwordx4 v[128:131], v5, s[4:7], s49 offen
    s_add_u32 s49, s36, 180224
    buffer_load_dwordx4 v[132:135], v5, s[4:7], s49 offen
    s_add_u32 s49, s36, 12288
    buffer_load_dwordx4 v[136:139], v5, s[4:7], s49 offen
    s_add_u32 s49, s36, 69632
    buffer_load_dwordx4 v[140:143], v5, s[4:7], s49 offen
    s_add_u32 s49, s36, 126976
    buffer_load_dwordx4 v[144:147], v5, s[4:7], s49 offen
    s_add_u32 s49, s36, 184320
    buffer_load_dwordx4 v[148:151], v5, s[4:7], s49 offen
    s_add_u32 s49, s36, 16384
    buffer_load_dwordx4 v[152:155], v5, s[4:7], s49 offen
    s_add_u32 s49, s36, 73728
    buffer_load_dwordx4 v[156:159], v5, s[4:7], s49 offen
    s_add_u32 s49, s36, 131072
    buffer_load_dwordx4 v[160:163], v5, s[4:7], s49 offen
    s_add_u32 s49, s36, 188416
    buffer_load_dwordx4 v[164:167], v5, s[4:7], s49 offen
    s_waitcnt vmcnt(19)
    v_mfma_f32_16x16x32_bf16 v[24:27], v[88:91], a[128:131], 0
    s_add_u32 s49, s36, 20480
    buffer_load_dwordx4 v[168:171], v5, s[4:7], s49 offen
    v_mfma_f32_16x16x32_bf16 v[28:31], v[88:91], a[132:135], 0
    v_mfma_f32_16x16x32_bf16 v[32:35], v[88:91], a[136:139], 0
    s_add_u32 s49, s36, 77824
    buffer_load_dwordx4 v[172:175], v5, s[4:7], s49 offen
    v_mfma_f32_16x16x32_bf16 v[36:39], v[88:91], a[140:143], 0
    s_waitcnt vmcnt(20)
    v_mfma_f32_16x16x32_bf16 v[40:43], v[92:95], a[128:131], 0
    s_add_u32 s49, s36, 135168
    buffer_load_dwordx4 v[176:179], v5, s[4:7], s49 offen
    v_mfma_f32_16x16x32_bf16 v[44:47], v[92:95], a[132:135], 0
    v_mfma_f32_16x16x32_bf16 v[48:51], v[92:95], a[136:139], 0
    s_add_u32 s49, s36, 192512
    buffer_load_dwordx4 v[180:183], v5, s[4:7], s49 offen
    v_mfma_f32_16x16x32_bf16 v[52:55], v[92:95], a[140:143], 0
    s_waitcnt vmcnt(21)
    v_mfma_f32_16x16x32_bf16 v[56:59], v[96:99], a[128:131], 0
    s_add_u32 s49, s36, 24576
    buffer_load_dwordx4 v[184:187], v5, s[4:7], s49 offen
    v_mfma_f32_16x16x32_bf16 v[60:63], v[96:99], a[132:135], 0
    v_mfma_f32_16x16x32_bf16 v[64:67], v[96:99], a[136:139], 0
    s_add_u32 s49, s36, 81920
    buffer_load_dwordx4 v[188:191], v5, s[4:7], s49 offen
    v_mfma_f32_16x16x32_bf16 v[68:71], v[96:99], a[140:143], 0
    s_waitcnt vmcnt(22)
    v_mfma_f32_16x16x32_bf16 v[72:75], v[100:103], a[128:131], 0
    s_add_u32 s49, s36, 139264
    buffer_load_dwordx4 v[192:195], v5, s[4:7], s49 offen
    v_mfma_f32_16x16x32_bf16 v[76:79], v[100:103], a[132:135], 0
    v_mfma_f32_16x16x32_bf16 v[80:83], v[100:103], a[136:139], 0
    s_add_u32 s49, s36, 196608
    buffer_load_dwordx4 v[196:199], v5, s[4:7], s49 offen
    v_mfma_f32_16x16x32_bf16 v[84:87], v[100:103], a[140:143], 0
    s_waitcnt vmcnt(23)
    v_mfma_f32_16x16x32_bf16 v[24:27], v[104:107], a[144:147], v[24:27]
    s_add_u32 s49, s36, 28672
    buffer_load_dwordx4 v[200:203], v5, s[4:7], s49 offen
    v_mfma_f32_16x16x32_bf16 v[28:31], v[104:107], a[148:151], v[28:31]
    v_mfma_f32_16x16x32_bf16 v[32:35], v[104:107], a[152:155], v[32:35]
    s_add_u32 s49, s36, 86016
    buffer_load_dwordx4 v[204:207], v5, s[4:7], s49 offen
    v_mfma_f32_16x16x32_bf16 v[36:39], v[104:107], a[156:159], v[36:39]
    s_waitcnt vmcnt(24)
    v_mfma_f32_16x16x32_bf16 v[40:43], v[108:111], a[144:147], v[40:43]
    s_add_u32 s49, s36, 143360
    buffer_load_dwordx4 v[208:211], v5, s[4:7], s49 offen
    v_mfma_f32_16x16x32_bf16 v[44:47], v[108:111], a[148:151], v[44:47]
    v_mfma_f32_16x16x32_bf16 v[48:51], v[108:111], a[152:155], v[48:51]
    s_add_u32 s49, s36, 200704
    buffer_load_dwordx4 v[212:215], v5, s[4:7], s49 offen
    v_mfma_f32_16x16x32_bf16 v[52:55], v[108:111], a[156:159], v[52:55]
    s_waitcnt vmcnt(25)
    v_mfma_f32_16x16x32_bf16 v[56:59], v[112:115], a[144:147], v[56:59]
    s_add_u32 s49, s36, 32768
    buffer_load_dwordx4 v[216:219], v5, s[4:7], s49 offen
    v_mfma_f32_16x16x32_bf16 v[60:63], v[112:115], a[148:151], v[60:63]
    v_mfma_f32_16x16x32_bf16 v[64:67], v[112:115], a[152:155], v[64:67]
    s_add_u32 s49, s36, 90112
    buffer_load_dwordx4 v[220:223], v5, s[4:7], s49 offen
    v_mfma_f32_16x16x32_bf16 v[68:71], v[112:115], a[156:159], v[68:71]
    s_waitcnt vmcnt(26)
    v_mfma_f32_16x16x32_bf16 v[72:75], v[116:119], a[144:147], v[72:75]
    s_add_u32 s49, s36, 147456
    buffer_load_dwordx4 v[224:227], v5, s[4:7], s49 offen
    v_mfma_f32_16x16x32_bf16 v[76:79], v[116:119], a[148:151], v[76:79]
    v_mfma_f32_16x16x32_bf16 v[80:83], v[116:119], a[152:155], v[80:83]
    s_add_u32 s49, s36, 204800
    buffer_load_dwordx4 v[228:231], v5, s[4:7], s49 offen
    v_mfma_f32_16x16x32_bf16 v[84:87], v[116:119], a[156:159], v[84:87]
    s_waitcnt vmcnt(27)
    v_mfma_f32_16x16x32_bf16 v[24:27], v[120:123], a[160:163], v[24:27]
    s_add_u32 s49, s36, 36864
    buffer_load_dwordx4 v[232:235], v5, s[4:7], s49 offen
    v_mfma_f32_16x16x32_bf16 v[28:31], v[120:123], a[164:167], v[28:31]
    v_mfma_f32_16x16x32_bf16 v[32:35], v[120:123], a[168:171], v[32:35]
    s_add_u32 s49, s36, 94208
    buffer_load_dwordx4 v[236:239], v5, s[4:7], s49 offen
    v_mfma_f32_16x16x32_bf16 v[36:39], v[120:123], a[172:175], v[36:39]
    s_waitcnt vmcnt(28)
    v_mfma_f32_16x16x32_bf16 v[40:43], v[124:127], a[160:163], v[40:43]
    s_add_u32 s49, s36, 151552
    buffer_load_dwordx4 v[240:243], v5, s[4:7], s49 offen
    v_mfma_f32_16x16x32_bf16 v[44:47], v[124:127], a[164:167], v[44:47]
    v_mfma_f32_16x16x32_bf16 v[48:51], v[124:127], a[168:171], v[48:51]
    s_add_u32 s49, s36, 208896
    buffer_load_dwordx4 v[244:247], v5, s[4:7], s49 offen
    v_mfma_f32_16x16x32_bf16 v[52:55], v[124:127], a[172:175], v[52:55]
    s_waitcnt vmcnt(29)
    v_mfma_f32_16x16x32_bf16 v[56:59], v[128:131], a[160:163], v[56:59]
    s_add_u32 s49, s36, 40960
    buffer_load_dwordx4 v[248:251], v5, s[4:7], s49 offen
    v_mfma_f32_16x16x32_bf16 v[60:63], v[128:131], a[164:167], v[60:63]
    v_mfma_f32_16x16x32_bf16 v[64:67], v[128:131], a[168:171], v[64:67]
    s_add_u32 s49, s36, 98304
    buffer_load_dwordx4 v[252:255], v5, s[4:7], s49 offen
    v_mfma_f32_16x16x32_bf16 v[68:71], v[128:131], a[172:175], v[68:71]
    s_waitcnt vmcnt(30)
    v_mfma_f32_16x16x32_bf16 v[72:75], v[132:135], a[160:163], v[72:75]
    s_add_u32 s49, s36, 155648
    buffer_load_dwordx4 v[88:91], v5, s[4:7], s49 offen
    v_mfma_f32_16x16x32_bf16 v[76:79], v[132:135], a[164:167], v[76:79]
    v_mfma_f32_16x16x32_bf16 v[80:83], v[132:135], a[168:171], v[80:83]
    v_mfma_f32_16x16x32_bf16 v[84:87], v[132:135], a[172:175], v[84:87]
    s_waitcnt vmcnt(30)
    v_mfma_f32_16x16x32_bf16 v[24:27], v[136:139], a[176:179], v[24:27]
    s_add_u32 s49, s36, 212992
    buffer_load_dwordx4 v[92:95], v5, s[4:7], s49 offen
    v_mfma_f32_16x16x32_bf16 v[28:31], v[136:139], a[180:183], v[28:31]
    v_mfma_f32_16x16x32_bf16 v[32:35], v[136:139], a[184:187], v[32:35]
    v_mfma_f32_16x16x32_bf16 v[36:39], v[136:139], a[188:191], v[36:39]
    s_waitcnt vmcnt(30)
    v_mfma_f32_16x16x32_bf16 v[40:43], v[140:143], a[176:179], v[40:43]
    s_add_u32 s49, s36, 45056
    buffer_load_dwordx4 v[96:99], v5, s[4:7], s49 offen
    v_mfma_f32_16x16x32_bf16 v[44:47], v[140:143], a[180:183], v[44:47]
    v_mfma_f32_16x16x32_bf16 v[48:51], v[140:143], a[184:187], v[48:51]
    v_mfma_f32_16x16x32_bf16 v[52:55], v[140:143], a[188:191], v[52:55]
    s_waitcnt vmcnt(30)
    v_mfma_f32_16x16x32_bf16 v[56:59], v[144:147], a[176:179], v[56:59]
    s_add_u32 s49, s36, 102400
    buffer_load_dwordx4 v[100:103], v5, s[4:7], s49 offen
    v_mfma_f32_16x16x32_bf16 v[60:63], v[144:147], a[180:183], v[60:63]
    v_mfma_f32_16x16x32_bf16 v[64:67], v[144:147], a[184:187], v[64:67]
    v_mfma_f32_16x16x32_bf16 v[68:71], v[144:147], a[188:191], v[68:71]
    s_waitcnt vmcnt(30)
    v_mfma_f32_16x16x32_bf16 v[72:75], v[148:151], a[176:179], v[72:75]
    s_add_u32 s49, s36, 159744
    buffer_load_dwordx4 v[104:107], v5, s[4:7], s49 offen
    v_mfma_f32_16x16x32_bf16 v[76:79], v[148:151], a[180:183], v[76:79]
    v_mfma_f32_16x16x32_bf16 v[80:83], v[148:151], a[184:187], v[80:83]
    v_mfma_f32_16x16x32_bf16 v[84:87], v[148:151], a[188:191], v[84:87]
    s_waitcnt vmcnt(30)
    v_mfma_f32_16x16x32_bf16 v[24:27], v[152:155], a[192:195], v[24:27]
    s_add_u32 s49, s36, 217088
    buffer_load_dwordx4 v[108:111], v5, s[4:7], s49 offen
    v_mfma_f32_16x16x32_bf16 v[28:31], v[152:155], a[196:199], v[28:31]
    v_mfma_f32_16x16x32_bf16 v[32:35], v[152:155], a[200:203], v[32:35]
    v_mfma_f32_16x16x32_bf16 v[36:39], v[152:155], a[204:207], v[36:39]
    s_waitcnt vmcnt(30)
    v_mfma_f32_16x16x32_bf16 v[40:43], v[156:159], a[192:195], v[40:43]
    s_add_u32 s49, s36, 49152
    buffer_load_dwordx4 v[112:115], v5, s[4:7], s49 offen
    v_mfma_f32_16x16x32_bf16 v[44:47], v[156:159], a[196:199], v[44:47]
    v_mfma_f32_16x16x32_bf16 v[48:51], v[156:159], a[200:203], v[48:51]
    v_mfma_f32_16x16x32_bf16 v[52:55], v[156:159], a[204:207], v[52:55]
    s_waitcnt vmcnt(30)
    v_mfma_f32_16x16x32_bf16 v[56:59], v[160:163], a[192:195], v[56:59]
    s_add_u32 s49, s36, 106496
    buffer_load_dwordx4 v[116:119], v5, s[4:7], s49 offen
    v_mfma_f32_16x16x32_bf16 v[60:63], v[160:163], a[196:199], v[60:63]
    v_mfma_f32_16x16x32_bf16 v[64:67], v[160:163], a[200:203], v[64:67]
    v_mfma_f32_16x16x32_bf16 v[68:71], v[160:163], a[204:207], v[68:71]
    s_waitcnt vmcnt(30)
    v_mfma_f32_16x16x32_bf16 v[72:75], v[164:167], a[192:195], v[72:75]
    s_add_u32 s49, s36, 163840
    buffer_load_dwordx4 v[120:123], v5, s[4:7], s49 offen
    v_mfma_f32_16x16x32_bf16 v[76:79], v[164:167], a[196:199], v[76:79]
    v_mfma_f32_16x16x32_bf16 v[80:83], v[164:167], a[200:203], v[80:83]
    v_mfma_f32_16x16x32_bf16 v[84:87], v[164:167], a[204:207], v[84:87]
    s_waitcnt vmcnt(30)
    v_mfma_f32_16x16x32_bf16 v[24:27], v[168:171], a[208:211], v[24:27]
    s_add_u32 s49, s36, 221184
    buffer_load_dwordx4 v[124:127], v5, s[4:7], s49 offen
    v_mfma_f32_16x16x32_bf16 v[28:31], v[168:171], a[212:215], v[28:31]
    v_mfma_f32_16x16x32_bf16 v[32:35], v[168:171], a[216:219], v[32:35]
    v_mfma_f32_16x16x32_bf16 v[36:39], v[168:171], a[220:223], v[36:39]
    s_waitcnt vmcnt(30)
    v_mfma_f32_16x16x32_bf16 v[40:43], v[172:175], a[208:211], v[40:43]
    s_add_u32 s49, s36, 53248
    buffer_load_dwordx4 v[128:131], v5, s[4:7], s49 offen
    v_mfma_f32_16x16x32_bf16 v[44:47], v[172:175], a[212:215], v[44:47]
    v_mfma_f32_16x16x32_bf16 v[48:51], v[172:175], a[216:219], v[48:51]
    v_mfma_f32_16x16x32_bf16 v[52:55], v[172:175], a[220:223], v[52:55]
    s_waitcnt vmcnt(30)
    v_mfma_f32_16x16x32_bf16 v[56:59], v[176:179], a[208:211], v[56:59]
    s_add_u32 s49, s36, 110592
    buffer_load_dwordx4 v[132:135], v5, s[4:7], s49 offen
    v_mfma_f32_16x16x32_bf16 v[60:63], v[176:179], a[212:215], v[60:63]
    v_mfma_f32_16x16x32_bf16 v[64:67], v[176:179], a[216:219], v[64:67]
    v_mfma_f32_16x16x32_bf16 v[68:71], v[176:179], a[220:223], v[68:71]
    s_waitcnt vmcnt(30)
    v_mfma_f32_16x16x32_bf16 v[72:75], v[180:183], a[208:211], v[72:75]
    s_add_u32 s49, s36, 167936
    buffer_load_dwordx4 v[136:139], v5, s[4:7], s49 offen
    v_mfma_f32_16x16x32_bf16 v[76:79], v[180:183], a[212:215], v[76:79]
    v_mfma_f32_16x16x32_bf16 v[80:83], v[180:183], a[216:219], v[80:83]
    v_mfma_f32_16x16x32_bf16 v[84:87], v[180:183], a[220:223], v[84:87]
    s_waitcnt vmcnt(30)
    v_mfma_f32_16x16x32_bf16 v[24:27], v[184:187], a[224:227], v[24:27]
    s_add_u32 s49, s36, 225280
    buffer_load_dwordx4 v[140:143], v5, s[4:7], s49 offen
    s_add_u32 s48, s37, 0x8000000
    buffer_load_dwordx2 v[10:11], v3, s[4:7], s48 offen
    buffer_load_ushort v18, v4, s[92:95], s39 offen offset:0
    s_add_u32 s48, s37, 0x8004000
    buffer_load_dwordx2 v[12:13], v3, s[4:7], s48 offen
    buffer_load_ushort v19, v4, s[92:95], s39 offen offset:32
    s_add_u32 s48, s37, 0x8008000
    buffer_load_dwordx2 v[14:15], v3, s[4:7], s48 offen
    buffer_load_ushort v20, v4, s[92:95], s39 offen offset:64
    s_add_u32 s48, s37, 0x800c000
    buffer_load_dwordx2 v[16:17], v3, s[4:7], s48 offen
    buffer_load_ushort v21, v4, s[92:95], s39 offen offset:96
    v_mfma_f32_16x16x32_bf16 v[28:31], v[184:187], a[228:231], v[28:31]
    v_mfma_f32_16x16x32_bf16 v[32:35], v[184:187], a[232:235], v[32:35]
    v_mfma_f32_16x16x32_bf16 v[36:39], v[184:187], a[236:239], v[36:39]
    s_waitcnt vmcnt(38)
    v_mfma_f32_16x16x32_bf16 v[40:43], v[188:191], a[224:227], v[40:43]
    v_mfma_f32_16x16x32_bf16 v[44:47], v[188:191], a[228:231], v[44:47]
    v_mfma_f32_16x16x32_bf16 v[48:51], v[188:191], a[232:235], v[48:51]
    v_mfma_f32_16x16x32_bf16 v[52:55], v[188:191], a[236:239], v[52:55]
    s_waitcnt vmcnt(37)
    v_mfma_f32_16x16x32_bf16 v[56:59], v[192:195], a[224:227], v[56:59]
    v_mfma_f32_16x16x32_bf16 v[60:63], v[192:195], a[228:231], v[60:63]
    v_mfma_f32_16x16x32_bf16 v[64:67], v[192:195], a[232:235], v[64:67]
    v_mfma_f32_16x16x32_bf16 v[68:71], v[192:195], a[236:239], v[68:71]
    s_waitcnt vmcnt(36)
    v_mfma_f32_16x16x32_bf16 v[72:75], v[196:199], a[224:227], v[72:75]
    v_mfma_f32_16x16x32_bf16 v[76:79], v[196:199], a[228:231], v[76:79]
    v_mfma_f32_16x16x32_bf16 v[80:83], v[196:199], a[232:235], v[80:83]
    v_mfma_f32_16x16x32_bf16 v[84:87], v[196:199], a[236:239], v[84:87]
    s_waitcnt vmcnt(35)
    v_mfma_f32_16x16x32_bf16 v[24:27], v[200:203], a[240:243], v[24:27]
    v_mfma_f32_16x16x32_bf16 v[28:31], v[200:203], a[244:247], v[28:31]
    v_mfma_f32_16x16x32_bf16 v[32:35], v[200:203], a[248:251], v[32:35]
    v_mfma_f32_16x16x32_bf16 v[36:39], v[200:203], a[252:255], v[36:39]
    s_waitcnt vmcnt(34)
    v_mfma_f32_16x16x32_bf16 v[40:43], v[204:207], a[240:243], v[40:43]
    v_mfma_f32_16x16x32_bf16 v[44:47], v[204:207], a[244:247], v[44:47]
    v_mfma_f32_16x16x32_bf16 v[48:51], v[204:207], a[248:251], v[48:51]
    v_mfma_f32_16x16x32_bf16 v[52:55], v[204:207], a[252:255], v[52:55]
    s_waitcnt vmcnt(33)
    v_mfma_f32_16x16x32_bf16 v[56:59], v[208:211], a[240:243], v[56:59]
    v_mfma_f32_16x16x32_bf16 v[60:63], v[208:211], a[244:247], v[60:63]
    v_mfma_f32_16x16x32_bf16 v[64:67], v[208:211], a[248:251], v[64:67]
    v_mfma_f32_16x16x32_bf16 v[68:71], v[208:211], a[252:255], v[68:71]
    s_waitcnt vmcnt(32)
    v_mfma_f32_16x16x32_bf16 v[72:75], v[212:215], a[240:243], v[72:75]
    v_mfma_f32_16x16x32_bf16 v[76:79], v[212:215], a[244:247], v[76:79]
    v_mfma_f32_16x16x32_bf16 v[80:83], v[212:215], a[248:251], v[80:83]
    v_mfma_f32_16x16x32_bf16 v[84:87], v[212:215], a[252:255], v[84:87]
    s_waitcnt vmcnt(31)
    v_mfma_f32_16x16x32_bf16 v[24:27], v[216:219], a[0:3], v[24:27]
    v_mfma_f32_16x16x32_bf16 v[28:31], v[216:219], a[4:7], v[28:31]
    v_mfma_f32_16x16x32_bf16 v[32:35], v[216:219], a[8:11], v[32:35]
    v_mfma_f32_16x16x32_bf16 v[36:39], v[216:219], a[12:15], v[36:39]
    s_waitcnt vmcnt(30)
    v_mfma_f32_16x16x32_bf16 v[40:43], v[220:223], a[0:3], v[40:43]
    v_mfma_f32_16x16x32_bf16 v[44:47], v[220:223], a[4:7], v[44:47]
    v_mfma_f32_16x16x32_bf16 v[48:51], v[220:223], a[8:11], v[48:51]
    v_mfma_f32_16x16x32_bf16 v[52:55], v[220:223], a[12:15], v[52:55]
    s_waitcnt vmcnt(29)
    v_mfma_f32_16x16x32_bf16 v[56:59], v[224:227], a[0:3], v[56:59]
    v_mfma_f32_16x16x32_bf16 v[60:63], v[224:227], a[4:7], v[60:63]
    v_mfma_f32_16x16x32_bf16 v[64:67], v[224:227], a[8:11], v[64:67]
    v_mfma_f32_16x16x32_bf16 v[68:71], v[224:227], a[12:15], v[68:71]
    s_waitcnt vmcnt(28)
    v_mfma_f32_16x16x32_bf16 v[72:75], v[228:231], a[0:3], v[72:75]
    v_mfma_f32_16x16x32_bf16 v[76:79], v[228:231], a[4:7], v[76:79]
    v_mfma_f32_16x16x32_bf16 v[80:83], v[228:231], a[8:11], v[80:83]
    v_mfma_f32_16x16x32_bf16 v[84:87], v[228:231], a[12:15], v[84:87]
    s_waitcnt vmcnt(27)
    v_mfma_f32_16x16x32_bf16 v[24:27], v[232:235], a[16:19], v[24:27]
    v_mfma_f32_16x16x32_bf16 v[28:31], v[232:235], a[20:23], v[28:31]
    v_mfma_f32_16x16x32_bf16 v[32:35], v[232:235], a[24:27], v[32:35]
    v_mfma_f32_16x16x32_bf16 v[36:39], v[232:235], a[28:31], v[36:39]
    s_waitcnt vmcnt(26)
    v_mfma_f32_16x16x32_bf16 v[40:43], v[236:239], a[16:19], v[40:43]
    v_mfma_f32_16x16x32_bf16 v[44:47], v[236:239], a[20:23], v[44:47]
    v_mfma_f32_16x16x32_bf16 v[48:51], v[236:239], a[24:27], v[48:51]
    v_mfma_f32_16x16x32_bf16 v[52:55], v[236:239], a[28:31], v[52:55]
    s_waitcnt vmcnt(25)
    v_mfma_f32_16x16x32_bf16 v[56:59], v[240:243], a[16:19], v[56:59]
    v_mfma_f32_16x16x32_bf16 v[60:63], v[240:243], a[20:23], v[60:63]
    v_mfma_f32_16x16x32_bf16 v[64:67], v[240:243], a[24:27], v[64:67]
    v_mfma_f32_16x16x32_bf16 v[68:71], v[240:243], a[28:31], v[68:71]
    s_waitcnt vmcnt(24)
    v_mfma_f32_16x16x32_bf16 v[72:75], v[244:247], a[16:19], v[72:75]
    v_mfma_f32_16x16x32_bf16 v[76:79], v[244:247], a[20:23], v[76:79]
    v_mfma_f32_16x16x32_bf16 v[80:83], v[244:247], a[24:27], v[80:83]
    v_mfma_f32_16x16x32_bf16 v[84:87], v[244:247], a[28:31], v[84:87]
    s_waitcnt vmcnt(23)
    v_mfma_f32_16x16x32_bf16 v[24:27], v[248:251], a[32:35], v[24:27]
    v_mfma_f32_16x16x32_bf16 v[28:31], v[248:251], a[36:39], v[28:31]
    v_mfma_f32_16x16x32_bf16 v[32:35], v[248:251], a[40:43], v[32:35]
    v_mfma_f32_16x16x32_bf16 v[36:39], v[248:251], a[44:47], v[36:39]
    s_waitcnt vmcnt(22)
    v_mfma_f32_16x16x32_bf16 v[40:43], v[252:255], a[32:35], v[40:43]
    v_mfma_f32_16x16x32_bf16 v[44:47], v[252:255], a[36:39], v[44:47]
    v_mfma_f32_16x16x32_bf16 v[48:51], v[252:255], a[40:43], v[48:51]
    v_mfma_f32_16x16x32_bf16 v[52:55], v[252:255], a[44:47], v[52:55]
    s_waitcnt vmcnt(21)
    v_mfma_f32_16x16x32_bf16 v[56:59], v[88:91], a[32:35], v[56:59]
    v_mfma_f32_16x16x32_bf16 v[60:63], v[88:91], a[36:39], v[60:63]
    v_mfma_f32_16x16x32_bf16 v[64:67], v[88:91], a[40:43], v[64:67]
    v_mfma_f32_16x16x32_bf16 v[68:71], v[88:91], a[44:47], v[68:71]
    s_waitcnt vmcnt(20)
    v_mfma_f32_16x16x32_bf16 v[72:75], v[92:95], a[32:35], v[72:75]
    v_mfma_f32_16x16x32_bf16 v[76:79], v[92:95], a[36:39], v[76:79]
    v_mfma_f32_16x16x32_bf16 v[80:83], v[92:95], a[40:43], v[80:83]
    v_mfma_f32_16x16x32_bf16 v[84:87], v[92:95], a[44:47], v[84:87]
    s_waitcnt vmcnt(19)
    v_mfma_f32_16x16x32_bf16 v[24:27], v[96:99], a[48:51], v[24:27]
    v_mfma_f32_16x16x32_bf16 v[28:31], v[96:99], a[52:55], v[28:31]
    v_mfma_f32_16x16x32_bf16 v[32:35], v[96:99], a[56:59], v[32:35]
    v_mfma_f32_16x16x32_bf16 v[36:39], v[96:99], a[60:63], v[36:39]
    s_waitcnt vmcnt(18)
    v_mfma_f32_16x16x32_bf16 v[40:43], v[100:103], a[48:51], v[40:43]
    v_mfma_f32_16x16x32_bf16 v[44:47], v[100:103], a[52:55], v[44:47]
    v_mfma_f32_16x16x32_bf16 v[48:51], v[100:103], a[56:59], v[48:51]
    v_mfma_f32_16x16x32_bf16 v[52:55], v[100:103], a[60:63], v[52:55]
    s_waitcnt vmcnt(17)
    v_mfma_f32_16x16x32_bf16 v[56:59], v[104:107], a[48:51], v[56:59]
    v_mfma_f32_16x16x32_bf16 v[60:63], v[104:107], a[52:55], v[60:63]
    v_mfma_f32_16x16x32_bf16 v[64:67], v[104:107], a[56:59], v[64:67]
    v_mfma_f32_16x16x32_bf16 v[68:71], v[104:107], a[60:63], v[68:71]
    s_waitcnt vmcnt(16)
    v_mfma_f32_16x16x32_bf16 v[72:75], v[108:111], a[48:51], v[72:75]
    v_mfma_f32_16x16x32_bf16 v[76:79], v[108:111], a[52:55], v[76:79]
    v_mfma_f32_16x16x32_bf16 v[80:83], v[108:111], a[56:59], v[80:83]
    v_mfma_f32_16x16x32_bf16 v[84:87], v[108:111], a[60:63], v[84:87]
    s_waitcnt vmcnt(15)
    v_mfma_f32_16x16x32_bf16 v[24:27], v[112:115], a[64:67], v[24:27]
    v_mfma_f32_16x16x32_bf16 v[28:31], v[112:115], a[68:71], v[28:31]
    v_mfma_f32_16x16x32_bf16 v[32:35], v[112:115], a[72:75], v[32:35]
    v_mfma_f32_16x16x32_bf16 v[36:39], v[112:115], a[76:79], v[36:39]
    s_waitcnt vmcnt(14)
    v_mfma_f32_16x16x32_bf16 v[40:43], v[116:119], a[64:67], v[40:43]
    v_mfma_f32_16x16x32_bf16 v[44:47], v[116:119], a[68:71], v[44:47]
    v_mfma_f32_16x16x32_bf16 v[48:51], v[116:119], a[72:75], v[48:51]
    v_mfma_f32_16x16x32_bf16 v[52:55], v[116:119], a[76:79], v[52:55]
    s_waitcnt vmcnt(13)
    v_mfma_f32_16x16x32_bf16 v[56:59], v[120:123], a[64:67], v[56:59]
    v_mfma_f32_16x16x32_bf16 v[60:63], v[120:123], a[68:71], v[60:63]
    v_mfma_f32_16x16x32_bf16 v[64:67], v[120:123], a[72:75], v[64:67]
    v_mfma_f32_16x16x32_bf16 v[68:71], v[120:123], a[76:79], v[68:71]
    s_waitcnt vmcnt(12)
    v_mfma_f32_16x16x32_bf16 v[72:75], v[124:127], a[64:67], v[72:75]
    v_mfma_f32_16x16x32_bf16 v[76:79], v[124:127], a[68:71], v[76:79]
    v_mfma_f32_16x16x32_bf16 v[80:83], v[124:127], a[72:75], v[80:83]
    v_mfma_f32_16x16x32_bf16 v[84:87], v[124:127], a[76:79], v[84:87]
    s_waitcnt vmcnt(11)
    v_mfma_f32_16x16x32_bf16 v[24:27], v[128:131], a[80:83], v[24:27]
    v_mfma_f32_16x16x32_bf16 v[28:31], v[128:131], a[84:87], v[28:31]
    v_mfma_f32_16x16x32_bf16 v[32:35], v[128:131], a[88:91], v[32:35]
    v_mfma_f32_16x16x32_bf16 v[36:39], v[128:131], a[92:95], v[36:39]
    s_waitcnt vmcnt(10)
    v_mfma_f32_16x16x32_bf16 v[40:43], v[132:135], a[80:83], v[40:43]
    v_mfma_f32_16x16x32_bf16 v[44:47], v[132:135], a[84:87], v[44:47]
    v_mfma_f32_16x16x32_bf16 v[48:51], v[132:135], a[88:91], v[48:51]
    v_mfma_f32_16x16x32_bf16 v[52:55], v[132:135], a[92:95], v[52:55]
    s_waitcnt vmcnt(9)
    v_mfma_f32_16x16x32_bf16 v[56:59], v[136:139], a[80:83], v[56:59]
    v_mfma_f32_16x16x32_bf16 v[60:63], v[136:139], a[84:87], v[60:63]
    v_mfma_f32_16x16x32_bf16 v[64:67], v[136:139], a[88:91], v[64:67]
    v_mfma_f32_16x16x32_bf16 v[68:71], v[136:139], a[92:95], v[68:71]
    s_waitcnt vmcnt(8)
    v_mfma_f32_16x16x32_bf16 v[72:75], v[140:143], a[80:83], v[72:75]
    v_mfma_f32_16x16x32_bf16 v[76:79], v[140:143], a[84:87], v[76:79]
    v_mfma_f32_16x16x32_bf16 v[80:83], v[140:143], a[88:91], v[80:83]
    v_mfma_f32_16x16x32_bf16 v[84:87], v[140:143], a[92:95], v[84:87]
    s_lshl_b32 s48, s33, 12
    v_add_u32 v6, s48, v5
    ds_write_b128 v6, v[24:27] offset:0
    ds_write_b128 v6, v[28:31] offset:1024
    ds_write_b128 v6, v[32:35] offset:2048
    ds_write_b128 v6, v[36:39] offset:3072
    s_waitcnt lgkmcnt(8)
    ds_write_b128 v6, v[40:43] offset:16384
    ds_write_b128 v6, v[44:47] offset:17408
    ds_write_b128 v6, v[48:51] offset:18432
    ds_write_b128 v6, v[52:55] offset:19456
    s_waitcnt lgkmcnt(8)
    ds_write_b128 v6, v[56:59] offset:32768
    ds_write_b128 v6, v[60:63] offset:33792
    ds_write_b128 v6, v[64:67] offset:34816
    ds_write_b128 v6, v[68:71] offset:35840
    s_waitcnt lgkmcnt(8)
    ds_write_b128 v6, v[72:75] offset:49152
    ds_write_b128 v6, v[76:79] offset:50176
    ds_write_b128 v6, v[80:83] offset:51200
    ds_write_b128 v6, v[84:87] offset:52224
    s_waitcnt lgkmcnt(8)
    s_lshl_b32 s48, s33, 14
    v_add_u32 v6, s48, v5
    s_waitcnt lgkmcnt(0)
    s_barrier
    ds_read_b128 v[24:27], v6 offset:0
    ds_read_b128 v[28:31], v6 offset:1024
    ds_read_b128 v[32:35], v6 offset:2048
    ds_read_b128 v[36:39], v6 offset:3072
    ds_read_b128 v[40:43], v6 offset:4096
    ds_read_b128 v[44:47], v6 offset:5120
    ds_read_b128 v[48:51], v6 offset:6144
    ds_read_b128 v[52:55], v6 offset:7168
    ds_read_b128 v[56:59], v6 offset:8192
    ds_read_b128 v[60:63], v6 offset:9216
    ds_read_b128 v[64:67], v6 offset:10240
    ds_read_b128 v[68:71], v6 offset:11264
    s_waitcnt lgkmcnt(8)
    ds_read_b128 v[72:75], v6 offset:12288
    ds_read_b128 v[76:79], v6 offset:13312
    ds_read_b128 v[80:83], v6 offset:14336
    ds_read_b128 v[84:87], v6 offset:15360
    s_waitcnt lgkmcnt(0) vmcnt(0)
    v_pk_add_f32 v[24:25], v[24:25], v[40:41]
    v_pk_add_f32 v[56:57], v[56:57], v[72:73]
    v_pk_add_f32 v[26:27], v[26:27], v[42:43]
    v_pk_add_f32 v[58:59], v[58:59], v[74:75]
    v_pk_add_f32 v[28:29], v[28:29], v[44:45]
    v_pk_add_f32 v[60:61], v[60:61], v[76:77]
    v_pk_add_f32 v[30:31], v[30:31], v[46:47]
    v_pk_add_f32 v[62:63], v[62:63], v[78:79]
    v_pk_add_f32 v[32:33], v[32:33], v[48:49]
    v_pk_add_f32 v[64:65], v[64:65], v[80:81]
    v_pk_add_f32 v[34:35], v[34:35], v[50:51]
    v_pk_add_f32 v[66:67], v[66:67], v[82:83]
    v_pk_add_f32 v[36:37], v[36:37], v[52:53]
    v_pk_add_f32 v[68:69], v[68:69], v[84:85]
    v_pk_add_f32 v[38:39], v[38:39], v[54:55]
    v_pk_add_f32 v[70:71], v[70:71], v[86:87]
    v_pk_add_f32 v[24:25], v[24:25], v[56:57]
    v_pk_add_f32 v[26:27], v[26:27], v[58:59]
    v_pk_add_f32 v[28:29], v[28:29], v[60:61]
    v_pk_add_f32 v[30:31], v[30:31], v[62:63]
    v_pk_add_f32 v[32:33], v[32:33], v[64:65]
    v_pk_add_f32 v[34:35], v[34:35], v[66:67]
    v_pk_add_f32 v[36:37], v[36:37], v[68:69]
    v_pk_add_f32 v[38:39], v[38:39], v[70:71]
    v_cvt_pk_bf16_f32 v88, v24, v25
    v_cvt_pk_bf16_f32 v89, v26, v27
    v_lshlrev_b32 v90, 16, v18
    v_lshlrev_b32 v24, 16, v88
    v_and_b32 v25, 0xffff0000, v88
    v_lshlrev_b32 v26, 16, v89
    v_and_b32 v27, 0xffff0000, v89
    v_add_f32 v24, v24, v90
    v_add_f32 v25, v25, v90
    v_add_f32 v26, v26, v90
    v_add_f32 v27, v27, v90
    v_cvt_pk_bf16_f32 v88, v24, v25
    v_cvt_pk_bf16_f32 v89, v26, v27
    v_lshlrev_b32 v24, 16, v88
    v_and_b32 v25, 0xffff0000, v88
    v_lshlrev_b32 v90, 16, v10
    v_and_b32 v91, 0xffff0000, v10
    v_add_f32 v24, v24, v90
    v_add_f32 v25, v25, v91
    v_lshlrev_b32 v26, 16, v89
    v_and_b32 v27, 0xffff0000, v89
    v_lshlrev_b32 v90, 16, v11
    v_and_b32 v91, 0xffff0000, v11
    v_add_f32 v26, v26, v90
    v_add_f32 v27, v27, v91
    v_cvt_pk_bf16_f32 v92, v24, v25
    v_cvt_pk_bf16_f32 v93, v26, v27
    s_add_u32 s48, s37, 0
    buffer_store_dwordx2 v[92:93], v3, s[88:91], s48 offen
    v_cvt_pk_bf16_f32 v88, v28, v29
    v_cvt_pk_bf16_f32 v89, v30, v31
    v_lshlrev_b32 v90, 16, v19
    v_lshlrev_b32 v28, 16, v88
    v_and_b32 v29, 0xffff0000, v88
    v_lshlrev_b32 v30, 16, v89
    v_and_b32 v31, 0xffff0000, v89
    v_add_f32 v28, v28, v90
    v_add_f32 v29, v29, v90
    v_add_f32 v30, v30, v90
    v_add_f32 v31, v31, v90
    v_cvt_pk_bf16_f32 v88, v28, v29
    v_cvt_pk_bf16_f32 v89, v30, v31
    v_lshlrev_b32 v28, 16, v88
    v_and_b32 v29, 0xffff0000, v88
    v_lshlrev_b32 v90, 16, v12
    v_and_b32 v91, 0xffff0000, v12
    v_add_f32 v28, v28, v90
    v_add_f32 v29, v29, v91
    v_lshlrev_b32 v30, 16, v89
    v_and_b32 v31, 0xffff0000, v89
    v_lshlrev_b32 v90, 16, v13
    v_and_b32 v91, 0xffff0000, v13
    v_add_f32 v30, v30, v90
    v_add_f32 v31, v31, v91
    v_cvt_pk_bf16_f32 v94, v28, v29
    v_cvt_pk_bf16_f32 v95, v30, v31
    s_add_u32 s48, s37, 16384
    buffer_store_dwordx2 v[94:95], v3, s[88:91], s48 offen
    v_cvt_pk_bf16_f32 v88, v32, v33
    v_cvt_pk_bf16_f32 v89, v34, v35
    v_lshlrev_b32 v90, 16, v20
    v_lshlrev_b32 v32, 16, v88
    v_and_b32 v33, 0xffff0000, v88
    v_lshlrev_b32 v34, 16, v89
    v_and_b32 v35, 0xffff0000, v89
    v_add_f32 v32, v32, v90
    v_add_f32 v33, v33, v90
    v_add_f32 v34, v34, v90
    v_add_f32 v35, v35, v90
    v_cvt_pk_bf16_f32 v88, v32, v33
    v_cvt_pk_bf16_f32 v89, v34, v35
    v_lshlrev_b32 v32, 16, v88
    v_and_b32 v33, 0xffff0000, v88
    v_lshlrev_b32 v90, 16, v14
    v_and_b32 v91, 0xffff0000, v14
    v_add_f32 v32, v32, v90
    v_add_f32 v33, v33, v91
    v_lshlrev_b32 v34, 16, v89
    v_and_b32 v35, 0xffff0000, v89
    v_lshlrev_b32 v90, 16, v15
    v_and_b32 v91, 0xffff0000, v15
    v_add_f32 v34, v34, v90
    v_add_f32 v35, v35, v91
    v_cvt_pk_bf16_f32 v96, v32, v33
    v_cvt_pk_bf16_f32 v97, v34, v35
    s_add_u32 s48, s37, 32768
    buffer_store_dwordx2 v[96:97], v3, s[88:91], s48 offen
    v_cvt_pk_bf16_f32 v88, v36, v37
    v_cvt_pk_bf16_f32 v89, v38, v39
    v_lshlrev_b32 v90, 16, v21
    v_lshlrev_b32 v36, 16, v88
    v_and_b32 v37, 0xffff0000, v88
    v_lshlrev_b32 v38, 16, v89
    v_and_b32 v39, 0xffff0000, v89
    v_add_f32 v36, v36, v90
    v_add_f32 v37, v37, v90
    v_add_f32 v38, v38, v90
    v_add_f32 v39, v39, v90
    v_cvt_pk_bf16_f32 v88, v36, v37
    v_cvt_pk_bf16_f32 v89, v38, v39
    v_lshlrev_b32 v36, 16, v88
    v_and_b32 v37, 0xffff0000, v88
    v_lshlrev_b32 v90, 16, v16
    v_and_b32 v91, 0xffff0000, v16
    v_add_f32 v36, v36, v90
    v_add_f32 v37, v37, v91
    v_lshlrev_b32 v38, 16, v89
    v_and_b32 v39, 0xffff0000, v89
    v_lshlrev_b32 v90, 16, v17
    v_and_b32 v91, 0xffff0000, v17
    v_add_f32 v38, v38, v90
    v_add_f32 v39, v39, v91
    v_cvt_pk_bf16_f32 v98, v36, v37
    v_cvt_pk_bf16_f32 v99, v38, v39
    s_add_u32 s48, s37, 49152
    buffer_store_dwordx2 v[98:99], v3, s[88:91], s48 offen
L_exit_1:
    s_endpgm
.section .rodata,"a"
.p2align 6
.amdhsa_kernel sequential_preLN__memory_aug_recurrent_mem_tr__mixer_token_mlp__prompt_kernel
  .amdhsa_next_free_vgpr 512
  .amdhsa_next_free_sgpr 102
  .amdhsa_accum_offset 256
  .amdhsa_group_segment_fixed_size 0
  .amdhsa_kernarg_size 120
  .amdhsa_user_sgpr_count 2
  .amdhsa_user_sgpr_kernarg_segment_ptr 1
  .amdhsa_system_sgpr_workgroup_id_x 1
.end_amdhsa_kernel
```
